```python
import torch

def _softmax(x, axis=-1):
    return torch.softmax(x, dim=axis)
def _gelu(x):
    return torch.nn.functional.gelu(x, approximate="tanh")
def _silu(x):
    return torch.nn.functional.silu(x)
def _sigmoid(x):
    return torch.sigmoid(x)
def _layernorm(x, axis=-1, eps=1e-5):
    m = x.mean(dim=axis, keepdim=True)
    v = x.var(dim=axis, keepdim=True, unbiased=False)
    return (x - m) / torch.sqrt(v + eps)
def _scatter_add(tgt, idx, src, axis=0):
    return tgt.clone().index_add_(axis, idx, src)
def _segment_sum(src, seg, n):
    out = torch.zeros((n,) + src.shape[1:], dtype=src.dtype)
    return out.index_add_(0, seg, src)
def _pad(x, pw):
    flat = tuple(v for pair in reversed(pw) for v in pair)
    return torch.nn.functional.pad(x, flat)

kernel_name = 'standalone__mha_block_cached__near_ridge'

def setup_inputs():

    _w = (lambda a: (lambda t: t.to(torch.bfloat16) if t.is_floating_point() else t)(torch.as_tensor(a)))
    B, Sq, D = 16, 96, 640
    H, Sk, Dh = 32, 512, 128
    return {
        "x": _w((lambda *s: torch.randn(*s, dtype=torch.bfloat16) * 0.8)(B, Sq, D)),
        "k_cache": _w((lambda *s: torch.randn(*s, dtype=torch.bfloat16) * 0.8)(B, H, Sk, Dh)),
        "v_cache": _w((lambda *s: torch.randn(*s, dtype=torch.bfloat16) * 0.05)(B, H, Sk, Dh)),
        "wq": _w((lambda *s: torch.randn(*s, dtype=torch.bfloat16) * 0.8)(D, H * Dh) * (D ** -0.5)),
        "wo": _w((lambda *s: torch.randn(*s, dtype=torch.bfloat16) * 0.05)(H * Dh, D) * ((H * Dh) ** -0.5)),
    }

def reference(x, k_cache, v_cache, wq, wo):
    B, Sq, D = x.shape
    H, Dh = 32, 128
    q = (lambda x, *d: x.permute(*d))((x @ wq).reshape(B, Sq, H, Dh), 0, 2, 1, 3)
    scores = torch.einsum("bhqd,bhkd->bhqk", q, k_cache) * (Dh ** -0.5)
    p = _softmax(scores, axis=-1)
    o = torch.einsum("bhqk,bhkd->bhqd", p, v_cache)
    return (lambda x, *d: x.permute(*d))(o, 0, 2, 1, 3).reshape(B, Sq, H * Dh) @ wo
```

```asm
; @launch grid=(256,1,1) block=(512,1,1) lds=163840
.amdgcn_target "amdgcn-amd-amdhsa--gfx950"
.text
.globl standalone__mha_block_cached__near_ridge_kernel
.p2align 8
.type standalone__mha_block_cached__near_ridge_kernel,@function
standalone__mha_block_cached__near_ridge_kernel:
    s_cmp_ge_u32 s2, 256
    s_cbranch_scc1 K1_END
    s_load_dwordx16 s[32:47], s[0:1], 0
    s_getpc_b64 s[30:31]
K1_pc_1:
    v_lshlrev_b32 v2, 7, v0
    v_min_u32 v2, K1_CODE_END-K1_pc_1-4, v2
    global_load_dword v31, v2, s[30:31]
    v_lshrrev_b32 v1, 6, v0
    v_and_b32 v0, 63, v0
    v_readfirstlane_b32 s48, v1
    s_and_b32 s56, s2, 7
    s_lshr_b32 s57, s2, 3
    s_and_b32 s53, s56, 3
    s_lshl_b32 s53, s53, 2
    s_and_b32 s58, s57, 3
    s_add_u32 s53, s53, s58
    s_mul_i32 s3, s58, 10
    s_lshr_b32 s58, s57, 2
    s_mul_i32 s64, s58, 5
    s_add_u32 s3, s3, s64
    s_lshr_b32 s3, s3, 2
    s_sub_u32 s64, s3, 10
    s_cmp_ge_u32 s3, 10
    s_cselect_b32 s3, s64, s3
    s_lshr_b32 s54, s56, 2
    s_lshl_b32 s54, s54, 3
    s_add_u32 s54, s54, s58
    s_lshr_b32 s49, s48, 2
    s_and_b32 s50, s48, 1
    s_bfe_u32 s51, s48, 0x10001
    s_and_b32 s52, s48, 3
    s_lshl_b32 s67, s53, 1
    s_add_u32 s67, s67, s49
    s_lshl_b32 s56, s54, 5
    s_add_u32 s56, s56, s67
    s_lshl_b32 s55, s56, 17
    s_lshl_b32 s57, s52, 12
    s_add_u32 s55, s55, s57
    s_mov_b32 s58, s67
    s_and_b32 s58, s58, 7
    s_lshl_b32 s58, s58, 14
    s_or_b32 s55, s55, s58
    s_lshl_b32 s60, s49, 16
    s_add_u32 s61, s60, s57
    s_lshl_b32 s62, s48, 11
    s_add_u32 s62, s62, 32768
    s_mul_i32 s63, s48, 1536
    s_add_u32 s63, s63, 131072
    s_mov_b32 s59, 0x3e0293ee
    s_mov_b32 s29, 0x41200000
    v_lshrrev_b32 v5, 4, v0
    v_and_b32 v6, 15, v0
    v_lshlrev_b32 v7, 4, v0
    v_lshrrev_b32 v1, 5, v0
    s_lshl_b32 s56, s51, 2
    v_add_u32 v2, s56, v1
    s_lshl_b32 s56, s48, 2
    v_add_u32 v1, s56, v1
    v_lshlrev_b32 v1, 13, v1
    s_lshl_b32 s56, s53, 9
    v_add_u32 v1, s56, v1
    v_bfe_u32 v3, v0, 4, 1
    v_lshl_add_u32 v1, v3, 8, v1
    v_add_u32 v3, 0, v2
    v_lshlrev_b32 v3, 1, v3
    v_xor_b32 v3, v3, v6
    v_lshl_add_u32 v24, v3, 4, v1
    v_add_u32 v3, 2, v2
    v_lshlrev_b32 v3, 1, v3
    v_xor_b32 v3, v3, v6
    v_lshl_add_u32 v25, v3, 4, v1
    v_add_u32 v25, 15360, v25
    s_mul_i32 s56, s48, 12
    v_lshrrev_b32 v1, 3, v0
    v_add_u32 v1, s56, v1
    v_and_b32 v4, 7, v0
    s_mul_i32 s57, s54, 96
    s_mov_b32 s58, 1280
    v_bfe_u32 v2, v1, 1, 3
    v_xor_b32 v2, v2, v4
    v_add_u32 v3, s57, v1
    v_mul_lo_u32 v3, v3, s58
    v_lshl_add_u32 v26, v2, 4, v3
    v_add_u32 v1, 8, v1
    v_bfe_u32 v2, v1, 1, 3
    v_xor_b32 v2, v2, v4
    v_add_u32 v3, s57, v1
    v_mul_lo_u32 v3, v3, s58
    v_lshl_add_u32 v27, v2, 4, v3
    v_subrev_u32 v27, 1024, v27
    s_waitcnt lgkmcnt(0)
    s_mov_b32 s4, s32
    s_and_b32 s5, s33, 0xffff
    s_mov_b32 s6, 0x1e0000
    s_mov_b32 s7, 0x20000
    s_mov_b32 s16, s38
    s_and_b32 s17, s39, 0xffff
    s_mov_b32 s18, 0x500000
    s_mov_b32 s19, 0x20000
    s_mov_b32 s24, s46
    s_and_b32 s25, s47, 0xffff
    s_mov_b32 s26, 0x10000000
    s_mov_b32 s27, 0x20000
    s_mov_b32 s47, s3
    s_mov_b32 m0, s63
    s_lshl_b32 s66, s47, 7
    buffer_load_dwordx4 v26, s[4:7], s66 offen lds
    s_mov_b32 exec_hi, 0
    buffer_load_dwordx4 v27, s[4:7], s66 offen offset:1024 lds
    s_mov_b32 exec_hi, -1
    s_add_u32 s47, s47, 1
    s_cmp_eq_u32 s47, 10
    s_cselect_b32 s47, 0, s47
    s_mov_b32 m0, s62
    s_lshl_b32 s65, s3, 19
    buffer_load_dwordx4 v24, s[16:19], s65 offen lds
    buffer_load_dwordx4 v25, s[16:19], s65 offen offset:1024 lds
    s_add_u32 m0, s62, 16384
    s_add_u32 s65, s65, 262144
    buffer_load_dwordx4 v24, s[16:19], s65 offen lds
    buffer_load_dwordx4 v25, s[16:19], s65 offen offset:1024 lds
    s_add_u32 s3, s3, 1
    s_cmp_eq_u32 s3, 10
    s_cselect_b32 s3, 0, s3
    s_mov_b32 s8, s34
    s_and_b32 s9, s35, 0xffff
    s_mov_b32 s10, 0x4000000
    s_mov_b32 s11, 0x20000
    s_mov_b32 s12, s36
    s_and_b32 s13, s37, 0xffff
    s_mov_b32 s14, 0x4000000
    s_mov_b32 s15, 0x20000
    s_mov_b32 s20, s40
    s_and_b32 s21, s41, 0xffff
    s_mov_b32 s22, 0x500000
    s_mov_b32 s23, 0x20000
    s_mov_b32 s32, s42
    s_and_b32 s33, s43, 0xffff
    s_mov_b32 s34, 0x1e0000
    s_mov_b32 s35, 0x20000
    s_mov_b32 s36, s44
    s_and_b32 s37, s45, 0xffff
    s_mov_b32 s38, 0x100
    s_mov_b32 s39, 0x20000
    v_xor_b32 v1, v6, v5
    v_lshlrev_b32 v1, 4, v1
    v_lshl_add_u32 v8, v5, 8, v1
    v_xor_b32 v9, 64, v8
    v_xor_b32 v10, 128, v8
    v_xor_b32 v11, 192, v8
    v_lshlrev_b32 v1, 1, v5
    v_xor_b32 v1, v1, v6
    v_lshlrev_b32 v1, 4, v1
    v_lshl_add_u32 v16, v5, 8, v1
    v_xor_b32 v17, 128, v16
    v_bfe_u32 v1, v0, 2, 2
    v_and_b32 v2, 1, v5
    v_lshl_add_u32 v2, v2, 2, v1
    v_lshl_add_u32 v3, v5, 3, v1
    v_lshlrev_b32 v3, 9, v3
    v_and_b32 v4, 3, v0
    v_lshl_add_u32 v3, v4, 3, v3
    s_lshl_b32 s56, s49, 8
    s_add_u32 s56, s56, 32768
    v_add_u32 v3, s56, v3
    s_lshl_b32 s56, s51, 2
    v_xor_b32 v2, s56, v2
    v_xor_b32 v4, 0, v2
    v_lshl_add_u32 v28, v4, 5, v3
    v_xor_b32 v4, 1, v2
    v_lshl_add_u32 v29, v4, 5, v3
    v_xor_b32 v4, 2, v2
    v_lshl_add_u32 v30, v4, 5, v3
    v_xor_b32 v4, 3, v2
    v_lshl_add_u32 v60, v4, 5, v3
    s_mul_i32 s56, s50, 6144
    s_add_u32 s56, s56, 131072
    v_lshlrev_b32 v1, 7, v6
    v_add_u32 v1, s56, v1
    v_lshrrev_b32 v2, 1, v6
    v_xor_b32 v2, v2, v5
    v_lshl_add_u32 v18, v2, 4, v1
    v_xor_b32 v19, 64, v18
    s_mul_i32 s56, s50, 12288
    s_add_u32 s56, s56, s60
    s_add_u32 s56, s56, 32768
    v_add_u32 v21, s56, v7
    s_lshl_b32 s57, s51, 11
    s_add_u32 s56, s56, s57
    v_lshrrev_b32 v1, 1, v5
    v_lshlrev_b32 v1, 8, v1
    v_lshl_add_u32 v1, v6, 4, v1
    v_and_b32 v2, 1, v5
    v_lshl_add_u32 v1, v2, 3, v1
    v_add_u32 v20, s56, v1
    s_lshl_b32 s56, s51, 13
    s_add_u32 s56, s56, s60
    v_xor_b32 v1, v5, v6
    v_lshlrev_b32 v1, 4, v1
    v_lshl_add_u32 v1, v6, 8, v1
    v_add_u32 v12, s56, v1
    v_xor_b32 v13, 64, v12
    v_xor_b32 v14, 128, v12
    v_xor_b32 v15, 192, v12
    s_bfe_u32 s41, s2, 0x20003
    s_lshr_b32 s57, s2, 5
    s_lshl_b32 s46, s41, 1
    s_add_u32 s46, s46, s57
    s_bfe_u32 s56, s2, 0x10001
    s_lshl_b32 s56, s56, 2
    s_add_u32 s41, s41, s56
    s_bfe_u32 s56, s2, 0x10002
    s_lshl_b32 s56, s56, 3
    s_add_u32 s40, s56, s57
    s_lshl_b32 s40, s40, 1
    s_and_b32 s58, s2, 1
    s_add_u32 s40, s40, s58
    s_lshl_b32 s42, s58, 3
    s_add_u32 s42, s42, s48
    s_lshl_b32 s42, s42, 3
    s_mul_i32 s43, s42, 40
    s_mul_i32 s56, s41, 5
    s_add_u32 s43, s43, s56
    s_lshl_b32 s43, s43, 10
    s_add_u32 s43, s43, 16777216
    s_lshl_b32 s44, s54, 4
    s_add_u32 s44, s44, s53
    s_lshl_b32 s44, s44, 8
    s_add_u32 s44, s44, 25165824
    s_cmp_eq_u32 s48, 0
    s_cselect_b32 s44, s44, 0x7f000000
    s_memrealtime s[30:31]
    s_or_b32 s56, s2, s48
    s_cmp_eq_u32 s56, 0
    s_cselect_b32 s56, 0, 0x7f000000
    s_waitcnt lgkmcnt(0)
    s_or_b32 s31, s31, 0x80000000
    v_mov_b32 v2, s30
    v_mov_b32 v3, s31
    v_mov_b32 v1, 0
    s_mov_b64 exec, 1
    buffer_store_dwordx2 v[2:3], v1, s[36:39], s56 offen sc1
    s_mov_b64 exec, -1
    s_nop 1
    s_add_u32 m0, s63, 12288
    s_lshl_b32 s66, s47, 7
    buffer_load_dwordx4 v26, s[4:7], s66 offen lds
    s_mov_b32 exec_hi, 0
    buffer_load_dwordx4 v27, s[4:7], s66 offen offset:1024 lds
    s_mov_b32 exec_hi, -1
    s_add_u32 s47, s47, 1
    s_cmp_eq_u32 s47, 10
    s_cselect_b32 s47, 0, s47
    s_add_u32 m0, s62, 65536
    s_lshl_b32 s65, s3, 19
    buffer_load_dwordx4 v24, s[16:19], s65 offen lds
    buffer_load_dwordx4 v25, s[16:19], s65 offen offset:1024 lds
    s_add_u32 m0, s62, 81920
    s_add_u32 s65, s65, 262144
    buffer_load_dwordx4 v24, s[16:19], s65 offen lds
    buffer_load_dwordx4 v25, s[16:19], s65 offen offset:1024 lds
    s_add_u32 s3, s3, 1
    s_cmp_eq_u32 s3, 10
    s_cselect_b32 s3, 0, s3
    s_cmp_eq_u32 s49, 1
    s_cbranch_scc1 K1_G1
    s_lshr_b32 s56, s2, 1
    s_lshl_b32 s56, s56, 5
    s_lshl_b32 s57, s48, 2
    s_add_u32 s56, s56, s57
    s_mul_i32 s56, s56, 1280
    s_and_b32 s58, s2, 1
    s_mul_i32 s58, s58, 640
    s_add_u32 s56, s56, s58
    s_mul_i32 s57, s48, 2560
    s_mov_b32 exec_hi, 0xff
    s_mov_b32 m0, s57
    s_nop 0
    buffer_load_dwordx4 v7, s[20:23], s56 offen lds
    s_add_u32 s56, s56, 1280
    s_add_u32 s57, s57, 640
    s_mov_b32 m0, s57
    s_nop 0
    buffer_load_dwordx4 v7, s[20:23], s56 offen lds
    s_add_u32 s56, s56, 1280
    s_add_u32 s57, s57, 640
    s_mov_b32 m0, s57
    s_nop 0
    buffer_load_dwordx4 v7, s[20:23], s56 offen lds
    s_add_u32 s56, s56, 1280
    s_add_u32 s57, s57, 640
    s_mov_b32 m0, s57
    s_nop 0
    buffer_load_dwordx4 v7, s[20:23], s56 offen lds
    s_add_u32 s56, s56, 1280
    s_add_u32 s57, s57, 640
    s_mov_b32 exec_hi, -1
    s_waitcnt vmcnt(15)
    s_waitcnt vmcnt(13)
    s_barrier
    ds_read_b128 v[48:51], v18 offset:0
    ds_read_b128 v[52:55], v18 offset:2048
    ds_read_b128 v[56:59], v18 offset:4096
    ds_read_b64_tr_b16 v[32:33], v28 offset:0
    ds_read_b64_tr_b16 v[34:35], v28 offset:2048
    ds_read_b64_tr_b16 v[36:37], v29 offset:0
    ds_read_b64_tr_b16 v[38:39], v29 offset:2048
    ds_read_b64_tr_b16 v[40:41], v30 offset:0
    ds_read_b64_tr_b16 v[42:43], v30 offset:2048
    ds_read_b64_tr_b16 v[44:45], v60 offset:0
    ds_read_b64_tr_b16 v[46:47], v60 offset:2048
    s_waitcnt vmcnt(11)
    s_waitcnt lgkmcnt(0)
    s_barrier
    v_mfma_f32_16x16x32_bf16 v[64:67], v[32:35], v[48:51], 0
    ds_read_b128 v[128:131], v19 offset:0
    v_mfma_f32_16x16x32_bf16 v[68:71], v[32:35], v[52:55], 0
    ds_read_b128 v[132:135], v19 offset:2048
    s_mov_b32 m0, s62
    s_lshl_b32 s65, s3, 19
    buffer_load_dwordx4 v24, s[16:19], s65 offen lds
    buffer_load_dwordx4 v25, s[16:19], s65 offen offset:1024 lds
    v_mfma_f32_16x16x32_bf16 v[72:75], v[32:35], v[56:59], 0
    ds_read_b128 v[136:139], v19 offset:4096
    v_mfma_f32_16x16x32_bf16 v[76:79], v[36:39], v[48:51], 0
    ds_read_b64_tr_b16 v[112:113], v28 offset:16384
    ds_read_b64_tr_b16 v[114:115], v28 offset:18432
    v_mfma_f32_16x16x32_bf16 v[80:83], v[36:39], v[52:55], 0
    ds_read_b64_tr_b16 v[116:117], v29 offset:16384
    ds_read_b64_tr_b16 v[118:119], v29 offset:18432
    v_mfma_f32_16x16x32_bf16 v[84:87], v[36:39], v[56:59], 0
    ds_read_b64_tr_b16 v[120:121], v30 offset:16384
    ds_read_b64_tr_b16 v[122:123], v30 offset:18432
    v_mfma_f32_16x16x32_bf16 v[88:91], v[40:43], v[48:51], 0
    ds_read_b64_tr_b16 v[124:125], v60 offset:16384
    ds_read_b64_tr_b16 v[126:127], v60 offset:18432
    v_mfma_f32_16x16x32_bf16 v[92:95], v[40:43], v[52:55], 0
    v_mfma_f32_16x16x32_bf16 v[96:99], v[40:43], v[56:59], 0
    v_mfma_f32_16x16x32_bf16 v[100:103], v[44:47], v[48:51], 0
    v_mfma_f32_16x16x32_bf16 v[104:107], v[44:47], v[52:55], 0
    v_mfma_f32_16x16x32_bf16 v[108:111], v[44:47], v[56:59], 0
    s_waitcnt vmcnt(10)
    s_waitcnt vmcnt(8)
    s_waitcnt lgkmcnt(0)
    s_barrier
    v_mfma_f32_16x16x32_bf16 v[64:67], v[112:115], v[128:131], v[64:67]
    ds_read_b128 v[48:51], v18 offset:12288
    v_mfma_f32_16x16x32_bf16 v[68:71], v[112:115], v[132:135], v[68:71]
    ds_read_b128 v[52:55], v18 offset:14336
    s_mov_b32 m0, s63
    s_lshl_b32 s66, s47, 7
    buffer_load_dwordx4 v26, s[4:7], s66 offen lds
    s_mov_b32 exec_hi, 0
    buffer_load_dwordx4 v27, s[4:7], s66 offen offset:1024 lds
    s_mov_b32 exec_hi, -1
    s_add_u32 s47, s47, 1
    s_cmp_eq_u32 s47, 10
    s_cselect_b32 s47, 0, s47
    v_mfma_f32_16x16x32_bf16 v[72:75], v[112:115], v[136:139], v[72:75]
    ds_read_b128 v[56:59], v18 offset:16384
    v_mfma_f32_16x16x32_bf16 v[76:79], v[116:119], v[128:131], v[76:79]
    v_xor_b32 v28, 0x10000, v28
    ds_read_b64_tr_b16 v[32:33], v28 offset:0
    ds_read_b64_tr_b16 v[34:35], v28 offset:2048
    v_mfma_f32_16x16x32_bf16 v[80:83], v[116:119], v[132:135], v[80:83]
    v_xor_b32 v29, 0x10000, v29
    ds_read_b64_tr_b16 v[36:37], v29 offset:0
    ds_read_b64_tr_b16 v[38:39], v29 offset:2048
    s_add_u32 m0, s62, 16384
    s_add_u32 s65, s65, 262144
    buffer_load_dwordx4 v24, s[16:19], s65 offen lds
    buffer_load_dwordx4 v25, s[16:19], s65 offen offset:1024 lds
    s_add_u32 s3, s3, 1
    s_cmp_eq_u32 s3, 10
    s_cselect_b32 s3, 0, s3
    v_mfma_f32_16x16x32_bf16 v[84:87], v[116:119], v[136:139], v[84:87]
    v_xor_b32 v30, 0x10000, v30
    ds_read_b64_tr_b16 v[40:41], v30 offset:0
    ds_read_b64_tr_b16 v[42:43], v30 offset:2048
    v_mfma_f32_16x16x32_bf16 v[88:91], v[120:123], v[128:131], v[88:91]
    v_xor_b32 v60, 0x10000, v60
    ds_read_b64_tr_b16 v[44:45], v60 offset:0
    ds_read_b64_tr_b16 v[46:47], v60 offset:2048
    v_mfma_f32_16x16x32_bf16 v[92:95], v[120:123], v[132:135], v[92:95]
    v_mfma_f32_16x16x32_bf16 v[96:99], v[120:123], v[136:139], v[96:99]
    v_mfma_f32_16x16x32_bf16 v[100:103], v[124:127], v[128:131], v[100:103]
    v_mfma_f32_16x16x32_bf16 v[104:107], v[124:127], v[132:135], v[104:107]
    v_mfma_f32_16x16x32_bf16 v[108:111], v[124:127], v[136:139], v[108:111]
    s_waitcnt vmcnt(10)
    s_waitcnt lgkmcnt(0)
    s_barrier
    v_mfma_f32_16x16x32_bf16 v[64:67], v[32:35], v[48:51], v[64:67]
    ds_read_b128 v[128:131], v19 offset:12288
    v_mfma_f32_16x16x32_bf16 v[68:71], v[32:35], v[52:55], v[68:71]
    ds_read_b128 v[132:135], v19 offset:14336
    s_add_u32 m0, s62, 65536
    s_lshl_b32 s65, s3, 19
    buffer_load_dwordx4 v24, s[16:19], s65 offen lds
    buffer_load_dwordx4 v25, s[16:19], s65 offen offset:1024 lds
    v_mfma_f32_16x16x32_bf16 v[72:75], v[32:35], v[56:59], v[72:75]
    ds_read_b128 v[136:139], v19 offset:16384
    v_mfma_f32_16x16x32_bf16 v[76:79], v[36:39], v[48:51], v[76:79]
    ds_read_b64_tr_b16 v[112:113], v28 offset:16384
    ds_read_b64_tr_b16 v[114:115], v28 offset:18432
    v_mfma_f32_16x16x32_bf16 v[80:83], v[36:39], v[52:55], v[80:83]
    ds_read_b64_tr_b16 v[116:117], v29 offset:16384
    ds_read_b64_tr_b16 v[118:119], v29 offset:18432
    v_mfma_f32_16x16x32_bf16 v[84:87], v[36:39], v[56:59], v[84:87]
    ds_read_b64_tr_b16 v[120:121], v30 offset:16384
    ds_read_b64_tr_b16 v[122:123], v30 offset:18432
    v_mfma_f32_16x16x32_bf16 v[88:91], v[40:43], v[48:51], v[88:91]
    ds_read_b64_tr_b16 v[124:125], v60 offset:16384
    ds_read_b64_tr_b16 v[126:127], v60 offset:18432
    v_mfma_f32_16x16x32_bf16 v[92:95], v[40:43], v[52:55], v[92:95]
    v_mfma_f32_16x16x32_bf16 v[96:99], v[40:43], v[56:59], v[96:99]
    v_mfma_f32_16x16x32_bf16 v[100:103], v[44:47], v[48:51], v[100:103]
    v_mfma_f32_16x16x32_bf16 v[104:107], v[44:47], v[52:55], v[104:107]
    v_mfma_f32_16x16x32_bf16 v[108:111], v[44:47], v[56:59], v[108:111]
    s_waitcnt vmcnt(4)
    s_waitcnt lgkmcnt(0)
    s_barrier
    v_mfma_f32_16x16x32_bf16 v[64:67], v[112:115], v[128:131], v[64:67]
    ds_read_b128 v[48:51], v18 offset:0
    v_mfma_f32_16x16x32_bf16 v[68:71], v[112:115], v[132:135], v[68:71]
    ds_read_b128 v[52:55], v18 offset:2048
    v_mov_b32 v61, 0
    buffer_load_dwordx2 v[62:63], v61, s[36:39], 0 offen sc1
    v_mfma_f32_16x16x32_bf16 v[72:75], v[112:115], v[136:139], v[72:75]
    ds_read_b128 v[56:59], v18 offset:4096
    v_mfma_f32_16x16x32_bf16 v[76:79], v[116:119], v[128:131], v[76:79]
    v_xor_b32 v28, 0x10000, v28
    ds_read_b64_tr_b16 v[32:33], v28 offset:0
    ds_read_b64_tr_b16 v[34:35], v28 offset:2048
    v_mfma_f32_16x16x32_bf16 v[80:83], v[116:119], v[132:135], v[80:83]
    v_xor_b32 v29, 0x10000, v29
    ds_read_b64_tr_b16 v[36:37], v29 offset:0
    ds_read_b64_tr_b16 v[38:39], v29 offset:2048
    s_add_u32 m0, s63, 12288
    s_lshl_b32 s66, s47, 7
    buffer_load_dwordx4 v26, s[4:7], s66 offen lds
    s_mov_b32 exec_hi, 0
    buffer_load_dwordx4 v27, s[4:7], s66 offen offset:1024 lds
    s_mov_b32 exec_hi, -1
    s_add_u32 s47, s47, 1
    s_cmp_eq_u32 s47, 10
    s_cselect_b32 s47, 0, s47
    v_mfma_f32_16x16x32_bf16 v[84:87], v[116:119], v[136:139], v[84:87]
    v_xor_b32 v30, 0x10000, v30
    ds_read_b64_tr_b16 v[40:41], v30 offset:0
    ds_read_b64_tr_b16 v[42:43], v30 offset:2048
    v_mfma_f32_16x16x32_bf16 v[88:91], v[120:123], v[128:131], v[88:91]
    v_xor_b32 v60, 0x10000, v60
    ds_read_b64_tr_b16 v[44:45], v60 offset:0
    ds_read_b64_tr_b16 v[46:47], v60 offset:2048
    v_mfma_f32_16x16x32_bf16 v[92:95], v[120:123], v[132:135], v[92:95]
    v_bfe_u32 v1, v0, 2, 2
    v_lshl_add_u32 v1, v5, 2, v1
    v_mul_u32_u24 v1, 640, v1
    v_and_b32 v2, 3, v0
    v_lshl_add_u32 v1, v2, 3, v1
    s_lshl_b32 s56, s48, 5
    v_add_u32 v1, s56, v1
    ds_read_b64_tr_b16 v[144:145], v1 offset:0
    ds_read_b64_tr_b16 v[146:147], v1 offset:10240
    ds_read_b64_tr_b16 v[148:149], v1 offset:256
    ds_read_b64_tr_b16 v[150:151], v1 offset:10496
    ds_read_b64_tr_b16 v[152:153], v1 offset:512
    ds_read_b64_tr_b16 v[154:155], v1 offset:10752
    s_add_u32 m0, s62, 81920
    s_add_u32 s65, s65, 262144
    buffer_load_dwordx4 v24, s[16:19], s65 offen lds
    buffer_load_dwordx4 v25, s[16:19], s65 offen offset:1024 lds
    s_add_u32 s3, s3, 1
    s_cmp_eq_u32 s3, 10
    s_cselect_b32 s3, 0, s3
    v_mfma_f32_16x16x32_bf16 v[96:99], v[120:123], v[136:139], v[96:99]
    v_mfma_f32_16x16x32_bf16 v[100:103], v[124:127], v[128:131], v[100:103]
    v_mfma_f32_16x16x32_bf16 v[104:107], v[124:127], v[132:135], v[104:107]
    v_mfma_f32_16x16x32_bf16 v[108:111], v[124:127], v[136:139], v[108:111]
    s_waitcnt vmcnt(7)
    s_waitcnt lgkmcnt(0)
    s_barrier
    v_mfma_f32_16x16x32_bf16 v[64:67], v[32:35], v[48:51], v[64:67]
    ds_read_b128 v[128:131], v19 offset:0
    v_mfma_f32_16x16x32_bf16 v[68:71], v[32:35], v[52:55], v[68:71]
    ds_read_b128 v[132:135], v19 offset:2048
    s_mov_b32 m0, s62
    s_lshl_b32 s65, s3, 19
    buffer_load_dwordx4 v24, s[16:19], s65 offen lds
    buffer_load_dwordx4 v25, s[16:19], s65 offen offset:1024 lds
    v_mfma_f32_16x16x32_bf16 v[72:75], v[32:35], v[56:59], v[72:75]
    ds_read_b128 v[136:139], v19 offset:4096
    v_mfma_f32_16x16x32_bf16 v[76:79], v[36:39], v[48:51], v[76:79]
    ds_read_b64_tr_b16 v[112:113], v28 offset:16384
    ds_read_b64_tr_b16 v[114:115], v28 offset:18432
    v_mfma_f32_16x16x32_bf16 v[80:83], v[36:39], v[52:55], v[80:83]
    ds_read_b64_tr_b16 v[116:117], v29 offset:16384
    ds_read_b64_tr_b16 v[118:119], v29 offset:18432
    s_mul_i32 s56, s2, 20
    s_add_u32 s56, s56, s48
    s_lshl_b32 s56, s56, 10
    s_add_u32 s56, s56, 16777216
    buffer_store_dwordx4 v[144:147], v7, s[24:27], s56 offen sc1
    s_add_u32 s56, s56, 8192
    buffer_store_dwordx4 v[148:151], v7, s[24:27], s56 offen sc1
    s_add_u32 s56, s56, 8192
    buffer_store_dwordx4 v[152:155], v7, s[24:27], s56 offen sc1
    v_mfma_f32_16x16x32_bf16 v[84:87], v[36:39], v[56:59], v[84:87]
    ds_read_b64_tr_b16 v[120:121], v30 offset:16384
    ds_read_b64_tr_b16 v[122:123], v30 offset:18432
    v_mfma_f32_16x16x32_bf16 v[88:91], v[40:43], v[48:51], v[88:91]
    ds_read_b64_tr_b16 v[124:125], v60 offset:16384
    ds_read_b64_tr_b16 v[126:127], v60 offset:18432
    v_mfma_f32_16x16x32_bf16 v[92:95], v[40:43], v[52:55], v[92:95]
    v_mfma_f32_16x16x32_bf16 v[96:99], v[40:43], v[56:59], v[96:99]
    v_mfma_f32_16x16x32_bf16 v[100:103], v[44:47], v[48:51], v[100:103]
    v_mfma_f32_16x16x32_bf16 v[104:107], v[44:47], v[52:55], v[104:107]
    v_mfma_f32_16x16x32_bf16 v[108:111], v[44:47], v[56:59], v[108:111]
    s_waitcnt vmcnt(7)
    s_waitcnt lgkmcnt(0)
    s_barrier
    v_mfma_f32_16x16x32_bf16 v[64:67], v[112:115], v[128:131], v[64:67]
    ds_read_b128 v[48:51], v18 offset:12288
    v_mfma_f32_16x16x32_bf16 v[68:71], v[112:115], v[132:135], v[68:71]
    ds_read_b128 v[52:55], v18 offset:14336
    s_mov_b32 m0, s63
    s_lshl_b32 s66, s47, 7
    buffer_load_dwordx4 v26, s[4:7], s66 offen lds
    s_mov_b32 exec_hi, 0
    buffer_load_dwordx4 v27, s[4:7], s66 offen offset:1024 lds
    s_mov_b32 exec_hi, -1
    s_add_u32 s47, s47, 1
    s_cmp_eq_u32 s47, 10
    s_cselect_b32 s47, 0, s47
    v_mfma_f32_16x16x32_bf16 v[72:75], v[112:115], v[136:139], v[72:75]
    ds_read_b128 v[56:59], v18 offset:16384
    v_mfma_f32_16x16x32_bf16 v[76:79], v[116:119], v[128:131], v[76:79]
    v_xor_b32 v28, 0x10000, v28
    ds_read_b64_tr_b16 v[32:33], v28 offset:0
    ds_read_b64_tr_b16 v[34:35], v28 offset:2048
    v_mfma_f32_16x16x32_bf16 v[80:83], v[116:119], v[132:135], v[80:83]
    v_xor_b32 v29, 0x10000, v29
    ds_read_b64_tr_b16 v[36:37], v29 offset:0
    ds_read_b64_tr_b16 v[38:39], v29 offset:2048
    s_add_u32 m0, s62, 16384
    s_add_u32 s65, s65, 262144
    buffer_load_dwordx4 v24, s[16:19], s65 offen lds
    buffer_load_dwordx4 v25, s[16:19], s65 offen offset:1024 lds
    s_add_u32 s3, s3, 1
    s_cmp_eq_u32 s3, 10
    s_cselect_b32 s3, 0, s3
    v_mfma_f32_16x16x32_bf16 v[84:87], v[116:119], v[136:139], v[84:87]
    v_xor_b32 v30, 0x10000, v30
    ds_read_b64_tr_b16 v[40:41], v30 offset:0
    ds_read_b64_tr_b16 v[42:43], v30 offset:2048
    v_mfma_f32_16x16x32_bf16 v[88:91], v[120:123], v[128:131], v[88:91]
    v_xor_b32 v60, 0x10000, v60
    ds_read_b64_tr_b16 v[44:45], v60 offset:0
    ds_read_b64_tr_b16 v[46:47], v60 offset:2048
    v_mfma_f32_16x16x32_bf16 v[92:95], v[120:123], v[132:135], v[92:95]
    v_mfma_f32_16x16x32_bf16 v[96:99], v[120:123], v[136:139], v[96:99]
    v_mfma_f32_16x16x32_bf16 v[100:103], v[124:127], v[128:131], v[100:103]
    v_mfma_f32_16x16x32_bf16 v[104:107], v[124:127], v[132:135], v[104:107]
    v_mfma_f32_16x16x32_bf16 v[108:111], v[124:127], v[136:139], v[108:111]
    s_waitcnt vmcnt(9)
    s_mov_b32 s57, 0
K1_N_0_CMP:
    v_readfirstlane_b32 s30, v62
    v_readfirstlane_b32 s31, v63
    s_add_u32 s57, s57, 1
    s_cmp_lg_u32 s31, 0
    s_cbranch_scc1 K1_N_0_OK
    s_cmp_ge_u32 s57, 0x40000
    s_cbranch_scc1 K1_N_0_OK
    s_sleep 4
    buffer_load_dwordx2 v[62:63], v61, s[36:39], 0 offen sc1
    s_waitcnt vmcnt(0)
    s_branch K1_N_0_CMP
K1_N_0_OK:
    s_nop 3
    s_waitcnt lgkmcnt(0)
    s_barrier
    v_mfma_f32_16x16x32_bf16 v[64:67], v[32:35], v[48:51], v[64:67]
    ds_read_b128 v[128:131], v19 offset:12288
    v_mfma_f32_16x16x32_bf16 v[68:71], v[32:35], v[52:55], v[68:71]
    ds_read_b128 v[132:135], v19 offset:14336
    s_add_u32 m0, s62, 65536
    s_lshl_b32 s65, s3, 19
    buffer_load_dwordx4 v24, s[16:19], s65 offen lds
    buffer_load_dwordx4 v25, s[16:19], s65 offen offset:1024 lds
    v_mfma_f32_16x16x32_bf16 v[72:75], v[32:35], v[56:59], v[72:75]
    ds_read_b128 v[136:139], v19 offset:16384
    v_mfma_f32_16x16x32_bf16 v[76:79], v[36:39], v[48:51], v[76:79]
    ds_read_b64_tr_b16 v[112:113], v28 offset:16384
    ds_read_b64_tr_b16 v[114:115], v28 offset:18432
    v_mfma_f32_16x16x32_bf16 v[80:83], v[36:39], v[52:55], v[80:83]
    ds_read_b64_tr_b16 v[116:117], v29 offset:16384
    ds_read_b64_tr_b16 v[118:119], v29 offset:18432
    v_mfma_f32_16x16x32_bf16 v[84:87], v[36:39], v[56:59], v[84:87]
    ds_read_b64_tr_b16 v[120:121], v30 offset:16384
    ds_read_b64_tr_b16 v[122:123], v30 offset:18432
    v_mfma_f32_16x16x32_bf16 v[88:91], v[40:43], v[48:51], v[88:91]
    ds_read_b64_tr_b16 v[124:125], v60 offset:16384
    ds_read_b64_tr_b16 v[126:127], v60 offset:18432
    v_mfma_f32_16x16x32_bf16 v[92:95], v[40:43], v[52:55], v[92:95]
    v_mfma_f32_16x16x32_bf16 v[96:99], v[40:43], v[56:59], v[96:99]
    v_mfma_f32_16x16x32_bf16 v[100:103], v[44:47], v[48:51], v[100:103]
    v_mfma_f32_16x16x32_bf16 v[104:107], v[44:47], v[52:55], v[104:107]
    v_mfma_f32_16x16x32_bf16 v[108:111], v[44:47], v[56:59], v[108:111]
    s_waitcnt vmcnt(4)
    s_waitcnt lgkmcnt(0)
    s_barrier
    v_mfma_f32_16x16x32_bf16 v[64:67], v[112:115], v[128:131], v[64:67]
    ds_read_b128 v[48:51], v18 offset:0
    v_mfma_f32_16x16x32_bf16 v[68:71], v[112:115], v[132:135], v[68:71]
    ds_read_b128 v[52:55], v18 offset:2048
    s_add_u32 m0, s63, 12288
    s_lshl_b32 s66, s47, 7
    buffer_load_dwordx4 v26, s[4:7], s66 offen lds
    s_mov_b32 exec_hi, 0
    buffer_load_dwordx4 v27, s[4:7], s66 offen offset:1024 lds
    s_mov_b32 exec_hi, -1
    s_add_u32 s47, s47, 1
    s_cmp_eq_u32 s47, 10
    s_cselect_b32 s47, 0, s47
    v_mfma_f32_16x16x32_bf16 v[72:75], v[112:115], v[136:139], v[72:75]
    ds_read_b128 v[56:59], v18 offset:4096
    v_mfma_f32_16x16x32_bf16 v[76:79], v[116:119], v[128:131], v[76:79]
    v_xor_b32 v28, 0x10000, v28
    ds_read_b64_tr_b16 v[32:33], v28 offset:0
    ds_read_b64_tr_b16 v[34:35], v28 offset:2048
    v_mfma_f32_16x16x32_bf16 v[80:83], v[116:119], v[132:135], v[80:83]
    v_xor_b32 v29, 0x10000, v29
    ds_read_b64_tr_b16 v[36:37], v29 offset:0
    ds_read_b64_tr_b16 v[38:39], v29 offset:2048
    s_add_u32 m0, s62, 81920
    s_add_u32 s65, s65, 262144
    buffer_load_dwordx4 v24, s[16:19], s65 offen lds
    buffer_load_dwordx4 v25, s[16:19], s65 offen offset:1024 lds
    s_add_u32 s3, s3, 1
    s_cmp_eq_u32 s3, 10
    s_cselect_b32 s3, 0, s3
    v_mfma_f32_16x16x32_bf16 v[84:87], v[116:119], v[136:139], v[84:87]
    v_xor_b32 v30, 0x10000, v30
    ds_read_b64_tr_b16 v[40:41], v30 offset:0
    ds_read_b64_tr_b16 v[42:43], v30 offset:2048
    v_mfma_f32_16x16x32_bf16 v[88:91], v[120:123], v[128:131], v[88:91]
    v_xor_b32 v60, 0x10000, v60
    ds_read_b64_tr_b16 v[44:45], v60 offset:0
    ds_read_b64_tr_b16 v[46:47], v60 offset:2048
    v_mfma_f32_16x16x32_bf16 v[92:95], v[120:123], v[132:135], v[92:95]
    s_lshl_b32 s58, s2, 6
    s_add_u32 s58, s58, 26214400
    s_cmp_eq_u32 s48, 0
    s_cselect_b32 s58, s58, 0x7f000000
    v_mov_b32 v2, s30
    v_mov_b32 v3, s31
    v_mov_b32 v1, 0
    s_mov_b64 exec, 1
    buffer_store_dwordx2 v[2:3], v1, s[24:27], s58 offen sc1
    s_mov_b64 exec, -1
    s_nop 1
    v_mfma_f32_16x16x32_bf16 v[96:99], v[120:123], v[136:139], v[96:99]
    v_mfma_f32_16x16x32_bf16 v[100:103], v[124:127], v[128:131], v[100:103]
    v_mfma_f32_16x16x32_bf16 v[104:107], v[124:127], v[132:135], v[104:107]
    s_mov_b32 m0, s61
    s_mov_b32 s64, s55
    buffer_load_dwordx4 v8, s[8:11], s64 offen offset:0 nt lds
    v_mfma_f32_16x16x32_bf16 v[108:111], v[124:127], v[136:139], v[108:111]
    s_mov_b32 m0, s61
    s_mov_b32 s64, s55
    buffer_load_dwordx4 v9, s[8:11], s64 offen offset:1024 nt lds
    s_mov_b32 m0, s61
    s_mov_b32 s64, s55
    buffer_load_dwordx4 v10, s[8:11], s64 offen offset:2048 nt lds
    s_mov_b32 m0, s61
    s_mov_b32 s64, s55
    buffer_load_dwordx4 v11, s[8:11], s64 offen offset:3072 nt lds
    s_waitcnt vmcnt(11)
    s_waitcnt lgkmcnt(0)
    s_barrier
    v_mfma_f32_16x16x32_bf16 v[64:67], v[32:35], v[48:51], v[64:67]
    ds_read_b128 v[128:131], v19 offset:0
    v_mfma_f32_16x16x32_bf16 v[68:71], v[32:35], v[52:55], v[68:71]
    ds_read_b128 v[132:135], v19 offset:2048
    s_mov_b32 m0, s62
    s_lshl_b32 s65, s3, 19
    buffer_load_dwordx4 v24, s[16:19], s65 offen lds
    buffer_load_dwordx4 v25, s[16:19], s65 offen offset:1024 lds
    v_mfma_f32_16x16x32_bf16 v[72:75], v[32:35], v[56:59], v[72:75]
    ds_read_b128 v[136:139], v19 offset:4096
    v_mfma_f32_16x16x32_bf16 v[76:79], v[36:39], v[48:51], v[76:79]
    ds_read_b64_tr_b16 v[112:113], v28 offset:16384
    ds_read_b64_tr_b16 v[114:115], v28 offset:18432
    v_mfma_f32_16x16x32_bf16 v[80:83], v[36:39], v[52:55], v[80:83]
    ds_read_b64_tr_b16 v[116:117], v29 offset:16384
    ds_read_b64_tr_b16 v[118:119], v29 offset:18432
    v_mfma_f32_16x16x32_bf16 v[84:87], v[36:39], v[56:59], v[84:87]
    ds_read_b64_tr_b16 v[120:121], v30 offset:16384
    ds_read_b64_tr_b16 v[122:123], v30 offset:18432
    v_mfma_f32_16x16x32_bf16 v[88:91], v[40:43], v[48:51], v[88:91]
    ds_read_b64_tr_b16 v[124:125], v60 offset:16384
    ds_read_b64_tr_b16 v[126:127], v60 offset:18432
    v_mfma_f32_16x16x32_bf16 v[92:95], v[40:43], v[52:55], v[92:95]
    v_mfma_f32_16x16x32_bf16 v[96:99], v[40:43], v[56:59], v[96:99]
    v_mfma_f32_16x16x32_bf16 v[100:103], v[44:47], v[48:51], v[100:103]
    v_mfma_f32_16x16x32_bf16 v[104:107], v[44:47], v[52:55], v[104:107]
    v_mfma_f32_16x16x32_bf16 v[108:111], v[44:47], v[56:59], v[108:111]
    s_waitcnt vmcnt(9)
    s_waitcnt lgkmcnt(0)
    s_barrier
    v_mfma_f32_16x16x32_bf16 v[64:67], v[112:115], v[128:131], v[64:67]
    ds_read_b128 v[48:51], v18 offset:12288
    v_mfma_f32_16x16x32_bf16 v[68:71], v[112:115], v[132:135], v[68:71]
    ds_read_b128 v[52:55], v18 offset:14336
    s_mov_b32 m0, s63
    s_lshl_b32 s66, s47, 7
    buffer_load_dwordx4 v26, s[4:7], s66 offen lds
    s_mov_b32 exec_hi, 0
    buffer_load_dwordx4 v27, s[4:7], s66 offen offset:1024 lds
    s_mov_b32 exec_hi, -1
    s_add_u32 s47, s47, 1
    s_cmp_eq_u32 s47, 10
    s_cselect_b32 s47, 0, s47
    v_mfma_f32_16x16x32_bf16 v[72:75], v[112:115], v[136:139], v[72:75]
    ds_read_b128 v[56:59], v18 offset:16384
    v_mfma_f32_16x16x32_bf16 v[76:79], v[116:119], v[128:131], v[76:79]
    v_xor_b32 v28, 0x10000, v28
    ds_read_b64_tr_b16 v[32:33], v28 offset:0
    ds_read_b64_tr_b16 v[34:35], v28 offset:2048
    v_mfma_f32_16x16x32_bf16 v[80:83], v[116:119], v[132:135], v[80:83]
    v_xor_b32 v29, 0x10000, v29
    ds_read_b64_tr_b16 v[36:37], v29 offset:0
    ds_read_b64_tr_b16 v[38:39], v29 offset:2048
    s_add_u32 m0, s62, 16384
    s_add_u32 s65, s65, 262144
    buffer_load_dwordx4 v24, s[16:19], s65 offen lds
    buffer_load_dwordx4 v25, s[16:19], s65 offen offset:1024 lds
    s_add_u32 s3, s3, 1
    s_cmp_eq_u32 s3, 10
    s_cselect_b32 s3, 0, s3
    v_mfma_f32_16x16x32_bf16 v[84:87], v[116:119], v[136:139], v[84:87]
    v_xor_b32 v30, 0x10000, v30
    ds_read_b64_tr_b16 v[40:41], v30 offset:0
    ds_read_b64_tr_b16 v[42:43], v30 offset:2048
    v_mfma_f32_16x16x32_bf16 v[88:91], v[120:123], v[128:131], v[88:91]
    v_xor_b32 v60, 0x10000, v60
    ds_read_b64_tr_b16 v[44:45], v60 offset:0
    ds_read_b64_tr_b16 v[46:47], v60 offset:2048
    v_mfma_f32_16x16x32_bf16 v[92:95], v[120:123], v[132:135], v[92:95]
    v_mfma_f32_16x16x32_bf16 v[96:99], v[120:123], v[136:139], v[96:99]
    v_mfma_f32_16x16x32_bf16 v[100:103], v[124:127], v[128:131], v[100:103]
    v_mfma_f32_16x16x32_bf16 v[104:107], v[124:127], v[132:135], v[104:107]
    v_mfma_f32_16x16x32_bf16 v[108:111], v[124:127], v[136:139], v[108:111]
    s_waitcnt vmcnt(11)
    s_waitcnt lgkmcnt(0)
    s_barrier
    v_mfma_f32_16x16x32_bf16 v[64:67], v[32:35], v[48:51], v[64:67]
    ds_read_b128 v[128:131], v19 offset:12288
    v_mfma_f32_16x16x32_bf16 v[68:71], v[32:35], v[52:55], v[68:71]
    ds_read_b128 v[132:135], v19 offset:14336
    s_add_u32 m0, s62, 65536
    s_lshl_b32 s65, s3, 19
    buffer_load_dwordx4 v24, s[16:19], s65 offen lds
    buffer_load_dwordx4 v25, s[16:19], s65 offen offset:1024 lds
    v_mfma_f32_16x16x32_bf16 v[72:75], v[32:35], v[56:59], v[72:75]
    ds_read_b128 v[136:139], v19 offset:16384
    v_mfma_f32_16x16x32_bf16 v[76:79], v[36:39], v[48:51], v[76:79]
    ds_read_b64_tr_b16 v[112:113], v28 offset:16384
    ds_read_b64_tr_b16 v[114:115], v28 offset:18432
    v_mfma_f32_16x16x32_bf16 v[80:83], v[36:39], v[52:55], v[80:83]
    ds_read_b64_tr_b16 v[116:117], v29 offset:16384
    ds_read_b64_tr_b16 v[118:119], v29 offset:18432
    s_add_u32 m0, s61, 16384
    s_xor_b32 s64, s55, 16384
    buffer_load_dwordx4 v8, s[8:11], s64 offen offset:0 nt lds
    v_mfma_f32_16x16x32_bf16 v[84:87], v[36:39], v[56:59], v[84:87]
    ds_read_b64_tr_b16 v[120:121], v30 offset:16384
    ds_read_b64_tr_b16 v[122:123], v30 offset:18432
    v_mfma_f32_16x16x32_bf16 v[88:91], v[40:43], v[48:51], v[88:91]
    ds_read_b64_tr_b16 v[124:125], v60 offset:16384
    ds_read_b64_tr_b16 v[126:127], v60 offset:18432
    v_mfma_f32_16x16x32_bf16 v[92:95], v[40:43], v[52:55], v[92:95]
    s_add_u32 m0, s61, 16384
    s_xor_b32 s64, s55, 16384
    buffer_load_dwordx4 v9, s[8:11], s64 offen offset:1024 nt lds
    v_mfma_f32_16x16x32_bf16 v[96:99], v[40:43], v[56:59], v[96:99]
    v_mfma_f32_16x16x32_bf16 v[100:103], v[44:47], v[48:51], v[100:103]
    v_mfma_f32_16x16x32_bf16 v[104:107], v[44:47], v[52:55], v[104:107]
    s_add_u32 m0, s61, 16384
    s_xor_b32 s64, s55, 16384
    buffer_load_dwordx4 v10, s[8:11], s64 offen offset:2048 nt lds
    v_mfma_f32_16x16x32_bf16 v[108:111], v[44:47], v[56:59], v[108:111]
    s_add_u32 m0, s61, 16384
    s_xor_b32 s64, s55, 16384
    buffer_load_dwordx4 v11, s[8:11], s64 offen offset:3072 nt lds
    s_waitcnt vmcnt(8)
    s_waitcnt lgkmcnt(0)
    s_barrier
    v_mfma_f32_16x16x32_bf16 v[64:67], v[112:115], v[128:131], v[64:67]
    ds_read_b128 v[48:51], v18 offset:0
    v_mfma_f32_16x16x32_bf16 v[68:71], v[112:115], v[132:135], v[68:71]
    ds_read_b128 v[52:55], v18 offset:2048
    s_add_u32 m0, s63, 12288
    s_lshl_b32 s66, s47, 7
    buffer_load_dwordx4 v26, s[4:7], s66 offen lds
    s_mov_b32 exec_hi, 0
    buffer_load_dwordx4 v27, s[4:7], s66 offen offset:1024 lds
    s_mov_b32 exec_hi, -1
    s_add_u32 s47, s47, 1
    s_cmp_eq_u32 s47, 10
    s_cselect_b32 s47, 0, s47
    v_mfma_f32_16x16x32_bf16 v[72:75], v[112:115], v[136:139], v[72:75]
    ds_read_b128 v[56:59], v18 offset:4096
    v_mfma_f32_16x16x32_bf16 v[76:79], v[116:119], v[128:131], v[76:79]
    v_xor_b32 v28, 0x10000, v28
    ds_read_b64_tr_b16 v[32:33], v28 offset:0
    ds_read_b64_tr_b16 v[34:35], v28 offset:2048
    v_mfma_f32_16x16x32_bf16 v[80:83], v[116:119], v[132:135], v[80:83]
    v_xor_b32 v29, 0x10000, v29
    ds_read_b64_tr_b16 v[36:37], v29 offset:0
    ds_read_b64_tr_b16 v[38:39], v29 offset:2048
    s_add_u32 m0, s62, 81920
    s_add_u32 s65, s65, 262144
    buffer_load_dwordx4 v24, s[16:19], s65 offen lds
    buffer_load_dwordx4 v25, s[16:19], s65 offen offset:1024 lds
    s_add_u32 s3, s3, 1
    s_cmp_eq_u32 s3, 10
    s_cselect_b32 s3, 0, s3
    v_mfma_f32_16x16x32_bf16 v[84:87], v[116:119], v[136:139], v[84:87]
    v_xor_b32 v30, 0x10000, v30
    ds_read_b64_tr_b16 v[40:41], v30 offset:0
    ds_read_b64_tr_b16 v[42:43], v30 offset:2048
    v_mfma_f32_16x16x32_bf16 v[88:91], v[120:123], v[128:131], v[88:91]
    v_xor_b32 v60, 0x10000, v60
    ds_read_b64_tr_b16 v[44:45], v60 offset:0
    ds_read_b64_tr_b16 v[46:47], v60 offset:2048
    v_mfma_f32_16x16x32_bf16 v[92:95], v[120:123], v[132:135], v[92:95]
    v_mfma_f32_16x16x32_bf16 v[96:99], v[120:123], v[136:139], v[96:99]
    v_mfma_f32_16x16x32_bf16 v[100:103], v[124:127], v[128:131], v[100:103]
    v_mfma_f32_16x16x32_bf16 v[104:107], v[124:127], v[132:135], v[104:107]
    v_mfma_f32_16x16x32_bf16 v[108:111], v[124:127], v[136:139], v[108:111]
    s_waitcnt vmcnt(10)
    s_waitcnt lgkmcnt(0)
    s_barrier
    v_mfma_f32_16x16x32_bf16 v[64:67], v[32:35], v[48:51], v[64:67]
    ds_read_b128 v[128:131], v19 offset:0
    v_mfma_f32_16x16x32_bf16 v[68:71], v[32:35], v[52:55], v[68:71]
    ds_read_b128 v[132:135], v19 offset:2048
    s_mov_b32 m0, s62
    s_lshl_b32 s65, s3, 19
    buffer_load_dwordx4 v24, s[16:19], s65 offen lds
    buffer_load_dwordx4 v25, s[16:19], s65 offen offset:1024 lds
    v_mfma_f32_16x16x32_bf16 v[72:75], v[32:35], v[56:59], v[72:75]
    ds_read_b128 v[136:139], v19 offset:4096
    v_mfma_f32_16x16x32_bf16 v[76:79], v[36:39], v[48:51], v[76:79]
    ds_read_b64_tr_b16 v[112:113], v28 offset:16384
    ds_read_b64_tr_b16 v[114:115], v28 offset:18432
    v_mfma_f32_16x16x32_bf16 v[80:83], v[36:39], v[52:55], v[80:83]
    ds_read_b64_tr_b16 v[116:117], v29 offset:16384
    ds_read_b64_tr_b16 v[118:119], v29 offset:18432
    v_mfma_f32_16x16x32_bf16 v[84:87], v[36:39], v[56:59], v[84:87]
    ds_read_b64_tr_b16 v[120:121], v30 offset:16384
    ds_read_b64_tr_b16 v[122:123], v30 offset:18432
    v_mfma_f32_16x16x32_bf16 v[88:91], v[40:43], v[48:51], v[88:91]
    ds_read_b64_tr_b16 v[124:125], v60 offset:16384
    ds_read_b64_tr_b16 v[126:127], v60 offset:18432
    v_mfma_f32_16x16x32_bf16 v[92:95], v[40:43], v[52:55], v[92:95]
    v_mfma_f32_16x16x32_bf16 v[96:99], v[40:43], v[56:59], v[96:99]
    v_mfma_f32_16x16x32_bf16 v[100:103], v[44:47], v[48:51], v[100:103]
    v_mfma_f32_16x16x32_bf16 v[104:107], v[44:47], v[52:55], v[104:107]
    v_mfma_f32_16x16x32_bf16 v[108:111], v[44:47], v[56:59], v[108:111]
    s_waitcnt vmcnt(4)
    s_waitcnt lgkmcnt(0)
    s_barrier
    v_mfma_f32_16x16x32_bf16 v[64:67], v[112:115], v[128:131], v[64:67]
    ds_read_b128 v[48:51], v18 offset:12288
    v_mfma_f32_16x16x32_bf16 v[68:71], v[112:115], v[132:135], v[68:71]
    ds_read_b128 v[52:55], v18 offset:14336
    s_mov_b32 m0, s63
    s_lshl_b32 s66, s47, 7
    buffer_load_dwordx4 v26, s[4:7], s66 offen lds
    s_mov_b32 exec_hi, 0
    buffer_load_dwordx4 v27, s[4:7], s66 offen offset:1024 lds
    s_mov_b32 exec_hi, -1
    s_add_u32 s47, s47, 1
    s_cmp_eq_u32 s47, 10
    s_cselect_b32 s47, 0, s47
    v_mfma_f32_16x16x32_bf16 v[72:75], v[112:115], v[136:139], v[72:75]
    ds_read_b128 v[56:59], v18 offset:16384
    v_mfma_f32_16x16x32_bf16 v[76:79], v[116:119], v[128:131], v[76:79]
    v_xor_b32 v28, 0x10000, v28
    ds_read_b64_tr_b16 v[32:33], v28 offset:0
    ds_read_b64_tr_b16 v[34:35], v28 offset:2048
    v_mfma_f32_16x16x32_bf16 v[80:83], v[116:119], v[132:135], v[80:83]
    v_xor_b32 v29, 0x10000, v29
    ds_read_b64_tr_b16 v[36:37], v29 offset:0
    ds_read_b64_tr_b16 v[38:39], v29 offset:2048
    s_add_u32 m0, s62, 16384
    s_add_u32 s65, s65, 262144
    buffer_load_dwordx4 v24, s[16:19], s65 offen lds
    buffer_load_dwordx4 v25, s[16:19], s65 offen offset:1024 lds
    s_add_u32 s3, s3, 1
    s_cmp_eq_u32 s3, 10
    s_cselect_b32 s3, 0, s3
    v_mfma_f32_16x16x32_bf16 v[84:87], v[116:119], v[136:139], v[84:87]
    v_xor_b32 v30, 0x10000, v30
    ds_read_b64_tr_b16 v[40:41], v30 offset:0
    ds_read_b64_tr_b16 v[42:43], v30 offset:2048
    v_mfma_f32_16x16x32_bf16 v[88:91], v[120:123], v[128:131], v[88:91]
    v_xor_b32 v60, 0x10000, v60
    ds_read_b64_tr_b16 v[44:45], v60 offset:0
    ds_read_b64_tr_b16 v[46:47], v60 offset:2048
    v_mfma_f32_16x16x32_bf16 v[92:95], v[120:123], v[132:135], v[92:95]
    s_xor_b32 s64, s55, 32768
    buffer_load_dwordx4 v[160:163], v8, s[8:11], s64 offen offset:0 nt
    v_mfma_f32_16x16x32_bf16 v[96:99], v[120:123], v[136:139], v[96:99]
    v_mfma_f32_16x16x32_bf16 v[100:103], v[124:127], v[128:131], v[100:103]
    v_mfma_f32_16x16x32_bf16 v[104:107], v[124:127], v[132:135], v[104:107]
    s_xor_b32 s64, s55, 32768
    buffer_load_dwordx4 v[164:167], v9, s[8:11], s64 offen offset:1024 nt
    v_mfma_f32_16x16x32_bf16 v[108:111], v[124:127], v[136:139], v[108:111]
    s_xor_b32 s64, s55, 32768
    buffer_load_dwordx4 v[168:171], v10, s[8:11], s64 offen offset:2048 nt
    s_xor_b32 s64, s55, 32768
    buffer_load_dwordx4 v[172:175], v11, s[8:11], s64 offen offset:3072 nt
    s_waitcnt vmcnt(10)
    s_waitcnt lgkmcnt(0)
    s_barrier
    v_mfma_f32_16x16x32_bf16 v[64:67], v[32:35], v[48:51], v[64:67]
    ds_read_b128 v[128:131], v19 offset:12288
    v_mfma_f32_16x16x32_bf16 v[68:71], v[32:35], v[52:55], v[68:71]
    ds_read_b128 v[132:135], v19 offset:14336
    s_add_u32 m0, s62, 65536
    s_lshl_b32 s65, s3, 19
    buffer_load_dwordx4 v24, s[16:19], s65 offen lds
    buffer_load_dwordx4 v25, s[16:19], s65 offen offset:1024 lds
    v_mfma_f32_16x16x32_bf16 v[72:75], v[32:35], v[56:59], v[72:75]
    ds_read_b128 v[136:139], v19 offset:16384
    v_mfma_f32_16x16x32_bf16 v[76:79], v[36:39], v[48:51], v[76:79]
    ds_read_b64_tr_b16 v[112:113], v28 offset:16384
    ds_read_b64_tr_b16 v[114:115], v28 offset:18432
    v_mfma_f32_16x16x32_bf16 v[80:83], v[36:39], v[52:55], v[80:83]
    ds_read_b64_tr_b16 v[116:117], v29 offset:16384
    ds_read_b64_tr_b16 v[118:119], v29 offset:18432
    v_mfma_f32_16x16x32_bf16 v[84:87], v[36:39], v[56:59], v[84:87]
    ds_read_b64_tr_b16 v[120:121], v30 offset:16384
    ds_read_b64_tr_b16 v[122:123], v30 offset:18432
    v_mfma_f32_16x16x32_bf16 v[88:91], v[40:43], v[48:51], v[88:91]
    ds_read_b64_tr_b16 v[124:125], v60 offset:16384
    ds_read_b64_tr_b16 v[126:127], v60 offset:18432
    v_mfma_f32_16x16x32_bf16 v[92:95], v[40:43], v[52:55], v[92:95]
    v_mfma_f32_16x16x32_bf16 v[96:99], v[40:43], v[56:59], v[96:99]
    v_mfma_f32_16x16x32_bf16 v[100:103], v[44:47], v[48:51], v[100:103]
    v_mfma_f32_16x16x32_bf16 v[104:107], v[44:47], v[52:55], v[104:107]
    v_mfma_f32_16x16x32_bf16 v[108:111], v[44:47], v[56:59], v[108:111]
    s_waitcnt vmcnt(8)
    s_waitcnt lgkmcnt(0)
    s_barrier
    v_mfma_f32_16x16x32_bf16 v[64:67], v[112:115], v[128:131], v[64:67]
    ds_read_b128 v[48:51], v18 offset:0
    v_mfma_f32_16x16x32_bf16 v[68:71], v[112:115], v[132:135], v[68:71]
    ds_read_b128 v[52:55], v18 offset:2048
    s_add_u32 m0, s63, 12288
    s_lshl_b32 s66, s47, 7
    buffer_load_dwordx4 v26, s[4:7], s66 offen lds
    s_mov_b32 exec_hi, 0
    buffer_load_dwordx4 v27, s[4:7], s66 offen offset:1024 lds
    s_mov_b32 exec_hi, -1
    s_add_u32 s47, s47, 1
    s_cmp_eq_u32 s47, 10
    s_cselect_b32 s47, 0, s47
    v_mfma_f32_16x16x32_bf16 v[72:75], v[112:115], v[136:139], v[72:75]
    ds_read_b128 v[56:59], v18 offset:4096
    v_mfma_f32_16x16x32_bf16 v[76:79], v[116:119], v[128:131], v[76:79]
    v_xor_b32 v28, 0x10000, v28
    ds_read_b64_tr_b16 v[32:33], v28 offset:0
    ds_read_b64_tr_b16 v[34:35], v28 offset:2048
    v_mfma_f32_16x16x32_bf16 v[80:83], v[116:119], v[132:135], v[80:83]
    v_xor_b32 v29, 0x10000, v29
    ds_read_b64_tr_b16 v[36:37], v29 offset:0
    ds_read_b64_tr_b16 v[38:39], v29 offset:2048
    s_add_u32 m0, s62, 81920
    s_add_u32 s65, s65, 262144
    buffer_load_dwordx4 v24, s[16:19], s65 offen lds
    buffer_load_dwordx4 v25, s[16:19], s65 offen offset:1024 lds
    s_add_u32 s3, s3, 1
    s_cmp_eq_u32 s3, 10
    s_cselect_b32 s3, 0, s3
    v_mfma_f32_16x16x32_bf16 v[84:87], v[116:119], v[136:139], v[84:87]
    v_xor_b32 v30, 0x10000, v30
    ds_read_b64_tr_b16 v[40:41], v30 offset:0
    ds_read_b64_tr_b16 v[42:43], v30 offset:2048
    v_mfma_f32_16x16x32_bf16 v[88:91], v[120:123], v[128:131], v[88:91]
    v_xor_b32 v60, 0x10000, v60
    ds_read_b64_tr_b16 v[44:45], v60 offset:0
    ds_read_b64_tr_b16 v[46:47], v60 offset:2048
    v_mfma_f32_16x16x32_bf16 v[92:95], v[120:123], v[132:135], v[92:95]
    v_mfma_f32_16x16x32_bf16 v[96:99], v[120:123], v[136:139], v[96:99]
    v_mfma_f32_16x16x32_bf16 v[100:103], v[124:127], v[128:131], v[100:103]
    v_mfma_f32_16x16x32_bf16 v[104:107], v[124:127], v[132:135], v[104:107]
    v_mfma_f32_16x16x32_bf16 v[108:111], v[124:127], v[136:139], v[108:111]
    s_waitcnt vmcnt(10)
    s_waitcnt lgkmcnt(0)
    s_barrier
    v_mfma_f32_16x16x32_bf16 v[64:67], v[32:35], v[48:51], v[64:67]
    ds_read_b128 v[128:131], v19 offset:0
    v_mfma_f32_16x16x32_bf16 v[68:71], v[32:35], v[52:55], v[68:71]
    ds_read_b128 v[132:135], v19 offset:2048
    s_xor_b32 s64, s55, 49152
    buffer_load_dwordx4 v[176:179], v8, s[8:11], s64 offen offset:0 nt
    v_mfma_f32_16x16x32_bf16 v[72:75], v[32:35], v[56:59], v[72:75]
    ds_read_b128 v[136:139], v19 offset:4096
    v_mfma_f32_16x16x32_bf16 v[76:79], v[36:39], v[48:51], v[76:79]
    ds_read_b64_tr_b16 v[112:113], v28 offset:16384
    ds_read_b64_tr_b16 v[114:115], v28 offset:18432
    v_mfma_f32_16x16x32_bf16 v[80:83], v[36:39], v[52:55], v[80:83]
    ds_read_b64_tr_b16 v[116:117], v29 offset:16384
    ds_read_b64_tr_b16 v[118:119], v29 offset:18432
    s_xor_b32 s64, s55, 49152
    buffer_load_dwordx4 v[180:183], v9, s[8:11], s64 offen offset:1024 nt
    v_mfma_f32_16x16x32_bf16 v[84:87], v[36:39], v[56:59], v[84:87]
    ds_read_b64_tr_b16 v[120:121], v30 offset:16384
    ds_read_b64_tr_b16 v[122:123], v30 offset:18432
    v_mfma_f32_16x16x32_bf16 v[88:91], v[40:43], v[48:51], v[88:91]
    ds_read_b64_tr_b16 v[124:125], v60 offset:16384
    ds_read_b64_tr_b16 v[126:127], v60 offset:18432
    v_mfma_f32_16x16x32_bf16 v[92:95], v[40:43], v[52:55], v[92:95]
    s_xor_b32 s64, s55, 49152
    buffer_load_dwordx4 v[184:187], v10, s[8:11], s64 offen offset:2048 nt
    v_mfma_f32_16x16x32_bf16 v[96:99], v[40:43], v[56:59], v[96:99]
    v_mfma_f32_16x16x32_bf16 v[100:103], v[44:47], v[48:51], v[100:103]
    v_mfma_f32_16x16x32_bf16 v[104:107], v[44:47], v[52:55], v[104:107]
    s_xor_b32 s64, s55, 49152
    buffer_load_dwordx4 v[188:191], v11, s[8:11], s64 offen offset:3072 nt
    v_mfma_f32_16x16x32_bf16 v[108:111], v[44:47], v[56:59], v[108:111]
    s_waitcnt vmcnt(6)
    s_waitcnt lgkmcnt(0)
    s_barrier
    v_mfma_f32_16x16x32_bf16 v[64:67], v[112:115], v[128:131], v[64:67]
    ds_read_b128 v[48:51], v18 offset:12288
    v_mfma_f32_16x16x32_bf16 v[68:71], v[112:115], v[132:135], v[68:71]
    ds_read_b128 v[52:55], v18 offset:14336
    v_mfma_f32_16x16x32_bf16 v[72:75], v[112:115], v[136:139], v[72:75]
    ds_read_b128 v[56:59], v18 offset:16384
    v_mfma_f32_16x16x32_bf16 v[76:79], v[116:119], v[128:131], v[76:79]
    v_xor_b32 v28, 0x10000, v28
    ds_read_b64_tr_b16 v[32:33], v28 offset:0
    ds_read_b64_tr_b16 v[34:35], v28 offset:2048
    v_mfma_f32_16x16x32_bf16 v[80:83], v[116:119], v[132:135], v[80:83]
    v_xor_b32 v29, 0x10000, v29
    ds_read_b64_tr_b16 v[36:37], v29 offset:0
    ds_read_b64_tr_b16 v[38:39], v29 offset:2048
    v_mfma_f32_16x16x32_bf16 v[84:87], v[116:119], v[136:139], v[84:87]
    v_xor_b32 v30, 0x10000, v30
    ds_read_b64_tr_b16 v[40:41], v30 offset:0
    ds_read_b64_tr_b16 v[42:43], v30 offset:2048
    v_mfma_f32_16x16x32_bf16 v[88:91], v[120:123], v[128:131], v[88:91]
    v_xor_b32 v60, 0x10000, v60
    ds_read_b64_tr_b16 v[44:45], v60 offset:0
    ds_read_b64_tr_b16 v[46:47], v60 offset:2048
    v_mfma_f32_16x16x32_bf16 v[92:95], v[120:123], v[132:135], v[92:95]
    v_mfma_f32_16x16x32_bf16 v[96:99], v[120:123], v[136:139], v[96:99]
    v_mfma_f32_16x16x32_bf16 v[100:103], v[124:127], v[128:131], v[100:103]
    v_mfma_f32_16x16x32_bf16 v[104:107], v[124:127], v[132:135], v[104:107]
    v_mfma_f32_16x16x32_bf16 v[108:111], v[124:127], v[136:139], v[108:111]
    s_waitcnt vmcnt(4)
    s_waitcnt lgkmcnt(0)
    s_barrier
    v_mfma_f32_16x16x32_bf16 v[64:67], v[32:35], v[48:51], v[64:67]
    ds_read_b128 v[128:131], v19 offset:12288
    v_mfma_f32_16x16x32_bf16 v[68:71], v[32:35], v[52:55], v[68:71]
    ds_read_b128 v[132:135], v19 offset:14336
    v_mfma_f32_16x16x32_bf16 v[72:75], v[32:35], v[56:59], v[72:75]
    ds_read_b128 v[136:139], v19 offset:16384
    v_mfma_f32_16x16x32_bf16 v[76:79], v[36:39], v[48:51], v[76:79]
    ds_read_b64_tr_b16 v[112:113], v28 offset:16384
    ds_read_b64_tr_b16 v[114:115], v28 offset:18432
    v_mfma_f32_16x16x32_bf16 v[80:83], v[36:39], v[52:55], v[80:83]
    ds_read_b64_tr_b16 v[116:117], v29 offset:16384
    ds_read_b64_tr_b16 v[118:119], v29 offset:18432
    v_mfma_f32_16x16x32_bf16 v[84:87], v[36:39], v[56:59], v[84:87]
    ds_read_b64_tr_b16 v[120:121], v30 offset:16384
    ds_read_b64_tr_b16 v[122:123], v30 offset:18432
    v_mfma_f32_16x16x32_bf16 v[88:91], v[40:43], v[48:51], v[88:91]
    ds_read_b64_tr_b16 v[124:125], v60 offset:16384
    ds_read_b64_tr_b16 v[126:127], v60 offset:18432
    v_mfma_f32_16x16x32_bf16 v[92:95], v[40:43], v[52:55], v[92:95]
    v_mfma_f32_16x16x32_bf16 v[96:99], v[40:43], v[56:59], v[96:99]
    v_mfma_f32_16x16x32_bf16 v[100:103], v[44:47], v[48:51], v[100:103]
    v_mfma_f32_16x16x32_bf16 v[104:107], v[44:47], v[52:55], v[104:107]
    v_mfma_f32_16x16x32_bf16 v[108:111], v[44:47], v[56:59], v[108:111]
    s_waitcnt lgkmcnt(0)
    s_barrier
    v_mfma_f32_16x16x32_bf16 v[64:67], v[112:115], v[128:131], v[64:67]
    v_mfma_f32_16x16x32_bf16 v[68:71], v[112:115], v[132:135], v[68:71]
    s_xor_b32 s64, s55, 65536
    buffer_load_dwordx4 v[192:195], v8, s[8:11], s64 offen offset:0 nt
    v_mfma_f32_16x16x32_bf16 v[72:75], v[112:115], v[136:139], v[72:75]
    v_mfma_f32_16x16x32_bf16 v[76:79], v[116:119], v[128:131], v[76:79]
    v_mfma_f32_16x16x32_bf16 v[80:83], v[116:119], v[132:135], v[80:83]
    s_xor_b32 s64, s55, 65536
    buffer_load_dwordx4 v[196:199], v9, s[8:11], s64 offen offset:1024 nt
    v_mfma_f32_16x16x32_bf16 v[84:87], v[116:119], v[136:139], v[84:87]
    v_mfma_f32_16x16x32_bf16 v[88:91], v[120:123], v[128:131], v[88:91]
    v_mfma_f32_16x16x32_bf16 v[92:95], v[120:123], v[132:135], v[92:95]
    s_xor_b32 s64, s55, 65536
    buffer_load_dwordx4 v[200:203], v10, s[8:11], s64 offen offset:2048 nt
    v_mfma_f32_16x16x32_bf16 v[96:99], v[120:123], v[136:139], v[96:99]
    v_mfma_f32_16x16x32_bf16 v[100:103], v[124:127], v[128:131], v[100:103]
    v_mfma_f32_16x16x32_bf16 v[104:107], v[124:127], v[132:135], v[104:107]
    s_xor_b32 s64, s55, 65536
    buffer_load_dwordx4 v[204:207], v11, s[8:11], s64 offen offset:3072 nt
    v_mfma_f32_16x16x32_bf16 v[108:111], v[124:127], v[136:139], v[108:111]
    v_cvt_pk_bf16_f32 v32, v64, v65
    v_cvt_pk_bf16_f32 v33, v66, v67
    ds_write_b64 v20, v[32:33] offset:0
    v_cvt_pk_bf16_f32 v34, v68, v69
    v_cvt_pk_bf16_f32 v35, v70, v71
    ds_write_b64 v20, v[34:35] offset:4096
    v_cvt_pk_bf16_f32 v36, v72, v73
    v_cvt_pk_bf16_f32 v37, v74, v75
    ds_write_b64 v20, v[36:37] offset:8192
    v_cvt_pk_bf16_f32 v38, v76, v77
    v_cvt_pk_bf16_f32 v39, v78, v79
    ds_write_b64 v20, v[38:39] offset:512
    v_cvt_pk_bf16_f32 v40, v80, v81
    v_cvt_pk_bf16_f32 v41, v82, v83
    ds_write_b64 v20, v[40:41] offset:4608
    v_cvt_pk_bf16_f32 v42, v84, v85
    v_cvt_pk_bf16_f32 v43, v86, v87
    ds_write_b64 v20, v[42:43] offset:8704
    v_cvt_pk_bf16_f32 v44, v88, v89
    v_cvt_pk_bf16_f32 v45, v90, v91
    ds_write_b64 v20, v[44:45] offset:1024
    v_cvt_pk_bf16_f32 v46, v92, v93
    v_cvt_pk_bf16_f32 v47, v94, v95
    ds_write_b64 v20, v[46:47] offset:5120
    v_cvt_pk_bf16_f32 v48, v96, v97
    v_cvt_pk_bf16_f32 v49, v98, v99
    ds_write_b64 v20, v[48:49] offset:9216
    v_cvt_pk_bf16_f32 v50, v100, v101
    v_cvt_pk_bf16_f32 v51, v102, v103
    ds_write_b64 v20, v[50:51] offset:1536
    v_cvt_pk_bf16_f32 v52, v104, v105
    v_cvt_pk_bf16_f32 v53, v106, v107
    ds_write_b64 v20, v[52:53] offset:5632
    v_cvt_pk_bf16_f32 v54, v108, v109
    v_cvt_pk_bf16_f32 v55, v110, v111
    ds_write_b64 v20, v[54:55] offset:9728
    v_bfe_u32 v1, v0, 2, 2
    v_and_b32 v2, 1, v5
    v_lshl_add_u32 v2, v2, 2, v1
    s_lshl_b32 s56, s51, 2
    s_xor_b32 s56, s56, 4
    v_xor_b32 v2, s56, v2
    v_lshl_add_u32 v3, v5, 2, v1
    v_lshlrev_b32 v3, 8, v3
    v_and_b32 v4, 3, v0
    v_lshl_add_u32 v3, v4, 3, v3
    s_lshl_b32 s56, s51, 13
    s_add_u32 s56, s56, s60
    v_add_u32 v3, s56, v3
    v_xor_b32 v4, 0, v2
    v_lshl_add_u32 v24, v4, 5, v3
    v_xor_b32 v4, 1, v2
    v_lshl_add_u32 v25, v4, 5, v3
    v_xor_b32 v4, 2, v2
    v_lshl_add_u32 v26, v4, 5, v3
    v_xor_b32 v4, 3, v2
    v_lshl_add_u32 v27, v4, 5, v3
    v_xor_b32 v4, 4, v2
    v_lshl_add_u32 v28, v4, 5, v3
    v_xor_b32 v4, 5, v2
    v_lshl_add_u32 v29, v4, 5, v3
    v_xor_b32 v4, 6, v2
    v_lshl_add_u32 v30, v4, 5, v3
    v_xor_b32 v4, 7, v2
    v_lshl_add_u32 v31, v4, 5, v3
    s_waitcnt lgkmcnt(0)
    s_barrier
    ds_read_b128 v[64:67], v21 offset:0
    ds_read_b128 v[80:83], v21 offset:4096
    ds_read_b128 v[96:99], v21 offset:8192
    ds_read_b128 v[68:71], v21 offset:1024
    ds_read_b128 v[84:87], v21 offset:5120
    ds_read_b128 v[100:103], v21 offset:9216
    ds_read_b128 v[72:75], v21 offset:2048
    ds_read_b128 v[88:91], v21 offset:6144
    ds_read_b128 v[104:107], v21 offset:10240
    ds_read_b128 v[76:79], v21 offset:3072
    ds_read_b128 v[92:95], v21 offset:7168
    ds_read_b128 v[108:111], v21 offset:11264
    ds_read_b128 v[32:35], v12 offset:0
    ds_read_b128 v[36:39], v13 offset:0
    ds_read_b128 v[40:43], v14 offset:0
    ds_read_b128 v[44:47], v15 offset:0
    ds_read_b128 v[48:51], v12 offset:4096
    ds_read_b128 v[52:55], v13 offset:4096
    ds_read_b128 v[56:59], v14 offset:4096
    ds_read_b128 v[60:63], v15 offset:4096
    s_xor_b32 s64, s55, 81920
    buffer_load_dwordx4 v[208:211], v8, s[8:11], s64 offen offset:0 nt
    s_xor_b32 s64, s55, 81920
    buffer_load_dwordx4 v[212:215], v9, s[8:11], s64 offen offset:1024 nt
    s_xor_b32 s64, s55, 81920
    buffer_load_dwordx4 v[216:219], v10, s[8:11], s64 offen offset:2048 nt
    s_xor_b32 s64, s55, 81920
    buffer_load_dwordx4 v[220:223], v11, s[8:11], s64 offen offset:3072 nt
    s_waitcnt lgkmcnt(7)
    v_mfma_f32_16x16x32_bf16 v[112:115], v[32:35], v[64:67], 0
    v_mfma_f32_16x16x32_bf16 v[120:123], v[32:35], v[80:83], 0
    v_mfma_f32_16x16x32_bf16 v[128:131], v[32:35], v[96:99], 0
    s_waitcnt lgkmcnt(6)
    v_mfma_f32_16x16x32_bf16 v[112:115], v[36:39], v[68:71], v[112:115]
    v_mfma_f32_16x16x32_bf16 v[120:123], v[36:39], v[84:87], v[120:123]
    v_mfma_f32_16x16x32_bf16 v[128:131], v[36:39], v[100:103], v[128:131]
    s_waitcnt lgkmcnt(5)
    v_mfma_f32_16x16x32_bf16 v[112:115], v[40:43], v[72:75], v[112:115]
    v_mfma_f32_16x16x32_bf16 v[120:123], v[40:43], v[88:91], v[120:123]
    v_mfma_f32_16x16x32_bf16 v[128:131], v[40:43], v[104:107], v[128:131]
    s_waitcnt lgkmcnt(4)
    v_mfma_f32_16x16x32_bf16 v[112:115], v[44:47], v[76:79], v[112:115]
    v_mfma_f32_16x16x32_bf16 v[120:123], v[44:47], v[92:95], v[120:123]
    v_mfma_f32_16x16x32_bf16 v[128:131], v[44:47], v[108:111], v[128:131]
    s_waitcnt lgkmcnt(3)
    v_mfma_f32_16x16x32_bf16 v[116:119], v[48:51], v[64:67], 0
    v_mfma_f32_16x16x32_bf16 v[124:127], v[48:51], v[80:83], 0
    v_mfma_f32_16x16x32_bf16 v[132:135], v[48:51], v[96:99], 0
    s_waitcnt lgkmcnt(2)
    v_mfma_f32_16x16x32_bf16 v[116:119], v[52:55], v[68:71], v[116:119]
    v_mfma_f32_16x16x32_bf16 v[124:127], v[52:55], v[84:87], v[124:127]
    v_mfma_f32_16x16x32_bf16 v[132:135], v[52:55], v[100:103], v[132:135]
    s_waitcnt lgkmcnt(1)
    v_mfma_f32_16x16x32_bf16 v[116:119], v[56:59], v[72:75], v[116:119]
    v_mfma_f32_16x16x32_bf16 v[124:127], v[56:59], v[88:91], v[124:127]
    v_mfma_f32_16x16x32_bf16 v[132:135], v[56:59], v[104:107], v[132:135]
    s_waitcnt lgkmcnt(0)
    v_mfma_f32_16x16x32_bf16 v[116:119], v[60:63], v[76:79], v[116:119]
    v_mfma_f32_16x16x32_bf16 v[124:127], v[60:63], v[92:95], v[124:127]
    v_mfma_f32_16x16x32_bf16 v[132:135], v[60:63], v[108:111], v[132:135]
    s_barrier
    s_add_u32 s58, s61, 32768
    v_add_u32 v4, s58, v7
    ds_write_b128 v4, v[160:163] offset:0
    ds_write_b128 v4, v[164:167] offset:1024
    ds_write_b128 v4, v[168:171] offset:2048
    ds_write_b128 v4, v[172:175] offset:3072
    s_waitcnt vmcnt(8)
    s_add_u32 s58, s61, 49152
    v_add_u32 v4, s58, v7
    ds_write_b128 v4, v[176:179] offset:0
    ds_write_b128 v4, v[180:183] offset:1024
    ds_write_b128 v4, v[184:187] offset:2048
    ds_write_b128 v4, v[188:191] offset:3072
    v_max3_f32 v18, v112, v113, v114
    v_max3_f32 v19, v120, v121, v122
    v_max3_f32 v20, v128, v129, v130
    v_max3_f32 v18, v18, v115, v116
    v_max3_f32 v19, v19, v123, v124
    v_max3_f32 v20, v20, v131, v132
    v_max3_f32 v18, v18, v117, v118
    v_max3_f32 v19, v19, v125, v126
    v_max3_f32 v20, v20, v133, v134
    v_max_f32 v18, v18, v119
    v_max_f32 v19, v19, v127
    v_max_f32 v20, v20, v135
    v_mov_b32 v136, v18
    v_mov_b32 v137, v19
    v_mov_b32 v138, v20
    v_permlane32_swap_b32 v18, v136
    v_permlane32_swap_b32 v19, v137
    v_permlane32_swap_b32 v20, v138
    v_max_f32 v18, v18, v136
    v_max_f32 v19, v19, v137
    v_max_f32 v20, v20, v138
    v_mov_b32 v136, v18
    v_mov_b32 v137, v19
    v_mov_b32 v138, v20
    v_permlane16_swap_b32 v18, v136
    v_permlane16_swap_b32 v19, v137
    v_permlane16_swap_b32 v20, v138
    v_max_f32 v18, v18, v136
    v_max_f32 v19, v19, v137
    v_max_f32 v20, v20, v138
    v_mul_f32 v18, s59, v18
    v_mul_f32 v19, s59, v19
    v_mul_f32 v20, s59, v20
    v_fma_f32 v112, v112, s59, -v18
    v_fma_f32 v120, v120, s59, -v19
    v_fma_f32 v128, v128, s59, -v20
    v_fma_f32 v113, v113, s59, -v18
    v_fma_f32 v121, v121, s59, -v19
    v_fma_f32 v129, v129, s59, -v20
    v_fma_f32 v114, v114, s59, -v18
    v_fma_f32 v122, v122, s59, -v19
    v_fma_f32 v130, v130, s59, -v20
    v_fma_f32 v115, v115, s59, -v18
    v_fma_f32 v123, v123, s59, -v19
    v_fma_f32 v131, v131, s59, -v20
    ds_read_b128 v[32:35], v12 offset:16384
    ds_read_b128 v[36:39], v13 offset:16384
    v_fma_f32 v116, v116, s59, -v18
    v_fma_f32 v124, v124, s59, -v19
    v_fma_f32 v132, v132, s59, -v20
    v_fma_f32 v117, v117, s59, -v18
    v_fma_f32 v125, v125, s59, -v19
    v_fma_f32 v133, v133, s59, -v20
    v_fma_f32 v118, v118, s59, -v18
    v_fma_f32 v126, v126, s59, -v19
    v_fma_f32 v134, v134, s59, -v20
    v_fma_f32 v119, v119, s59, -v18
    v_fma_f32 v127, v127, s59, -v19
    v_fma_f32 v135, v135, s59, -v20
    ds_read_b128 v[40:43], v14 offset:16384
    ds_read_b128 v[44:47], v15 offset:16384
    ds_read_b128 v[48:51], v12 offset:20480
    ds_read_b128 v[52:55], v13 offset:20480
    v_exp_f32 v112, v112
    v_exp_f32 v120, v120
    v_exp_f32 v128, v128
    ds_read_b128 v[56:59], v14 offset:20480
    ds_read_b128 v[60:63], v15 offset:20480
    v_exp_f32 v113, v113
    v_exp_f32 v121, v121
    v_exp_f32 v129, v129
    v_exp_f32 v114, v114
    v_exp_f32 v122, v122
    v_exp_f32 v130, v130
    v_add_f32 v21, v112, v113
    v_add_f32 v22, v120, v121
    v_add_f32 v23, v128, v129
    v_cvt_pk_bf16_f32 v148, v112, v113
    v_cvt_pk_bf16_f32 v152, v120, v121
    v_cvt_pk_bf16_f32 v156, v128, v129
    v_exp_f32 v115, v115
    v_exp_f32 v123, v123
    v_exp_f32 v131, v131
    v_add_f32 v21, v21, v114
    v_add_f32 v22, v22, v122
    v_add_f32 v23, v23, v130
    v_exp_f32 v116, v116
    v_exp_f32 v124, v124
    v_exp_f32 v132, v132
    v_add_f32 v21, v21, v115
    v_add_f32 v22, v22, v123
    v_add_f32 v23, v23, v131
    v_cvt_pk_bf16_f32 v149, v114, v115
    v_cvt_pk_bf16_f32 v153, v122, v123
    v_cvt_pk_bf16_f32 v157, v130, v131
    v_exp_f32 v117, v117
    v_exp_f32 v125, v125
    v_exp_f32 v133, v133
    v_add_f32 v21, v21, v116
    v_add_f32 v22, v22, v124
    v_add_f32 v23, v23, v132
    v_exp_f32 v118, v118
    v_exp_f32 v126, v126
    v_exp_f32 v134, v134
    v_add_f32 v21, v21, v117
    v_add_f32 v22, v22, v125
    v_add_f32 v23, v23, v133
    v_cvt_pk_bf16_f32 v150, v116, v117
    v_cvt_pk_bf16_f32 v154, v124, v125
    v_cvt_pk_bf16_f32 v158, v132, v133
    v_exp_f32 v119, v119
    v_exp_f32 v127, v127
    v_exp_f32 v135, v135
    v_add_f32 v21, v21, v118
    v_add_f32 v22, v22, v126
    v_add_f32 v23, v23, v134
    v_add_f32 v21, v21, v119
    v_add_f32 v22, v22, v127
    v_add_f32 v23, v23, v135
    v_cvt_pk_bf16_f32 v151, v118, v119
    v_cvt_pk_bf16_f32 v155, v126, v127
    v_cvt_pk_bf16_f32 v159, v134, v135
    s_waitcnt lgkmcnt(7)
    v_mfma_f32_16x16x32_bf16 v[112:115], v[32:35], v[64:67], 0
    v_mfma_f32_16x16x32_bf16 v[120:123], v[32:35], v[80:83], 0
    v_mfma_f32_16x16x32_bf16 v[128:131], v[32:35], v[96:99], 0
    s_waitcnt lgkmcnt(6)
    v_mfma_f32_16x16x32_bf16 v[112:115], v[36:39], v[68:71], v[112:115]
    v_mfma_f32_16x16x32_bf16 v[120:123], v[36:39], v[84:87], v[120:123]
    v_mfma_f32_16x16x32_bf16 v[128:131], v[36:39], v[100:103], v[128:131]
    s_waitcnt lgkmcnt(5)
    v_mfma_f32_16x16x32_bf16 v[112:115], v[40:43], v[72:75], v[112:115]
    v_mfma_f32_16x16x32_bf16 v[120:123], v[40:43], v[88:91], v[120:123]
    v_mfma_f32_16x16x32_bf16 v[128:131], v[40:43], v[104:107], v[128:131]
    s_waitcnt lgkmcnt(4)
    v_mfma_f32_16x16x32_bf16 v[112:115], v[44:47], v[76:79], v[112:115]
    v_mfma_f32_16x16x32_bf16 v[120:123], v[44:47], v[92:95], v[120:123]
    v_mfma_f32_16x16x32_bf16 v[128:131], v[44:47], v[108:111], v[128:131]
    s_waitcnt lgkmcnt(3)
    v_mfma_f32_16x16x32_bf16 v[116:119], v[48:51], v[64:67], 0
    v_mfma_f32_16x16x32_bf16 v[124:127], v[48:51], v[80:83], 0
    v_mfma_f32_16x16x32_bf16 v[132:135], v[48:51], v[96:99], 0
    s_waitcnt lgkmcnt(2)
    v_mfma_f32_16x16x32_bf16 v[116:119], v[52:55], v[68:71], v[116:119]
    v_mfma_f32_16x16x32_bf16 v[124:127], v[52:55], v[84:87], v[124:127]
    v_mfma_f32_16x16x32_bf16 v[132:135], v[52:55], v[100:103], v[132:135]
    s_waitcnt lgkmcnt(1)
    v_mfma_f32_16x16x32_bf16 v[116:119], v[56:59], v[72:75], v[116:119]
    v_mfma_f32_16x16x32_bf16 v[124:127], v[56:59], v[88:91], v[124:127]
    v_mfma_f32_16x16x32_bf16 v[132:135], v[56:59], v[104:107], v[132:135]
    s_waitcnt lgkmcnt(0)
    v_mfma_f32_16x16x32_bf16 v[116:119], v[60:63], v[76:79], v[116:119]
    v_mfma_f32_16x16x32_bf16 v[124:127], v[60:63], v[92:95], v[124:127]
    v_mfma_f32_16x16x32_bf16 v[132:135], v[60:63], v[108:111], v[132:135]
    s_barrier
    s_waitcnt vmcnt(4)
    s_add_u32 s58, s61, 0
    v_add_u32 v4, s58, v7
    ds_write_b128 v4, v[192:195] offset:0
    ds_write_b128 v4, v[196:199] offset:1024
    ds_write_b128 v4, v[200:203] offset:2048
    ds_write_b128 v4, v[204:207] offset:3072
    v_fma_f32 v112, v112, s59, -v18
    v_fma_f32 v120, v120, s59, -v19
    v_fma_f32 v128, v128, s59, -v20
    v_fma_f32 v113, v113, s59, -v18
    v_fma_f32 v121, v121, s59, -v19
    v_fma_f32 v129, v129, s59, -v20
    v_fma_f32 v114, v114, s59, -v18
    v_fma_f32 v122, v122, s59, -v19
    v_fma_f32 v130, v130, s59, -v20
    v_fma_f32 v115, v115, s59, -v18
    v_fma_f32 v123, v123, s59, -v19
    v_fma_f32 v131, v131, s59, -v20
    ds_read_b128 v[32:35], v12 offset:32768
    ds_read_b128 v[36:39], v13 offset:32768
    v_fma_f32 v116, v116, s59, -v18
    v_fma_f32 v124, v124, s59, -v19
    v_fma_f32 v132, v132, s59, -v20
    v_fma_f32 v117, v117, s59, -v18
    v_fma_f32 v125, v125, s59, -v19
    v_fma_f32 v133, v133, s59, -v20
    v_fma_f32 v118, v118, s59, -v18
    v_fma_f32 v126, v126, s59, -v19
    v_fma_f32 v134, v134, s59, -v20
    v_fma_f32 v119, v119, s59, -v18
    v_fma_f32 v127, v127, s59, -v19
    v_fma_f32 v135, v135, s59, -v20
    ds_read_b128 v[40:43], v14 offset:32768
    ds_read_b128 v[44:47], v15 offset:32768
    v_max3_f32 v136, v112, v113, v114
    v_max3_f32 v137, v120, v121, v122
    v_max3_f32 v138, v128, v129, v130
    v_max3_f32 v136, v136, v115, v116
    v_max3_f32 v137, v137, v123, v124
    v_max3_f32 v138, v138, v131, v132
    v_max3_f32 v136, v136, v117, v118
    v_max3_f32 v137, v137, v125, v126
    v_max3_f32 v138, v138, v133, v134
    v_max_f32 v136, v136, v119
    v_max_f32 v137, v137, v127
    v_max_f32 v138, v138, v135
    v_max3_f32 v139, v136, v137, v138
    v_cmp_lt_f32 vcc, s29, v139
    s_mov_b32 s28, 1
    s_nop 3
    s_cbranch_vccnz K1_SLOW_0
K1_RET1_0:
    ds_read_b128 v[48:51], v12 offset:36864
    ds_read_b128 v[52:55], v13 offset:36864
    v_exp_f32 v112, v112
    v_exp_f32 v120, v120
    v_exp_f32 v128, v128
    ds_read_b128 v[56:59], v14 offset:36864
    ds_read_b128 v[60:63], v15 offset:36864
    s_xor_b32 s64, s55, 98304
    buffer_load_dwordx4 v[224:227], v8, s[8:11], s64 offen offset:0 nt
    v_exp_f32 v113, v113
    v_exp_f32 v121, v121
    v_exp_f32 v129, v129
    v_add_f32 v21, v21, v112
    v_add_f32 v22, v22, v120
    v_add_f32 v23, v23, v128
    s_xor_b32 s64, s55, 98304
    buffer_load_dwordx4 v[228:231], v9, s[8:11], s64 offen offset:1024 nt
    v_exp_f32 v114, v114
    v_exp_f32 v122, v122
    v_exp_f32 v130, v130
    v_add_f32 v21, v21, v113
    v_add_f32 v22, v22, v121
    v_add_f32 v23, v23, v129
    v_cvt_pk_bf16_f32 v160, v112, v113
    v_cvt_pk_bf16_f32 v164, v120, v121
    v_cvt_pk_bf16_f32 v168, v128, v129
    s_xor_b32 s64, s55, 98304
    buffer_load_dwordx4 v[232:235], v10, s[8:11], s64 offen offset:2048 nt
    v_exp_f32 v115, v115
    v_exp_f32 v123, v123
    v_exp_f32 v131, v131
    v_add_f32 v21, v21, v114
    v_add_f32 v22, v22, v122
    v_add_f32 v23, v23, v130
    s_xor_b32 s64, s55, 98304
    buffer_load_dwordx4 v[236:239], v11, s[8:11], s64 offen offset:3072 nt
    v_exp_f32 v116, v116
    v_exp_f32 v124, v124
    v_exp_f32 v132, v132
    v_add_f32 v21, v21, v115
    v_add_f32 v22, v22, v123
    v_add_f32 v23, v23, v131
    v_cvt_pk_bf16_f32 v161, v114, v115
    v_cvt_pk_bf16_f32 v165, v122, v123
    v_cvt_pk_bf16_f32 v169, v130, v131
    v_exp_f32 v117, v117
    v_exp_f32 v125, v125
    v_exp_f32 v133, v133
    v_add_f32 v21, v21, v116
    v_add_f32 v22, v22, v124
    v_add_f32 v23, v23, v132
    v_exp_f32 v118, v118
    v_exp_f32 v126, v126
    v_exp_f32 v134, v134
    v_add_f32 v21, v21, v117
    v_add_f32 v22, v22, v125
    v_add_f32 v23, v23, v133
    v_cvt_pk_bf16_f32 v162, v116, v117
    v_cvt_pk_bf16_f32 v166, v124, v125
    v_cvt_pk_bf16_f32 v170, v132, v133
    v_exp_f32 v119, v119
    v_exp_f32 v127, v127
    v_exp_f32 v135, v135
    v_add_f32 v21, v21, v118
    v_add_f32 v22, v22, v126
    v_add_f32 v23, v23, v134
    v_add_f32 v21, v21, v119
    v_add_f32 v22, v22, v127
    v_add_f32 v23, v23, v135
    v_cvt_pk_bf16_f32 v163, v118, v119
    v_cvt_pk_bf16_f32 v167, v126, v127
    v_cvt_pk_bf16_f32 v171, v134, v135
    s_waitcnt lgkmcnt(7)
    v_mfma_f32_16x16x32_bf16 v[112:115], v[32:35], v[64:67], 0
    v_mfma_f32_16x16x32_bf16 v[120:123], v[32:35], v[80:83], 0
    v_mfma_f32_16x16x32_bf16 v[128:131], v[32:35], v[96:99], 0
    s_waitcnt lgkmcnt(6)
    v_mfma_f32_16x16x32_bf16 v[112:115], v[36:39], v[68:71], v[112:115]
    v_mfma_f32_16x16x32_bf16 v[120:123], v[36:39], v[84:87], v[120:123]
    v_mfma_f32_16x16x32_bf16 v[128:131], v[36:39], v[100:103], v[128:131]
    s_waitcnt lgkmcnt(5)
    v_mfma_f32_16x16x32_bf16 v[112:115], v[40:43], v[72:75], v[112:115]
    v_mfma_f32_16x16x32_bf16 v[120:123], v[40:43], v[88:91], v[120:123]
    v_mfma_f32_16x16x32_bf16 v[128:131], v[40:43], v[104:107], v[128:131]
    s_waitcnt lgkmcnt(4)
    v_mfma_f32_16x16x32_bf16 v[112:115], v[44:47], v[76:79], v[112:115]
    v_mfma_f32_16x16x32_bf16 v[120:123], v[44:47], v[92:95], v[120:123]
    v_mfma_f32_16x16x32_bf16 v[128:131], v[44:47], v[108:111], v[128:131]
    s_waitcnt lgkmcnt(3)
    v_mfma_f32_16x16x32_bf16 v[116:119], v[48:51], v[64:67], 0
    v_mfma_f32_16x16x32_bf16 v[124:127], v[48:51], v[80:83], 0
    v_mfma_f32_16x16x32_bf16 v[132:135], v[48:51], v[96:99], 0
    s_waitcnt lgkmcnt(2)
    v_mfma_f32_16x16x32_bf16 v[116:119], v[52:55], v[68:71], v[116:119]
    v_mfma_f32_16x16x32_bf16 v[124:127], v[52:55], v[84:87], v[124:127]
    v_mfma_f32_16x16x32_bf16 v[132:135], v[52:55], v[100:103], v[132:135]
    s_waitcnt lgkmcnt(1)
    v_mfma_f32_16x16x32_bf16 v[116:119], v[56:59], v[72:75], v[116:119]
    v_mfma_f32_16x16x32_bf16 v[124:127], v[56:59], v[88:91], v[124:127]
    v_mfma_f32_16x16x32_bf16 v[132:135], v[56:59], v[104:107], v[132:135]
    s_waitcnt lgkmcnt(0)
    v_mfma_f32_16x16x32_bf16 v[116:119], v[60:63], v[76:79], v[116:119]
    v_mfma_f32_16x16x32_bf16 v[124:127], v[60:63], v[92:95], v[124:127]
    v_mfma_f32_16x16x32_bf16 v[132:135], v[60:63], v[108:111], v[132:135]
    s_barrier
    s_waitcnt vmcnt(4)
    s_add_u32 s58, s61, 16384
    v_add_u32 v4, s58, v7
    ds_write_b128 v4, v[208:211] offset:0
    ds_write_b128 v4, v[212:215] offset:1024
    ds_write_b128 v4, v[216:219] offset:2048
    ds_write_b128 v4, v[220:223] offset:3072
    v_fma_f32 v112, v112, s59, -v18
    v_fma_f32 v120, v120, s59, -v19
    v_fma_f32 v128, v128, s59, -v20
    v_fma_f32 v113, v113, s59, -v18
    v_fma_f32 v121, v121, s59, -v19
    v_fma_f32 v129, v129, s59, -v20
    v_fma_f32 v114, v114, s59, -v18
    v_fma_f32 v122, v122, s59, -v19
    v_fma_f32 v130, v130, s59, -v20
    v_fma_f32 v115, v115, s59, -v18
    v_fma_f32 v123, v123, s59, -v19
    v_fma_f32 v131, v131, s59, -v20
    ds_read_b128 v[32:35], v12 offset:49152
    ds_read_b128 v[36:39], v13 offset:49152
    v_fma_f32 v116, v116, s59, -v18
    v_fma_f32 v124, v124, s59, -v19
    v_fma_f32 v132, v132, s59, -v20
    v_fma_f32 v117, v117, s59, -v18
    v_fma_f32 v125, v125, s59, -v19
    v_fma_f32 v133, v133, s59, -v20
    v_fma_f32 v118, v118, s59, -v18
    v_fma_f32 v126, v126, s59, -v19
    v_fma_f32 v134, v134, s59, -v20
    v_fma_f32 v119, v119, s59, -v18
    v_fma_f32 v127, v127, s59, -v19
    v_fma_f32 v135, v135, s59, -v20
    ds_read_b128 v[40:43], v14 offset:49152
    ds_read_b128 v[44:47], v15 offset:49152
    v_max3_f32 v136, v112, v113, v114
    v_max3_f32 v137, v120, v121, v122
    v_max3_f32 v138, v128, v129, v130
    v_max3_f32 v136, v136, v115, v116
    v_max3_f32 v137, v137, v123, v124
    v_max3_f32 v138, v138, v131, v132
    v_max3_f32 v136, v136, v117, v118
    v_max3_f32 v137, v137, v125, v126
    v_max3_f32 v138, v138, v133, v134
    v_max_f32 v136, v136, v119
    v_max_f32 v137, v137, v127
    v_max_f32 v138, v138, v135
    v_max3_f32 v139, v136, v137, v138
    v_cmp_lt_f32 vcc, s29, v139
    s_mov_b32 s28, 2
    s_nop 3
    s_cbranch_vccnz K1_SLOW_0
K1_RET2_0:
    ds_read_b128 v[48:51], v12 offset:53248
    ds_read_b128 v[52:55], v13 offset:53248
    v_exp_f32 v112, v112
    v_exp_f32 v120, v120
    v_exp_f32 v128, v128
    ds_read_b128 v[56:59], v14 offset:53248
    ds_read_b128 v[60:63], v15 offset:53248
    s_xor_b32 s64, s55, 114688
    buffer_load_dwordx4 v[240:243], v8, s[8:11], s64 offen offset:0 nt
    v_exp_f32 v113, v113
    v_exp_f32 v121, v121
    v_exp_f32 v129, v129
    v_add_f32 v21, v21, v112
    v_add_f32 v22, v22, v120
    v_add_f32 v23, v23, v128
    s_xor_b32 s64, s55, 114688
    buffer_load_dwordx4 v[244:247], v9, s[8:11], s64 offen offset:1024 nt
    v_exp_f32 v114, v114
    v_exp_f32 v122, v122
    v_exp_f32 v130, v130
    v_add_f32 v21, v21, v113
    v_add_f32 v22, v22, v121
    v_add_f32 v23, v23, v129
    v_cvt_pk_bf16_f32 v172, v112, v113
    v_cvt_pk_bf16_f32 v176, v120, v121
    v_cvt_pk_bf16_f32 v180, v128, v129
    s_xor_b32 s64, s55, 114688
    buffer_load_dwordx4 v[248:251], v10, s[8:11], s64 offen offset:2048 nt
    v_exp_f32 v115, v115
    v_exp_f32 v123, v123
    v_exp_f32 v131, v131
    v_add_f32 v21, v21, v114
    v_add_f32 v22, v22, v122
    v_add_f32 v23, v23, v130
    s_xor_b32 s64, s55, 114688
    buffer_load_dwordx4 v[252:255], v11, s[8:11], s64 offen offset:3072 nt
    v_exp_f32 v116, v116
    v_exp_f32 v124, v124
    v_exp_f32 v132, v132
    v_add_f32 v21, v21, v115
    v_add_f32 v22, v22, v123
    v_add_f32 v23, v23, v131
    v_cvt_pk_bf16_f32 v173, v114, v115
    v_cvt_pk_bf16_f32 v177, v122, v123
    v_cvt_pk_bf16_f32 v181, v130, v131
    v_exp_f32 v117, v117
    v_exp_f32 v125, v125
    v_exp_f32 v133, v133
    v_add_f32 v21, v21, v116
    v_add_f32 v22, v22, v124
    v_add_f32 v23, v23, v132
    v_exp_f32 v118, v118
    v_exp_f32 v126, v126
    v_exp_f32 v134, v134
    v_add_f32 v21, v21, v117
    v_add_f32 v22, v22, v125
    v_add_f32 v23, v23, v133
    v_cvt_pk_bf16_f32 v174, v116, v117
    v_cvt_pk_bf16_f32 v178, v124, v125
    v_cvt_pk_bf16_f32 v182, v132, v133
    v_exp_f32 v119, v119
    v_exp_f32 v127, v127
    v_exp_f32 v135, v135
    v_add_f32 v21, v21, v118
    v_add_f32 v22, v22, v126
    v_add_f32 v23, v23, v134
    v_add_f32 v21, v21, v119
    v_add_f32 v22, v22, v127
    v_add_f32 v23, v23, v135
    v_cvt_pk_bf16_f32 v175, v118, v119
    v_cvt_pk_bf16_f32 v179, v126, v127
    v_cvt_pk_bf16_f32 v183, v134, v135
    s_waitcnt lgkmcnt(7)
    v_mfma_f32_16x16x32_bf16 v[112:115], v[32:35], v[64:67], 0
    v_mfma_f32_16x16x32_bf16 v[120:123], v[32:35], v[80:83], 0
    v_mfma_f32_16x16x32_bf16 v[128:131], v[32:35], v[96:99], 0
    s_waitcnt lgkmcnt(6)
    v_mfma_f32_16x16x32_bf16 v[112:115], v[36:39], v[68:71], v[112:115]
    v_mfma_f32_16x16x32_bf16 v[120:123], v[36:39], v[84:87], v[120:123]
    v_mfma_f32_16x16x32_bf16 v[128:131], v[36:39], v[100:103], v[128:131]
    s_waitcnt lgkmcnt(5)
    v_mfma_f32_16x16x32_bf16 v[112:115], v[40:43], v[72:75], v[112:115]
    v_mfma_f32_16x16x32_bf16 v[120:123], v[40:43], v[88:91], v[120:123]
    v_mfma_f32_16x16x32_bf16 v[128:131], v[40:43], v[104:107], v[128:131]
    s_waitcnt lgkmcnt(4)
    v_mfma_f32_16x16x32_bf16 v[112:115], v[44:47], v[76:79], v[112:115]
    v_mfma_f32_16x16x32_bf16 v[120:123], v[44:47], v[92:95], v[120:123]
    v_mfma_f32_16x16x32_bf16 v[128:131], v[44:47], v[108:111], v[128:131]
    s_waitcnt lgkmcnt(3)
    v_mfma_f32_16x16x32_bf16 v[116:119], v[48:51], v[64:67], 0
    v_mfma_f32_16x16x32_bf16 v[124:127], v[48:51], v[80:83], 0
    v_mfma_f32_16x16x32_bf16 v[132:135], v[48:51], v[96:99], 0
    s_waitcnt lgkmcnt(2)
    v_mfma_f32_16x16x32_bf16 v[116:119], v[52:55], v[68:71], v[116:119]
    v_mfma_f32_16x16x32_bf16 v[124:127], v[52:55], v[84:87], v[124:127]
    v_mfma_f32_16x16x32_bf16 v[132:135], v[52:55], v[100:103], v[132:135]
    s_waitcnt lgkmcnt(1)
    v_mfma_f32_16x16x32_bf16 v[116:119], v[56:59], v[72:75], v[116:119]
    v_mfma_f32_16x16x32_bf16 v[124:127], v[56:59], v[88:91], v[124:127]
    v_mfma_f32_16x16x32_bf16 v[132:135], v[56:59], v[104:107], v[132:135]
    s_waitcnt lgkmcnt(0)
    v_mfma_f32_16x16x32_bf16 v[116:119], v[60:63], v[76:79], v[116:119]
    v_mfma_f32_16x16x32_bf16 v[124:127], v[60:63], v[92:95], v[124:127]
    v_mfma_f32_16x16x32_bf16 v[132:135], v[60:63], v[108:111], v[132:135]
    s_barrier
    s_waitcnt vmcnt(4)
    s_add_u32 s58, s61, 32768
    v_add_u32 v4, s58, v7
    ds_write_b128 v4, v[224:227] offset:0
    ds_write_b128 v4, v[228:231] offset:1024
    ds_write_b128 v4, v[232:235] offset:2048
    ds_write_b128 v4, v[236:239] offset:3072
    v_fma_f32 v112, v112, s59, -v18
    v_fma_f32 v120, v120, s59, -v19
    v_fma_f32 v128, v128, s59, -v20
    v_fma_f32 v113, v113, s59, -v18
    v_fma_f32 v121, v121, s59, -v19
    v_fma_f32 v129, v129, s59, -v20
    v_fma_f32 v114, v114, s59, -v18
    v_fma_f32 v122, v122, s59, -v19
    v_fma_f32 v130, v130, s59, -v20
    v_fma_f32 v115, v115, s59, -v18
    v_fma_f32 v123, v123, s59, -v19
    v_fma_f32 v131, v131, s59, -v20
    ds_read_b128 v[32:35], v12 offset:0
    ds_read_b128 v[36:39], v13 offset:0
    v_fma_f32 v116, v116, s59, -v18
    v_fma_f32 v124, v124, s59, -v19
    v_fma_f32 v132, v132, s59, -v20
    v_fma_f32 v117, v117, s59, -v18
    v_fma_f32 v125, v125, s59, -v19
    v_fma_f32 v133, v133, s59, -v20
    v_fma_f32 v118, v118, s59, -v18
    v_fma_f32 v126, v126, s59, -v19
    v_fma_f32 v134, v134, s59, -v20
    v_fma_f32 v119, v119, s59, -v18
    v_fma_f32 v127, v127, s59, -v19
    v_fma_f32 v135, v135, s59, -v20
    ds_read_b128 v[40:43], v14 offset:0
    ds_read_b128 v[44:47], v15 offset:0
    v_max3_f32 v136, v112, v113, v114
    v_max3_f32 v137, v120, v121, v122
    v_max3_f32 v138, v128, v129, v130
    v_max3_f32 v136, v136, v115, v116
    v_max3_f32 v137, v137, v123, v124
    v_max3_f32 v138, v138, v131, v132
    v_max3_f32 v136, v136, v117, v118
    v_max3_f32 v137, v137, v125, v126
    v_max3_f32 v138, v138, v133, v134
    v_max_f32 v136, v136, v119
    v_max_f32 v137, v137, v127
    v_max_f32 v138, v138, v135
    v_max3_f32 v139, v136, v137, v138
    v_cmp_lt_f32 vcc, s29, v139
    s_mov_b32 s28, 3
    s_nop 3
    s_cbranch_vccnz K1_SLOW_0
K1_RET3_0:
    ds_read_b128 v[48:51], v12 offset:4096
    ds_read_b128 v[52:55], v13 offset:4096
    v_exp_f32 v112, v112
    v_exp_f32 v120, v120
    v_exp_f32 v128, v128
    ds_read_b128 v[56:59], v14 offset:4096
    ds_read_b128 v[60:63], v15 offset:4096
    s_add_u32 m0, s61, 131072
    s_mov_b32 s64, s55
    buffer_load_dwordx4 v16, s[12:15], s64 offen offset:0 nt lds
    v_exp_f32 v113, v113
    v_exp_f32 v121, v121
    v_exp_f32 v129, v129
    v_add_f32 v21, v21, v112
    v_add_f32 v22, v22, v120
    v_add_f32 v23, v23, v128
    s_add_u32 m0, s61, 131072
    s_mov_b32 s64, s55
    buffer_load_dwordx4 v17, s[12:15], s64 offen offset:1024 nt lds
    v_exp_f32 v114, v114
    v_exp_f32 v122, v122
    v_exp_f32 v130, v130
    v_add_f32 v21, v21, v113
    v_add_f32 v22, v22, v121
    v_add_f32 v23, v23, v129
    v_cvt_pk_bf16_f32 v184, v112, v113
    v_cvt_pk_bf16_f32 v188, v120, v121
    v_cvt_pk_bf16_f32 v192, v128, v129
    s_add_u32 m0, s61, 131072
    s_mov_b32 s64, s55
    buffer_load_dwordx4 v16, s[12:15], s64 offen offset:2048 nt lds
    v_exp_f32 v115, v115
    v_exp_f32 v123, v123
    v_exp_f32 v131, v131
    v_add_f32 v21, v21, v114
    v_add_f32 v22, v22, v122
    v_add_f32 v23, v23, v130
    s_add_u32 m0, s61, 131072
    s_mov_b32 s64, s55
    buffer_load_dwordx4 v17, s[12:15], s64 offen offset:3072 nt lds
    v_exp_f32 v116, v116
    v_exp_f32 v124, v124
    v_exp_f32 v132, v132
    v_add_f32 v21, v21, v115
    v_add_f32 v22, v22, v123
    v_add_f32 v23, v23, v131
    v_cvt_pk_bf16_f32 v185, v114, v115
    v_cvt_pk_bf16_f32 v189, v122, v123
    v_cvt_pk_bf16_f32 v193, v130, v131
    v_exp_f32 v117, v117
    v_exp_f32 v125, v125
    v_exp_f32 v133, v133
    v_add_f32 v21, v21, v116
    v_add_f32 v22, v22, v124
    v_add_f32 v23, v23, v132
    v_exp_f32 v118, v118
    v_exp_f32 v126, v126
    v_exp_f32 v134, v134
    v_add_f32 v21, v21, v117
    v_add_f32 v22, v22, v125
    v_add_f32 v23, v23, v133
    v_cvt_pk_bf16_f32 v186, v116, v117
    v_cvt_pk_bf16_f32 v190, v124, v125
    v_cvt_pk_bf16_f32 v194, v132, v133
    v_exp_f32 v119, v119
    v_exp_f32 v127, v127
    v_exp_f32 v135, v135
    v_add_f32 v21, v21, v118
    v_add_f32 v22, v22, v126
    v_add_f32 v23, v23, v134
    v_add_f32 v21, v21, v119
    v_add_f32 v22, v22, v127
    v_add_f32 v23, v23, v135
    v_cvt_pk_bf16_f32 v187, v118, v119
    v_cvt_pk_bf16_f32 v191, v126, v127
    v_cvt_pk_bf16_f32 v195, v134, v135
    s_waitcnt lgkmcnt(7)
    v_mfma_f32_16x16x32_bf16 v[112:115], v[32:35], v[64:67], 0
    v_mfma_f32_16x16x32_bf16 v[120:123], v[32:35], v[80:83], 0
    v_mfma_f32_16x16x32_bf16 v[128:131], v[32:35], v[96:99], 0
    s_waitcnt lgkmcnt(6)
    v_mfma_f32_16x16x32_bf16 v[112:115], v[36:39], v[68:71], v[112:115]
    v_mfma_f32_16x16x32_bf16 v[120:123], v[36:39], v[84:87], v[120:123]
    v_mfma_f32_16x16x32_bf16 v[128:131], v[36:39], v[100:103], v[128:131]
    s_waitcnt lgkmcnt(5)
    v_mfma_f32_16x16x32_bf16 v[112:115], v[40:43], v[72:75], v[112:115]
    v_mfma_f32_16x16x32_bf16 v[120:123], v[40:43], v[88:91], v[120:123]
    v_mfma_f32_16x16x32_bf16 v[128:131], v[40:43], v[104:107], v[128:131]
    s_waitcnt lgkmcnt(4)
    v_mfma_f32_16x16x32_bf16 v[112:115], v[44:47], v[76:79], v[112:115]
    v_mfma_f32_16x16x32_bf16 v[120:123], v[44:47], v[92:95], v[120:123]
    v_mfma_f32_16x16x32_bf16 v[128:131], v[44:47], v[108:111], v[128:131]
    s_waitcnt lgkmcnt(3)
    v_mfma_f32_16x16x32_bf16 v[116:119], v[48:51], v[64:67], 0
    v_mfma_f32_16x16x32_bf16 v[124:127], v[48:51], v[80:83], 0
    v_mfma_f32_16x16x32_bf16 v[132:135], v[48:51], v[96:99], 0
    s_waitcnt lgkmcnt(2)
    v_mfma_f32_16x16x32_bf16 v[116:119], v[52:55], v[68:71], v[116:119]
    v_mfma_f32_16x16x32_bf16 v[124:127], v[52:55], v[84:87], v[124:127]
    v_mfma_f32_16x16x32_bf16 v[132:135], v[52:55], v[100:103], v[132:135]
    s_waitcnt lgkmcnt(1)
    v_mfma_f32_16x16x32_bf16 v[116:119], v[56:59], v[72:75], v[116:119]
    v_mfma_f32_16x16x32_bf16 v[124:127], v[56:59], v[88:91], v[124:127]
    v_mfma_f32_16x16x32_bf16 v[132:135], v[56:59], v[104:107], v[132:135]
    s_waitcnt lgkmcnt(0)
    v_mfma_f32_16x16x32_bf16 v[116:119], v[60:63], v[76:79], v[116:119]
    v_mfma_f32_16x16x32_bf16 v[124:127], v[60:63], v[92:95], v[124:127]
    v_mfma_f32_16x16x32_bf16 v[132:135], v[60:63], v[108:111], v[132:135]
    s_barrier
    s_waitcnt vmcnt(4)
    s_add_u32 s58, s61, 49152
    v_add_u32 v4, s58, v7
    ds_write_b128 v4, v[240:243] offset:0
    ds_write_b128 v4, v[244:247] offset:1024
    ds_write_b128 v4, v[248:251] offset:2048
    ds_write_b128 v4, v[252:255] offset:3072
    v_fma_f32 v112, v112, s59, -v18
    v_fma_f32 v120, v120, s59, -v19
    v_fma_f32 v128, v128, s59, -v20
    v_fma_f32 v113, v113, s59, -v18
    v_fma_f32 v121, v121, s59, -v19
    v_fma_f32 v129, v129, s59, -v20
    v_fma_f32 v114, v114, s59, -v18
    v_fma_f32 v122, v122, s59, -v19
    v_fma_f32 v130, v130, s59, -v20
    v_fma_f32 v115, v115, s59, -v18
    v_fma_f32 v123, v123, s59, -v19
    v_fma_f32 v131, v131, s59, -v20
    ds_read_b128 v[32:35], v12 offset:16384
    ds_read_b128 v[36:39], v13 offset:16384
    v_fma_f32 v116, v116, s59, -v18
    v_fma_f32 v124, v124, s59, -v19
    v_fma_f32 v132, v132, s59, -v20
    v_fma_f32 v117, v117, s59, -v18
    v_fma_f32 v125, v125, s59, -v19
    v_fma_f32 v133, v133, s59, -v20
    v_fma_f32 v118, v118, s59, -v18
    v_fma_f32 v126, v126, s59, -v19
    v_fma_f32 v134, v134, s59, -v20
    v_fma_f32 v119, v119, s59, -v18
    v_fma_f32 v127, v127, s59, -v19
    v_fma_f32 v135, v135, s59, -v20
    ds_read_b128 v[40:43], v14 offset:16384
    ds_read_b128 v[44:47], v15 offset:16384
    v_max3_f32 v136, v112, v113, v114
    v_max3_f32 v137, v120, v121, v122
    v_max3_f32 v138, v128, v129, v130
    v_max3_f32 v136, v136, v115, v116
    v_max3_f32 v137, v137, v123, v124
    v_max3_f32 v138, v138, v131, v132
    v_max3_f32 v136, v136, v117, v118
    v_max3_f32 v137, v137, v125, v126
    v_max3_f32 v138, v138, v133, v134
    v_max_f32 v136, v136, v119
    v_max_f32 v137, v137, v127
    v_max_f32 v138, v138, v135
    v_max3_f32 v139, v136, v137, v138
    v_cmp_lt_f32 vcc, s29, v139
    s_mov_b32 s28, 4
    s_nop 3
    s_cbranch_vccnz K1_SLOW_0
K1_RET4_0:
    ds_read_b128 v[48:51], v12 offset:20480
    ds_read_b128 v[52:55], v13 offset:20480
    v_exp_f32 v112, v112
    v_exp_f32 v120, v120
    v_exp_f32 v128, v128
    ds_read_b128 v[56:59], v14 offset:20480
    ds_read_b128 v[60:63], v15 offset:20480
    s_mov_b32 m0, s61
    s_xor_b32 s64, s55, 16384
    buffer_load_dwordx4 v16, s[12:15], s64 offen offset:0 nt lds
    v_exp_f32 v113, v113
    v_exp_f32 v121, v121
    v_exp_f32 v129, v129
    v_add_f32 v21, v21, v112
    v_add_f32 v22, v22, v120
    v_add_f32 v23, v23, v128
    s_mov_b32 m0, s61
    s_xor_b32 s64, s55, 16384
    buffer_load_dwordx4 v17, s[12:15], s64 offen offset:1024 nt lds
    v_exp_f32 v114, v114
    v_exp_f32 v122, v122
    v_exp_f32 v130, v130
    v_add_f32 v21, v21, v113
    v_add_f32 v22, v22, v121
    v_add_f32 v23, v23, v129
    v_cvt_pk_bf16_f32 v196, v112, v113
    v_cvt_pk_bf16_f32 v200, v120, v121
    v_cvt_pk_bf16_f32 v204, v128, v129
    s_mov_b32 m0, s61
    s_xor_b32 s64, s55, 16384
    buffer_load_dwordx4 v16, s[12:15], s64 offen offset:2048 nt lds
    v_exp_f32 v115, v115
    v_exp_f32 v123, v123
    v_exp_f32 v131, v131
    v_add_f32 v21, v21, v114
    v_add_f32 v22, v22, v122
    v_add_f32 v23, v23, v130
    s_mov_b32 m0, s61
    s_xor_b32 s64, s55, 16384
    buffer_load_dwordx4 v17, s[12:15], s64 offen offset:3072 nt lds
    v_exp_f32 v116, v116
    v_exp_f32 v124, v124
    v_exp_f32 v132, v132
    v_add_f32 v21, v21, v115
    v_add_f32 v22, v22, v123
    v_add_f32 v23, v23, v131
    v_cvt_pk_bf16_f32 v197, v114, v115
    v_cvt_pk_bf16_f32 v201, v122, v123
    v_cvt_pk_bf16_f32 v205, v130, v131
    v_exp_f32 v117, v117
    v_exp_f32 v125, v125
    v_exp_f32 v133, v133
    v_add_f32 v21, v21, v116
    v_add_f32 v22, v22, v124
    v_add_f32 v23, v23, v132
    v_exp_f32 v118, v118
    v_exp_f32 v126, v126
    v_exp_f32 v134, v134
    v_add_f32 v21, v21, v117
    v_add_f32 v22, v22, v125
    v_add_f32 v23, v23, v133
    v_cvt_pk_bf16_f32 v198, v116, v117
    v_cvt_pk_bf16_f32 v202, v124, v125
    v_cvt_pk_bf16_f32 v206, v132, v133
    v_exp_f32 v119, v119
    v_exp_f32 v127, v127
    v_exp_f32 v135, v135
    v_add_f32 v21, v21, v118
    v_add_f32 v22, v22, v126
    v_add_f32 v23, v23, v134
    v_add_f32 v21, v21, v119
    v_add_f32 v22, v22, v127
    v_add_f32 v23, v23, v135
    v_cvt_pk_bf16_f32 v199, v118, v119
    v_cvt_pk_bf16_f32 v203, v126, v127
    v_cvt_pk_bf16_f32 v207, v134, v135
    s_waitcnt lgkmcnt(7)
    v_mfma_f32_16x16x32_bf16 v[112:115], v[32:35], v[64:67], 0
    v_mfma_f32_16x16x32_bf16 v[120:123], v[32:35], v[80:83], 0
    v_mfma_f32_16x16x32_bf16 v[128:131], v[32:35], v[96:99], 0
    s_waitcnt lgkmcnt(6)
    v_mfma_f32_16x16x32_bf16 v[112:115], v[36:39], v[68:71], v[112:115]
    v_mfma_f32_16x16x32_bf16 v[120:123], v[36:39], v[84:87], v[120:123]
    v_mfma_f32_16x16x32_bf16 v[128:131], v[36:39], v[100:103], v[128:131]
    s_waitcnt lgkmcnt(5)
    v_mfma_f32_16x16x32_bf16 v[112:115], v[40:43], v[72:75], v[112:115]
    v_mfma_f32_16x16x32_bf16 v[120:123], v[40:43], v[88:91], v[120:123]
    v_mfma_f32_16x16x32_bf16 v[128:131], v[40:43], v[104:107], v[128:131]
    s_waitcnt lgkmcnt(4)
    v_mfma_f32_16x16x32_bf16 v[112:115], v[44:47], v[76:79], v[112:115]
    v_mfma_f32_16x16x32_bf16 v[120:123], v[44:47], v[92:95], v[120:123]
    v_mfma_f32_16x16x32_bf16 v[128:131], v[44:47], v[108:111], v[128:131]
    s_waitcnt lgkmcnt(3)
    v_mfma_f32_16x16x32_bf16 v[116:119], v[48:51], v[64:67], 0
    v_mfma_f32_16x16x32_bf16 v[124:127], v[48:51], v[80:83], 0
    v_mfma_f32_16x16x32_bf16 v[132:135], v[48:51], v[96:99], 0
    s_waitcnt lgkmcnt(2)
    v_mfma_f32_16x16x32_bf16 v[116:119], v[52:55], v[68:71], v[116:119]
    v_mfma_f32_16x16x32_bf16 v[124:127], v[52:55], v[84:87], v[124:127]
    v_mfma_f32_16x16x32_bf16 v[132:135], v[52:55], v[100:103], v[132:135]
    s_waitcnt lgkmcnt(1)
    v_mfma_f32_16x16x32_bf16 v[116:119], v[56:59], v[72:75], v[116:119]
    v_mfma_f32_16x16x32_bf16 v[124:127], v[56:59], v[88:91], v[124:127]
    v_mfma_f32_16x16x32_bf16 v[132:135], v[56:59], v[104:107], v[132:135]
    s_waitcnt lgkmcnt(0)
    v_mfma_f32_16x16x32_bf16 v[116:119], v[60:63], v[76:79], v[116:119]
    v_mfma_f32_16x16x32_bf16 v[124:127], v[60:63], v[92:95], v[124:127]
    v_mfma_f32_16x16x32_bf16 v[132:135], v[60:63], v[108:111], v[132:135]
    s_barrier
    v_fma_f32 v112, v112, s59, -v18
    v_fma_f32 v120, v120, s59, -v19
    v_fma_f32 v128, v128, s59, -v20
    v_fma_f32 v113, v113, s59, -v18
    v_fma_f32 v121, v121, s59, -v19
    v_fma_f32 v129, v129, s59, -v20
    v_fma_f32 v114, v114, s59, -v18
    v_fma_f32 v122, v122, s59, -v19
    v_fma_f32 v130, v130, s59, -v20
    v_fma_f32 v115, v115, s59, -v18
    v_fma_f32 v123, v123, s59, -v19
    v_fma_f32 v131, v131, s59, -v20
    ds_read_b128 v[32:35], v12 offset:32768
    ds_read_b128 v[36:39], v13 offset:32768
    v_fma_f32 v116, v116, s59, -v18
    v_fma_f32 v124, v124, s59, -v19
    v_fma_f32 v132, v132, s59, -v20
    v_fma_f32 v117, v117, s59, -v18
    v_fma_f32 v125, v125, s59, -v19
    v_fma_f32 v133, v133, s59, -v20
    v_fma_f32 v118, v118, s59, -v18
    v_fma_f32 v126, v126, s59, -v19
    v_fma_f32 v134, v134, s59, -v20
    v_fma_f32 v119, v119, s59, -v18
    v_fma_f32 v127, v127, s59, -v19
    v_fma_f32 v135, v135, s59, -v20
    ds_read_b128 v[40:43], v14 offset:32768
    ds_read_b128 v[44:47], v15 offset:32768
    v_max3_f32 v136, v112, v113, v114
    v_max3_f32 v137, v120, v121, v122
    v_max3_f32 v138, v128, v129, v130
    v_max3_f32 v136, v136, v115, v116
    v_max3_f32 v137, v137, v123, v124
    v_max3_f32 v138, v138, v131, v132
    v_max3_f32 v136, v136, v117, v118
    v_max3_f32 v137, v137, v125, v126
    v_max3_f32 v138, v138, v133, v134
    v_max_f32 v136, v136, v119
    v_max_f32 v137, v137, v127
    v_max_f32 v138, v138, v135
    v_max3_f32 v139, v136, v137, v138
    v_cmp_lt_f32 vcc, s29, v139
    s_mov_b32 s28, 5
    s_nop 3
    s_cbranch_vccnz K1_SLOW_0
K1_RET5_0:
    ds_read_b128 v[48:51], v12 offset:36864
    ds_read_b128 v[52:55], v13 offset:36864
    v_exp_f32 v112, v112
    v_exp_f32 v120, v120
    v_exp_f32 v128, v128
    ds_read_b128 v[56:59], v14 offset:36864
    ds_read_b128 v[60:63], v15 offset:36864
    s_add_u32 m0, s61, 16384
    s_xor_b32 s64, s55, 32768
    buffer_load_dwordx4 v16, s[12:15], s64 offen offset:0 nt lds
    v_exp_f32 v113, v113
    v_exp_f32 v121, v121
    v_exp_f32 v129, v129
    v_add_f32 v21, v21, v112
    v_add_f32 v22, v22, v120
    v_add_f32 v23, v23, v128
    s_add_u32 m0, s61, 16384
    s_xor_b32 s64, s55, 32768
    buffer_load_dwordx4 v17, s[12:15], s64 offen offset:1024 nt lds
    v_exp_f32 v114, v114
    v_exp_f32 v122, v122
    v_exp_f32 v130, v130
    v_add_f32 v21, v21, v113
    v_add_f32 v22, v22, v121
    v_add_f32 v23, v23, v129
    v_cvt_pk_bf16_f32 v208, v112, v113
    v_cvt_pk_bf16_f32 v212, v120, v121
    v_cvt_pk_bf16_f32 v216, v128, v129
    s_add_u32 m0, s61, 16384
    s_xor_b32 s64, s55, 32768
    buffer_load_dwordx4 v16, s[12:15], s64 offen offset:2048 nt lds
    v_exp_f32 v115, v115
    v_exp_f32 v123, v123
    v_exp_f32 v131, v131
    v_add_f32 v21, v21, v114
    v_add_f32 v22, v22, v122
    v_add_f32 v23, v23, v130
    s_add_u32 m0, s61, 16384
    s_xor_b32 s64, s55, 32768
    buffer_load_dwordx4 v17, s[12:15], s64 offen offset:3072 nt lds
    v_exp_f32 v116, v116
    v_exp_f32 v124, v124
    v_exp_f32 v132, v132
    v_add_f32 v21, v21, v115
    v_add_f32 v22, v22, v123
    v_add_f32 v23, v23, v131
    v_cvt_pk_bf16_f32 v209, v114, v115
    v_cvt_pk_bf16_f32 v213, v122, v123
    v_cvt_pk_bf16_f32 v217, v130, v131
    v_exp_f32 v117, v117
    v_exp_f32 v125, v125
    v_exp_f32 v133, v133
    v_add_f32 v21, v21, v116
    v_add_f32 v22, v22, v124
    v_add_f32 v23, v23, v132
    v_exp_f32 v118, v118
    v_exp_f32 v126, v126
    v_exp_f32 v134, v134
    v_add_f32 v21, v21, v117
    v_add_f32 v22, v22, v125
    v_add_f32 v23, v23, v133
    v_cvt_pk_bf16_f32 v210, v116, v117
    v_cvt_pk_bf16_f32 v214, v124, v125
    v_cvt_pk_bf16_f32 v218, v132, v133
    v_exp_f32 v119, v119
    v_exp_f32 v127, v127
    v_exp_f32 v135, v135
    v_add_f32 v21, v21, v118
    v_add_f32 v22, v22, v126
    v_add_f32 v23, v23, v134
    v_add_f32 v21, v21, v119
    v_add_f32 v22, v22, v127
    v_add_f32 v23, v23, v135
    v_cvt_pk_bf16_f32 v211, v118, v119
    v_cvt_pk_bf16_f32 v215, v126, v127
    v_cvt_pk_bf16_f32 v219, v134, v135
    s_waitcnt lgkmcnt(7)
    v_mfma_f32_16x16x32_bf16 v[112:115], v[32:35], v[64:67], 0
    v_mfma_f32_16x16x32_bf16 v[120:123], v[32:35], v[80:83], 0
    v_mfma_f32_16x16x32_bf16 v[128:131], v[32:35], v[96:99], 0
    s_waitcnt lgkmcnt(6)
    v_mfma_f32_16x16x32_bf16 v[112:115], v[36:39], v[68:71], v[112:115]
    v_mfma_f32_16x16x32_bf16 v[120:123], v[36:39], v[84:87], v[120:123]
    v_mfma_f32_16x16x32_bf16 v[128:131], v[36:39], v[100:103], v[128:131]
    s_waitcnt lgkmcnt(5)
    v_mfma_f32_16x16x32_bf16 v[112:115], v[40:43], v[72:75], v[112:115]
    v_mfma_f32_16x16x32_bf16 v[120:123], v[40:43], v[88:91], v[120:123]
    v_mfma_f32_16x16x32_bf16 v[128:131], v[40:43], v[104:107], v[128:131]
    s_waitcnt lgkmcnt(4)
    v_mfma_f32_16x16x32_bf16 v[112:115], v[44:47], v[76:79], v[112:115]
    v_mfma_f32_16x16x32_bf16 v[120:123], v[44:47], v[92:95], v[120:123]
    v_mfma_f32_16x16x32_bf16 v[128:131], v[44:47], v[108:111], v[128:131]
    s_waitcnt lgkmcnt(3)
    v_mfma_f32_16x16x32_bf16 v[116:119], v[48:51], v[64:67], 0
    v_mfma_f32_16x16x32_bf16 v[124:127], v[48:51], v[80:83], 0
    v_mfma_f32_16x16x32_bf16 v[132:135], v[48:51], v[96:99], 0
    s_waitcnt lgkmcnt(2)
    v_mfma_f32_16x16x32_bf16 v[116:119], v[52:55], v[68:71], v[116:119]
    v_mfma_f32_16x16x32_bf16 v[124:127], v[52:55], v[84:87], v[124:127]
    v_mfma_f32_16x16x32_bf16 v[132:135], v[52:55], v[100:103], v[132:135]
    s_waitcnt lgkmcnt(1)
    v_mfma_f32_16x16x32_bf16 v[116:119], v[56:59], v[72:75], v[116:119]
    v_mfma_f32_16x16x32_bf16 v[124:127], v[56:59], v[88:91], v[124:127]
    v_mfma_f32_16x16x32_bf16 v[132:135], v[56:59], v[104:107], v[132:135]
    s_waitcnt lgkmcnt(0)
    v_mfma_f32_16x16x32_bf16 v[116:119], v[60:63], v[76:79], v[116:119]
    v_mfma_f32_16x16x32_bf16 v[124:127], v[60:63], v[92:95], v[124:127]
    v_mfma_f32_16x16x32_bf16 v[132:135], v[60:63], v[108:111], v[132:135]
    s_barrier
    v_fma_f32 v112, v112, s59, -v18
    v_fma_f32 v120, v120, s59, -v19
    v_fma_f32 v128, v128, s59, -v20
    v_fma_f32 v113, v113, s59, -v18
    v_fma_f32 v121, v121, s59, -v19
    v_fma_f32 v129, v129, s59, -v20
    v_fma_f32 v114, v114, s59, -v18
    v_fma_f32 v122, v122, s59, -v19
    v_fma_f32 v130, v130, s59, -v20
    v_fma_f32 v115, v115, s59, -v18
    v_fma_f32 v123, v123, s59, -v19
    v_fma_f32 v131, v131, s59, -v20
    ds_read_b128 v[32:35], v12 offset:49152
    ds_read_b128 v[36:39], v13 offset:49152
    v_fma_f32 v116, v116, s59, -v18
    v_fma_f32 v124, v124, s59, -v19
    v_fma_f32 v132, v132, s59, -v20
    v_fma_f32 v117, v117, s59, -v18
    v_fma_f32 v125, v125, s59, -v19
    v_fma_f32 v133, v133, s59, -v20
    v_fma_f32 v118, v118, s59, -v18
    v_fma_f32 v126, v126, s59, -v19
    v_fma_f32 v134, v134, s59, -v20
    v_fma_f32 v119, v119, s59, -v18
    v_fma_f32 v127, v127, s59, -v19
    v_fma_f32 v135, v135, s59, -v20
    ds_read_b128 v[40:43], v14 offset:49152
    ds_read_b128 v[44:47], v15 offset:49152
    v_max3_f32 v136, v112, v113, v114
    v_max3_f32 v137, v120, v121, v122
    v_max3_f32 v138, v128, v129, v130
    v_max3_f32 v136, v136, v115, v116
    v_max3_f32 v137, v137, v123, v124
    v_max3_f32 v138, v138, v131, v132
    v_max3_f32 v136, v136, v117, v118
    v_max3_f32 v137, v137, v125, v126
    v_max3_f32 v138, v138, v133, v134
    v_max_f32 v136, v136, v119
    v_max_f32 v137, v137, v127
    v_max_f32 v138, v138, v135
    v_max3_f32 v139, v136, v137, v138
    v_cmp_lt_f32 vcc, s29, v139
    s_mov_b32 s28, 6
    s_nop 3
    s_cbranch_vccnz K1_SLOW_0
K1_RET6_0:
    ds_read_b128 v[48:51], v12 offset:53248
    ds_read_b128 v[52:55], v13 offset:53248
    v_exp_f32 v112, v112
    v_exp_f32 v120, v120
    v_exp_f32 v128, v128
    ds_read_b128 v[56:59], v14 offset:53248
    ds_read_b128 v[60:63], v15 offset:53248
    s_add_u32 m0, s61, 32768
    s_xor_b32 s64, s55, 49152
    buffer_load_dwordx4 v16, s[12:15], s64 offen offset:0 nt lds
    v_exp_f32 v113, v113
    v_exp_f32 v121, v121
    v_exp_f32 v129, v129
    v_add_f32 v21, v21, v112
    v_add_f32 v22, v22, v120
    v_add_f32 v23, v23, v128
    s_add_u32 m0, s61, 32768
    s_xor_b32 s64, s55, 49152
    buffer_load_dwordx4 v17, s[12:15], s64 offen offset:1024 nt lds
    v_exp_f32 v114, v114
    v_exp_f32 v122, v122
    v_exp_f32 v130, v130
    v_add_f32 v21, v21, v113
    v_add_f32 v22, v22, v121
    v_add_f32 v23, v23, v129
    v_cvt_pk_bf16_f32 v220, v112, v113
    v_cvt_pk_bf16_f32 v224, v120, v121
    v_cvt_pk_bf16_f32 v228, v128, v129
    s_add_u32 m0, s61, 32768
    s_xor_b32 s64, s55, 49152
    buffer_load_dwordx4 v16, s[12:15], s64 offen offset:2048 nt lds
    v_exp_f32 v115, v115
    v_exp_f32 v123, v123
    v_exp_f32 v131, v131
    v_add_f32 v21, v21, v114
    v_add_f32 v22, v22, v122
    v_add_f32 v23, v23, v130
    s_add_u32 m0, s61, 32768
    s_xor_b32 s64, s55, 49152
    buffer_load_dwordx4 v17, s[12:15], s64 offen offset:3072 nt lds
    v_exp_f32 v116, v116
    v_exp_f32 v124, v124
    v_exp_f32 v132, v132
    v_add_f32 v21, v21, v115
    v_add_f32 v22, v22, v123
    v_add_f32 v23, v23, v131
    v_cvt_pk_bf16_f32 v221, v114, v115
    v_cvt_pk_bf16_f32 v225, v122, v123
    v_cvt_pk_bf16_f32 v229, v130, v131
    v_exp_f32 v117, v117
    v_exp_f32 v125, v125
    v_exp_f32 v133, v133
    v_add_f32 v21, v21, v116
    v_add_f32 v22, v22, v124
    v_add_f32 v23, v23, v132
    v_exp_f32 v118, v118
    v_exp_f32 v126, v126
    v_exp_f32 v134, v134
    v_add_f32 v21, v21, v117
    v_add_f32 v22, v22, v125
    v_add_f32 v23, v23, v133
    v_cvt_pk_bf16_f32 v222, v116, v117
    v_cvt_pk_bf16_f32 v226, v124, v125
    v_cvt_pk_bf16_f32 v230, v132, v133
    v_exp_f32 v119, v119
    v_exp_f32 v127, v127
    v_exp_f32 v135, v135
    v_add_f32 v21, v21, v118
    v_add_f32 v22, v22, v126
    v_add_f32 v23, v23, v134
    v_add_f32 v21, v21, v119
    v_add_f32 v22, v22, v127
    v_add_f32 v23, v23, v135
    v_cvt_pk_bf16_f32 v223, v118, v119
    v_cvt_pk_bf16_f32 v227, v126, v127
    v_cvt_pk_bf16_f32 v231, v134, v135
    s_waitcnt lgkmcnt(7)
    v_mfma_f32_16x16x32_bf16 v[112:115], v[32:35], v[64:67], 0
    v_mfma_f32_16x16x32_bf16 v[120:123], v[32:35], v[80:83], 0
    v_mfma_f32_16x16x32_bf16 v[128:131], v[32:35], v[96:99], 0
    s_waitcnt lgkmcnt(6)
    v_mfma_f32_16x16x32_bf16 v[112:115], v[36:39], v[68:71], v[112:115]
    v_mfma_f32_16x16x32_bf16 v[120:123], v[36:39], v[84:87], v[120:123]
    v_mfma_f32_16x16x32_bf16 v[128:131], v[36:39], v[100:103], v[128:131]
    s_waitcnt lgkmcnt(5)
    v_mfma_f32_16x16x32_bf16 v[112:115], v[40:43], v[72:75], v[112:115]
    v_mfma_f32_16x16x32_bf16 v[120:123], v[40:43], v[88:91], v[120:123]
    v_mfma_f32_16x16x32_bf16 v[128:131], v[40:43], v[104:107], v[128:131]
    s_waitcnt lgkmcnt(4)
    v_mfma_f32_16x16x32_bf16 v[112:115], v[44:47], v[76:79], v[112:115]
    v_mfma_f32_16x16x32_bf16 v[120:123], v[44:47], v[92:95], v[120:123]
    v_mfma_f32_16x16x32_bf16 v[128:131], v[44:47], v[108:111], v[128:131]
    s_waitcnt lgkmcnt(3)
    v_mfma_f32_16x16x32_bf16 v[116:119], v[48:51], v[64:67], 0
    v_mfma_f32_16x16x32_bf16 v[124:127], v[48:51], v[80:83], 0
    v_mfma_f32_16x16x32_bf16 v[132:135], v[48:51], v[96:99], 0
    s_waitcnt lgkmcnt(2)
    v_mfma_f32_16x16x32_bf16 v[116:119], v[52:55], v[68:71], v[116:119]
    v_mfma_f32_16x16x32_bf16 v[124:127], v[52:55], v[84:87], v[124:127]
    v_mfma_f32_16x16x32_bf16 v[132:135], v[52:55], v[100:103], v[132:135]
    s_waitcnt lgkmcnt(1)
    v_mfma_f32_16x16x32_bf16 v[116:119], v[56:59], v[72:75], v[116:119]
    v_mfma_f32_16x16x32_bf16 v[124:127], v[56:59], v[88:91], v[124:127]
    v_mfma_f32_16x16x32_bf16 v[132:135], v[56:59], v[104:107], v[132:135]
    s_waitcnt lgkmcnt(0)
    v_mfma_f32_16x16x32_bf16 v[116:119], v[60:63], v[76:79], v[116:119]
    v_mfma_f32_16x16x32_bf16 v[124:127], v[60:63], v[92:95], v[124:127]
    v_mfma_f32_16x16x32_bf16 v[132:135], v[60:63], v[108:111], v[132:135]
    s_waitcnt vmcnt(12)
    s_barrier
    v_and_b32 v4, 7, v0
    v_lshlrev_b32 v4, 7, v4
    s_lshl_b32 s45, s42, 7
    s_lshr_b32 s56, s41, 2
    s_lshl_b32 s56, s56, 6
    s_add_u32 s45, s45, s56
    s_add_u32 s45, s45, 26214400
    buffer_load_dwordx2 v[2:3], v4, s[24:27], s45 offen offset:0 sc1
    v_fma_f32 v112, v112, s59, -v18
    v_fma_f32 v120, v120, s59, -v19
    v_fma_f32 v128, v128, s59, -v20
    v_fma_f32 v113, v113, s59, -v18
    v_fma_f32 v121, v121, s59, -v19
    v_fma_f32 v129, v129, s59, -v20
    v_fma_f32 v114, v114, s59, -v18
    v_fma_f32 v122, v122, s59, -v19
    v_fma_f32 v130, v130, s59, -v20
    v_fma_f32 v115, v115, s59, -v18
    v_fma_f32 v123, v123, s59, -v19
    v_fma_f32 v131, v131, s59, -v20
    v_add_u32 v24, 131072, v24
    ds_read_b64_tr_b16 v[32:33], v24 offset:0
    ds_read_b64_tr_b16 v[34:35], v24 offset:4096
    v_fma_f32 v116, v116, s59, -v18
    v_fma_f32 v124, v124, s59, -v19
    v_fma_f32 v132, v132, s59, -v20
    v_fma_f32 v117, v117, s59, -v18
    v_fma_f32 v125, v125, s59, -v19
    v_fma_f32 v133, v133, s59, -v20
    v_fma_f32 v118, v118, s59, -v18
    v_fma_f32 v126, v126, s59, -v19
    v_fma_f32 v134, v134, s59, -v20
    v_fma_f32 v119, v119, s59, -v18
    v_fma_f32 v127, v127, s59, -v19
    v_fma_f32 v135, v135, s59, -v20
    v_add_u32 v25, 131072, v25
    ds_read_b64_tr_b16 v[36:37], v25 offset:0
    ds_read_b64_tr_b16 v[38:39], v25 offset:4096
    v_max3_f32 v136, v112, v113, v114
    v_max3_f32 v137, v120, v121, v122
    v_max3_f32 v138, v128, v129, v130
    v_max3_f32 v136, v136, v115, v116
    v_max3_f32 v137, v137, v123, v124
    v_max3_f32 v138, v138, v131, v132
    v_max3_f32 v136, v136, v117, v118
    v_max3_f32 v137, v137, v125, v126
    v_max3_f32 v138, v138, v133, v134
    v_max_f32 v136, v136, v119
    v_max_f32 v137, v137, v127
    v_max_f32 v138, v138, v135
    v_max3_f32 v139, v136, v137, v138
    v_cmp_lt_f32 vcc, s29, v139
    s_mov_b32 s28, 7
    s_nop 3
    s_cbranch_vccnz K1_SLOW_0
K1_RET7_0:
    v_add_u32 v26, 131072, v26
    ds_read_b64_tr_b16 v[40:41], v26 offset:0
    ds_read_b64_tr_b16 v[42:43], v26 offset:4096
    v_exp_f32 v112, v112
    v_exp_f32 v120, v120
    v_exp_f32 v128, v128
    v_add_u32 v27, 131072, v27
    ds_read_b64_tr_b16 v[44:45], v27 offset:0
    ds_read_b64_tr_b16 v[46:47], v27 offset:4096
    s_add_u32 m0, s61, 49152
    s_xor_b32 s64, s55, 65536
    buffer_load_dwordx4 v16, s[12:15], s64 offen offset:0 nt lds
    v_exp_f32 v113, v113
    v_exp_f32 v121, v121
    v_exp_f32 v129, v129
    v_add_f32 v21, v21, v112
    v_add_f32 v22, v22, v120
    v_add_f32 v23, v23, v128
    s_add_u32 m0, s61, 49152
    s_xor_b32 s64, s55, 65536
    buffer_load_dwordx4 v17, s[12:15], s64 offen offset:1024 nt lds
    v_exp_f32 v114, v114
    v_exp_f32 v122, v122
    v_exp_f32 v130, v130
    v_add_f32 v21, v21, v113
    v_add_f32 v22, v22, v121
    v_add_f32 v23, v23, v129
    v_cvt_pk_bf16_f32 v232, v112, v113
    v_cvt_pk_bf16_f32 v236, v120, v121
    v_cvt_pk_bf16_f32 v240, v128, v129
    s_add_u32 m0, s61, 49152
    s_xor_b32 s64, s55, 65536
    buffer_load_dwordx4 v16, s[12:15], s64 offen offset:2048 nt lds
    v_exp_f32 v115, v115
    v_exp_f32 v123, v123
    v_exp_f32 v131, v131
    v_add_f32 v21, v21, v114
    v_add_f32 v22, v22, v122
    v_add_f32 v23, v23, v130
    s_add_u32 m0, s61, 49152
    s_xor_b32 s64, s55, 65536
    buffer_load_dwordx4 v17, s[12:15], s64 offen offset:3072 nt lds
    v_exp_f32 v116, v116
    v_exp_f32 v124, v124
    v_exp_f32 v132, v132
    v_add_f32 v21, v21, v115
    v_add_f32 v22, v22, v123
    v_add_f32 v23, v23, v131
    v_cvt_pk_bf16_f32 v233, v114, v115
    v_cvt_pk_bf16_f32 v237, v122, v123
    v_cvt_pk_bf16_f32 v241, v130, v131
    v_exp_f32 v117, v117
    v_exp_f32 v125, v125
    v_exp_f32 v133, v133
    v_add_f32 v21, v21, v116
    v_add_f32 v22, v22, v124
    v_add_f32 v23, v23, v132
    v_exp_f32 v118, v118
    v_exp_f32 v126, v126
    v_exp_f32 v134, v134
    v_add_f32 v21, v21, v117
    v_add_f32 v22, v22, v125
    v_add_f32 v23, v23, v133
    v_cvt_pk_bf16_f32 v234, v116, v117
    v_cvt_pk_bf16_f32 v238, v124, v125
    v_cvt_pk_bf16_f32 v242, v132, v133
    v_exp_f32 v119, v119
    v_exp_f32 v127, v127
    v_exp_f32 v135, v135
    v_add_f32 v21, v21, v118
    v_add_f32 v22, v22, v126
    v_add_f32 v23, v23, v134
    v_add_f32 v21, v21, v119
    v_add_f32 v22, v22, v127
    v_add_f32 v23, v23, v135
    v_cvt_pk_bf16_f32 v235, v118, v119
    v_cvt_pk_bf16_f32 v239, v126, v127
    v_cvt_pk_bf16_f32 v243, v134, v135
    s_waitcnt lgkmcnt(6)
    v_mfma_f32_16x16x32_bf16 v[64:67], v[32:35], v[148:151], 0
    v_add_u32 v28, 131072, v28
    ds_read_b64_tr_b16 v[48:49], v28 offset:0
    v_mfma_f32_16x16x32_bf16 v[68:71], v[32:35], v[152:155], 0
    ds_read_b64_tr_b16 v[50:51], v28 offset:4096
    v_mfma_f32_16x16x32_bf16 v[72:75], v[32:35], v[156:159], 0
    v_add_u32 v29, 131072, v29
    ds_read_b64_tr_b16 v[52:53], v29 offset:0
    s_waitcnt lgkmcnt(7)
    v_mfma_f32_16x16x32_bf16 v[76:79], v[36:39], v[148:151], 0
    ds_read_b64_tr_b16 v[54:55], v29 offset:4096
    v_mfma_f32_16x16x32_bf16 v[80:83], v[36:39], v[152:155], 0
    v_add_u32 v30, 131072, v30
    ds_read_b64_tr_b16 v[56:57], v30 offset:0
    v_mfma_f32_16x16x32_bf16 v[84:87], v[36:39], v[156:159], 0
    ds_read_b64_tr_b16 v[58:59], v30 offset:4096
    s_waitcnt lgkmcnt(8)
    v_mfma_f32_16x16x32_bf16 v[88:91], v[40:43], v[148:151], 0
    v_add_u32 v31, 131072, v31
    ds_read_b64_tr_b16 v[60:61], v31 offset:0
    v_mfma_f32_16x16x32_bf16 v[92:95], v[40:43], v[152:155], 0
    ds_read_b64_tr_b16 v[62:63], v31 offset:4096
    v_mfma_f32_16x16x32_bf16 v[96:99], v[40:43], v[156:159], 0
    s_waitcnt lgkmcnt(8)
    v_mfma_f32_16x16x32_bf16 v[100:103], v[44:47], v[148:151], 0
    v_mfma_f32_16x16x32_bf16 v[104:107], v[44:47], v[152:155], 0
    v_mfma_f32_16x16x32_bf16 v[108:111], v[44:47], v[156:159], 0
    s_waitcnt vmcnt(13)
    s_waitcnt lgkmcnt(0)
    s_barrier
    v_add_u32 v8, 4096, v7
    v_mfma_f32_16x16x32_bf16 v[112:115], v[48:51], v[148:151], 0
    v_subrev_u32 v24, 131072, v24
    ds_read_b64_tr_b16 v[32:33], v24 offset:0
    v_mfma_f32_16x16x32_bf16 v[116:119], v[48:51], v[152:155], 0
    ds_read_b64_tr_b16 v[34:35], v24 offset:4096
    s_add_u32 m0, s61, 131072
    s_xor_b32 s64, s55, 81920
    buffer_load_dwordx4 v16, s[12:15], s64 offen offset:0 nt lds
    v_mfma_f32_16x16x32_bf16 v[120:123], v[48:51], v[156:159], 0
    v_subrev_u32 v25, 131072, v25
    ds_read_b64_tr_b16 v[36:37], v25 offset:0
    v_mfma_f32_16x16x32_bf16 v[124:127], v[52:55], v[148:151], 0
    ds_read_b64_tr_b16 v[38:39], v25 offset:4096
    s_add_u32 m0, s61, 131072
    s_xor_b32 s64, s55, 81920
    buffer_load_dwordx4 v17, s[12:15], s64 offen offset:1024 nt lds
    v_mfma_f32_16x16x32_bf16 v[128:131], v[52:55], v[152:155], 0
    v_subrev_u32 v26, 131072, v26
    ds_read_b64_tr_b16 v[40:41], v26 offset:0
    v_mfma_f32_16x16x32_bf16 v[132:135], v[52:55], v[156:159], 0
    ds_read_b64_tr_b16 v[42:43], v26 offset:4096
    s_add_u32 m0, s61, 131072
    s_xor_b32 s64, s55, 81920
    buffer_load_dwordx4 v16, s[12:15], s64 offen offset:2048 nt lds
    v_mfma_f32_16x16x32_bf16 v[136:139], v[56:59], v[148:151], 0
    v_subrev_u32 v27, 131072, v27
    ds_read_b64_tr_b16 v[44:45], v27 offset:0
    v_mfma_f32_16x16x32_bf16 v[140:143], v[56:59], v[152:155], 0
    ds_read_b64_tr_b16 v[46:47], v27 offset:4096
    s_add_u32 m0, s61, 131072
    s_xor_b32 s64, s55, 81920
    buffer_load_dwordx4 v17, s[12:15], s64 offen offset:3072 nt lds
    v_mfma_f32_16x16x32_bf16 v[144:147], v[56:59], v[156:159], 0
    v_mfma_f32_16x16x32_bf16 v[244:247], v[60:63], v[148:151], 0
    v_mfma_f32_16x16x32_bf16 v[248:251], v[60:63], v[152:155], 0
    v_mfma_f32_16x16x32_bf16 v[252:255], v[60:63], v[156:159], 0
    s_waitcnt lgkmcnt(6)
    v_mfma_f32_16x16x32_bf16 v[64:67], v[32:35], v[160:163], v[64:67]
    v_subrev_u32 v28, 131072, v28
    ds_read_b64_tr_b16 v[48:49], v28 offset:0
    v_mfma_f32_16x16x32_bf16 v[68:71], v[32:35], v[164:167], v[68:71]
    ds_read_b64_tr_b16 v[50:51], v28 offset:4096
    v_mfma_f32_16x16x32_bf16 v[72:75], v[32:35], v[168:171], v[72:75]
    v_subrev_u32 v29, 131072, v29
    ds_read_b64_tr_b16 v[52:53], v29 offset:0
    s_waitcnt lgkmcnt(7)
    v_mfma_f32_16x16x32_bf16 v[76:79], v[36:39], v[160:163], v[76:79]
    ds_read_b64_tr_b16 v[54:55], v29 offset:4096
    v_mfma_f32_16x16x32_bf16 v[80:83], v[36:39], v[164:167], v[80:83]
    v_subrev_u32 v30, 131072, v30
    ds_read_b64_tr_b16 v[56:57], v30 offset:0
    v_mfma_f32_16x16x32_bf16 v[84:87], v[36:39], v[168:171], v[84:87]
    ds_read_b64_tr_b16 v[58:59], v30 offset:4096
    s_waitcnt lgkmcnt(8)
    v_mfma_f32_16x16x32_bf16 v[88:91], v[40:43], v[160:163], v[88:91]
    v_subrev_u32 v31, 131072, v31
    ds_read_b64_tr_b16 v[60:61], v31 offset:0
    v_mfma_f32_16x16x32_bf16 v[92:95], v[40:43], v[164:167], v[92:95]
    ds_read_b64_tr_b16 v[62:63], v31 offset:4096
    v_mfma_f32_16x16x32_bf16 v[96:99], v[40:43], v[168:171], v[96:99]
    s_waitcnt lgkmcnt(8)
    v_mfma_f32_16x16x32_bf16 v[100:103], v[44:47], v[160:163], v[100:103]
    v_mfma_f32_16x16x32_bf16 v[104:107], v[44:47], v[164:167], v[104:107]
    v_mfma_f32_16x16x32_bf16 v[108:111], v[44:47], v[168:171], v[108:111]
    s_waitcnt vmcnt(13)
    s_waitcnt lgkmcnt(0)
    s_barrier
    v_mfma_f32_16x16x32_bf16 v[112:115], v[48:51], v[160:163], v[112:115]
    ds_read_b64_tr_b16 v[32:33], v24 offset:16384
    v_mfma_f32_16x16x32_bf16 v[116:119], v[48:51], v[164:167], v[116:119]
    ds_read_b64_tr_b16 v[34:35], v24 offset:20480
    s_mov_b32 m0, s61
    s_xor_b32 s64, s55, 98304
    buffer_load_dwordx4 v16, s[12:15], s64 offen offset:0 nt lds
    v_mfma_f32_16x16x32_bf16 v[120:123], v[48:51], v[168:171], v[120:123]
    ds_read_b64_tr_b16 v[36:37], v25 offset:16384
    v_mfma_f32_16x16x32_bf16 v[124:127], v[52:55], v[160:163], v[124:127]
    ds_read_b64_tr_b16 v[38:39], v25 offset:20480
    s_mov_b32 m0, s61
    s_xor_b32 s64, s55, 98304
    buffer_load_dwordx4 v17, s[12:15], s64 offen offset:1024 nt lds
    v_mfma_f32_16x16x32_bf16 v[128:131], v[52:55], v[164:167], v[128:131]
    ds_read_b64_tr_b16 v[40:41], v26 offset:16384
    v_mfma_f32_16x16x32_bf16 v[132:135], v[52:55], v[168:171], v[132:135]
    ds_read_b64_tr_b16 v[42:43], v26 offset:20480
    s_mov_b32 m0, s61
    s_xor_b32 s64, s55, 98304
    buffer_load_dwordx4 v16, s[12:15], s64 offen offset:2048 nt lds
    v_mfma_f32_16x16x32_bf16 v[136:139], v[56:59], v[160:163], v[136:139]
    ds_read_b64_tr_b16 v[44:45], v27 offset:16384
    v_mfma_f32_16x16x32_bf16 v[140:143], v[56:59], v[164:167], v[140:143]
    ds_read_b64_tr_b16 v[46:47], v27 offset:20480
    s_mov_b32 m0, s61
    s_xor_b32 s64, s55, 98304
    buffer_load_dwordx4 v17, s[12:15], s64 offen offset:3072 nt lds
    v_mfma_f32_16x16x32_bf16 v[144:147], v[56:59], v[168:171], v[144:147]
    v_mfma_f32_16x16x32_bf16 v[244:247], v[60:63], v[160:163], v[244:247]
    v_mfma_f32_16x16x32_bf16 v[248:251], v[60:63], v[164:167], v[248:251]
    v_mfma_f32_16x16x32_bf16 v[252:255], v[60:63], v[168:171], v[252:255]
    s_waitcnt lgkmcnt(6)
    v_mfma_f32_16x16x32_bf16 v[64:67], v[32:35], v[172:175], v[64:67]
    ds_read_b64_tr_b16 v[48:49], v28 offset:16384
    v_mfma_f32_16x16x32_bf16 v[68:71], v[32:35], v[176:179], v[68:71]
    ds_read_b64_tr_b16 v[50:51], v28 offset:20480
    v_mfma_f32_16x16x32_bf16 v[72:75], v[32:35], v[180:183], v[72:75]
    ds_read_b64_tr_b16 v[52:53], v29 offset:16384
    s_waitcnt lgkmcnt(7)
    v_mfma_f32_16x16x32_bf16 v[76:79], v[36:39], v[172:175], v[76:79]
    ds_read_b64_tr_b16 v[54:55], v29 offset:20480
    v_mfma_f32_16x16x32_bf16 v[80:83], v[36:39], v[176:179], v[80:83]
    ds_read_b64_tr_b16 v[56:57], v30 offset:16384
    v_mfma_f32_16x16x32_bf16 v[84:87], v[36:39], v[180:183], v[84:87]
    ds_read_b64_tr_b16 v[58:59], v30 offset:20480
    s_waitcnt lgkmcnt(8)
    v_mfma_f32_16x16x32_bf16 v[88:91], v[40:43], v[172:175], v[88:91]
    ds_read_b64_tr_b16 v[60:61], v31 offset:16384
    v_mfma_f32_16x16x32_bf16 v[92:95], v[40:43], v[176:179], v[92:95]
    ds_read_b64_tr_b16 v[62:63], v31 offset:20480
    v_mfma_f32_16x16x32_bf16 v[96:99], v[40:43], v[180:183], v[96:99]
    s_waitcnt lgkmcnt(8)
    v_mfma_f32_16x16x32_bf16 v[100:103], v[44:47], v[172:175], v[100:103]
    v_mfma_f32_16x16x32_bf16 v[104:107], v[44:47], v[176:179], v[104:107]
    v_mfma_f32_16x16x32_bf16 v[108:111], v[44:47], v[180:183], v[108:111]
    s_waitcnt vmcnt(13)
    s_waitcnt vmcnt(12)
    s_mov_b32 s57, 0
K1_W_0_CMP:
    v_cmp_ne_u64 vcc, s[30:31], v[2:3]
    s_add_u32 s57, s57, 1
    s_nop 3
    s_cbranch_vccz K1_W_0_OK
    s_cmp_ge_u32 s57, 0x40000
    s_cbranch_scc1 K1_W_0_OK
    s_sleep 4
    buffer_load_dwordx2 v[2:3], v4, s[24:27], s45 offen offset:0 sc1
    s_waitcnt vmcnt(0)
    s_branch K1_W_0_CMP
K1_W_0_OK:
    s_waitcnt lgkmcnt(0)
    s_barrier
    v_mfma_f32_16x16x32_bf16 v[112:115], v[48:51], v[172:175], v[112:115]
    ds_read_b64_tr_b16 v[32:33], v24 offset:32768
    v_mfma_f32_16x16x32_bf16 v[116:119], v[48:51], v[176:179], v[116:119]
    ds_read_b64_tr_b16 v[34:35], v24 offset:36864
    s_add_u32 m0, s61, 16384
    s_xor_b32 s64, s55, 114688
    buffer_load_dwordx4 v16, s[12:15], s64 offen offset:0 nt lds
    v_mfma_f32_16x16x32_bf16 v[120:123], v[48:51], v[180:183], v[120:123]
    ds_read_b64_tr_b16 v[36:37], v25 offset:32768
    v_mfma_f32_16x16x32_bf16 v[124:127], v[52:55], v[172:175], v[124:127]
    ds_read_b64_tr_b16 v[38:39], v25 offset:36864
    s_add_u32 m0, s61, 16384
    s_xor_b32 s64, s55, 114688
    buffer_load_dwordx4 v17, s[12:15], s64 offen offset:1024 nt lds
    v_mfma_f32_16x16x32_bf16 v[128:131], v[52:55], v[176:179], v[128:131]
    ds_read_b64_tr_b16 v[40:41], v26 offset:32768
    v_mfma_f32_16x16x32_bf16 v[132:135], v[52:55], v[180:183], v[132:135]
    ds_read_b64_tr_b16 v[42:43], v26 offset:36864
    s_add_u32 m0, s61, 16384
    s_xor_b32 s64, s55, 114688
    buffer_load_dwordx4 v16, s[12:15], s64 offen offset:2048 nt lds
    v_mfma_f32_16x16x32_bf16 v[136:139], v[56:59], v[172:175], v[136:139]
    ds_read_b64_tr_b16 v[44:45], v27 offset:32768
    v_mfma_f32_16x16x32_bf16 v[140:143], v[56:59], v[176:179], v[140:143]
    ds_read_b64_tr_b16 v[46:47], v27 offset:36864
    s_add_u32 m0, s61, 16384
    s_xor_b32 s64, s55, 114688
    buffer_load_dwordx4 v17, s[12:15], s64 offen offset:3072 nt lds
    v_mfma_f32_16x16x32_bf16 v[144:147], v[56:59], v[180:183], v[144:147]
    v_mfma_f32_16x16x32_bf16 v[244:247], v[60:63], v[172:175], v[244:247]
    v_mfma_f32_16x16x32_bf16 v[248:251], v[60:63], v[176:179], v[248:251]
    v_mfma_f32_16x16x32_bf16 v[252:255], v[60:63], v[180:183], v[252:255]
    s_waitcnt lgkmcnt(6)
    v_mfma_f32_16x16x32_bf16 v[64:67], v[32:35], v[184:187], v[64:67]
    ds_read_b64_tr_b16 v[48:49], v28 offset:32768
    v_mfma_f32_16x16x32_bf16 v[68:71], v[32:35], v[188:191], v[68:71]
    ds_read_b64_tr_b16 v[50:51], v28 offset:36864
    v_mfma_f32_16x16x32_bf16 v[72:75], v[32:35], v[192:195], v[72:75]
    ds_read_b64_tr_b16 v[52:53], v29 offset:32768
    s_waitcnt lgkmcnt(7)
    v_mfma_f32_16x16x32_bf16 v[76:79], v[36:39], v[184:187], v[76:79]
    ds_read_b64_tr_b16 v[54:55], v29 offset:36864
    v_mfma_f32_16x16x32_bf16 v[80:83], v[36:39], v[188:191], v[80:83]
    ds_read_b64_tr_b16 v[56:57], v30 offset:32768
    v_mfma_f32_16x16x32_bf16 v[84:87], v[36:39], v[192:195], v[84:87]
    ds_read_b64_tr_b16 v[58:59], v30 offset:36864
    s_waitcnt lgkmcnt(8)
    v_mfma_f32_16x16x32_bf16 v[88:91], v[40:43], v[184:187], v[88:91]
    ds_read_b64_tr_b16 v[60:61], v31 offset:32768
    v_mfma_f32_16x16x32_bf16 v[92:95], v[40:43], v[188:191], v[92:95]
    ds_read_b64_tr_b16 v[62:63], v31 offset:36864
    v_mfma_f32_16x16x32_bf16 v[96:99], v[40:43], v[192:195], v[96:99]
    s_waitcnt lgkmcnt(8)
    v_mfma_f32_16x16x32_bf16 v[100:103], v[44:47], v[184:187], v[100:103]
    v_mfma_f32_16x16x32_bf16 v[104:107], v[44:47], v[188:191], v[104:107]
    v_mfma_f32_16x16x32_bf16 v[108:111], v[44:47], v[192:195], v[108:111]
    s_waitcnt vmcnt(12)
    s_waitcnt lgkmcnt(0)
    s_barrier
    v_mov_b32 v1, v21
    v_mov_b32 v2, v22
    v_mov_b32 v3, v23
    v_permlane32_swap_b32 v21, v1
    v_permlane32_swap_b32 v22, v2
    v_permlane32_swap_b32 v23, v3
    v_add_f32 v21, v21, v1
    v_add_f32 v22, v22, v2
    v_add_f32 v23, v23, v3
    v_mov_b32 v1, v21
    v_mov_b32 v2, v22
    v_mov_b32 v3, v23
    v_permlane16_swap_b32 v21, v1
    v_permlane16_swap_b32 v22, v2
    v_permlane16_swap_b32 v23, v3
    v_add_f32 v21, v21, v1
    v_add_f32 v22, v22, v2
    v_add_f32 v23, v23, v3
    s_lshl_b32 s56, s52, 9
    s_add_u32 s56, s56, 45056
    v_lshl_add_u32 v4, v6, 5, s56
    ds_write_b128 v4, v[18:21]
    ds_write_b64 v4, v[22:23] offset:16
    v_mfma_f32_16x16x32_bf16 v[112:115], v[48:51], v[184:187], v[112:115]
    ds_read_b64_tr_b16 v[32:33], v24 offset:49152
    v_mfma_f32_16x16x32_bf16 v[116:119], v[48:51], v[188:191], v[116:119]
    ds_read_b64_tr_b16 v[34:35], v24 offset:53248
    v_mfma_f32_16x16x32_bf16 v[120:123], v[48:51], v[192:195], v[120:123]
    ds_read_b64_tr_b16 v[36:37], v25 offset:49152
    v_mfma_f32_16x16x32_bf16 v[124:127], v[52:55], v[184:187], v[124:127]
    ds_read_b64_tr_b16 v[38:39], v25 offset:53248
    v_mfma_f32_16x16x32_bf16 v[128:131], v[52:55], v[188:191], v[128:131]
    ds_read_b64_tr_b16 v[40:41], v26 offset:49152
    v_mfma_f32_16x16x32_bf16 v[132:135], v[52:55], v[192:195], v[132:135]
    ds_read_b64_tr_b16 v[42:43], v26 offset:53248
    v_mfma_f32_16x16x32_bf16 v[136:139], v[56:59], v[184:187], v[136:139]
    ds_read_b64_tr_b16 v[44:45], v27 offset:49152
    v_mfma_f32_16x16x32_bf16 v[140:143], v[56:59], v[188:191], v[140:143]
    ds_read_b64_tr_b16 v[46:47], v27 offset:53248
    v_mfma_f32_16x16x32_bf16 v[144:147], v[56:59], v[192:195], v[144:147]
    v_mfma_f32_16x16x32_bf16 v[244:247], v[60:63], v[184:187], v[244:247]
    v_mfma_f32_16x16x32_bf16 v[248:251], v[60:63], v[188:191], v[248:251]
    v_mfma_f32_16x16x32_bf16 v[252:255], v[60:63], v[192:195], v[252:255]
    s_waitcnt lgkmcnt(6)
    v_mfma_f32_16x16x32_bf16 v[64:67], v[32:35], v[196:199], v[64:67]
    ds_read_b64_tr_b16 v[48:49], v28 offset:49152
    v_mfma_f32_16x16x32_bf16 v[68:71], v[32:35], v[200:203], v[68:71]
    ds_read_b64_tr_b16 v[50:51], v28 offset:53248
    v_mfma_f32_16x16x32_bf16 v[72:75], v[32:35], v[204:207], v[72:75]
    ds_read_b64_tr_b16 v[52:53], v29 offset:49152
    s_waitcnt lgkmcnt(7)
    v_mfma_f32_16x16x32_bf16 v[76:79], v[36:39], v[196:199], v[76:79]
    ds_read_b64_tr_b16 v[54:55], v29 offset:53248
    v_mfma_f32_16x16x32_bf16 v[80:83], v[36:39], v[200:203], v[80:83]
    ds_read_b64_tr_b16 v[56:57], v30 offset:49152
    v_mfma_f32_16x16x32_bf16 v[84:87], v[36:39], v[204:207], v[84:87]
    ds_read_b64_tr_b16 v[58:59], v30 offset:53248
    s_waitcnt lgkmcnt(8)
    v_mfma_f32_16x16x32_bf16 v[88:91], v[40:43], v[196:199], v[88:91]
    ds_read_b64_tr_b16 v[60:61], v31 offset:49152
    v_mfma_f32_16x16x32_bf16 v[92:95], v[40:43], v[200:203], v[92:95]
    ds_read_b64_tr_b16 v[62:63], v31 offset:53248
    v_mfma_f32_16x16x32_bf16 v[96:99], v[40:43], v[204:207], v[96:99]
    s_waitcnt lgkmcnt(8)
    v_mfma_f32_16x16x32_bf16 v[100:103], v[44:47], v[196:199], v[100:103]
    v_mfma_f32_16x16x32_bf16 v[104:107], v[44:47], v[200:203], v[104:107]
    v_mfma_f32_16x16x32_bf16 v[108:111], v[44:47], v[204:207], v[108:111]
    s_waitcnt vmcnt(8)
    s_waitcnt lgkmcnt(0)
    s_barrier
    s_lshl_b32 s56, s52, 9
    s_xor_b32 s56, s56, 1024
    s_add_u32 s56, s56, 45056
    v_lshl_add_u32 v4, v6, 5, s56
    ds_read_b128 v[148:151], v4
    ds_read_b64 v[152:153], v4 offset:16
    v_mfma_f32_16x16x32_bf16 v[112:115], v[48:51], v[196:199], v[112:115]
    v_add_u32 v24, 131072, v24
    ds_read_b64_tr_b16 v[32:33], v24 offset:0
    v_mfma_f32_16x16x32_bf16 v[116:119], v[48:51], v[200:203], v[116:119]
    ds_read_b64_tr_b16 v[34:35], v24 offset:4096
    v_mfma_f32_16x16x32_bf16 v[120:123], v[48:51], v[204:207], v[120:123]
    v_add_u32 v25, 131072, v25
    ds_read_b64_tr_b16 v[36:37], v25 offset:0
    v_mfma_f32_16x16x32_bf16 v[124:127], v[52:55], v[196:199], v[124:127]
    ds_read_b64_tr_b16 v[38:39], v25 offset:4096
    v_mfma_f32_16x16x32_bf16 v[128:131], v[52:55], v[200:203], v[128:131]
    v_add_u32 v26, 131072, v26
    ds_read_b64_tr_b16 v[40:41], v26 offset:0
    v_mfma_f32_16x16x32_bf16 v[132:135], v[52:55], v[204:207], v[132:135]
    ds_read_b64_tr_b16 v[42:43], v26 offset:4096
    v_mfma_f32_16x16x32_bf16 v[136:139], v[56:59], v[196:199], v[136:139]
    v_add_u32 v27, 131072, v27
    ds_read_b64_tr_b16 v[44:45], v27 offset:0
    v_mfma_f32_16x16x32_bf16 v[140:143], v[56:59], v[200:203], v[140:143]
    ds_read_b64_tr_b16 v[46:47], v27 offset:4096
    v_mfma_f32_16x16x32_bf16 v[144:147], v[56:59], v[204:207], v[144:147]
    v_mfma_f32_16x16x32_bf16 v[244:247], v[60:63], v[196:199], v[244:247]
    v_mfma_f32_16x16x32_bf16 v[248:251], v[60:63], v[200:203], v[248:251]
    v_mfma_f32_16x16x32_bf16 v[252:255], v[60:63], v[204:207], v[252:255]
    s_waitcnt lgkmcnt(6)
    v_mfma_f32_16x16x32_bf16 v[64:67], v[32:35], v[208:211], v[64:67]
    v_add_u32 v28, 131072, v28
    ds_read_b64_tr_b16 v[48:49], v28 offset:0
    v_mfma_f32_16x16x32_bf16 v[68:71], v[32:35], v[212:215], v[68:71]
    ds_read_b64_tr_b16 v[50:51], v28 offset:4096
    v_mfma_f32_16x16x32_bf16 v[72:75], v[32:35], v[216:219], v[72:75]
    v_add_u32 v29, 131072, v29
    ds_read_b64_tr_b16 v[52:53], v29 offset:0
    s_waitcnt lgkmcnt(7)
    v_mfma_f32_16x16x32_bf16 v[76:79], v[36:39], v[208:211], v[76:79]
    ds_read_b64_tr_b16 v[54:55], v29 offset:4096
    v_mfma_f32_16x16x32_bf16 v[80:83], v[36:39], v[212:215], v[80:83]
    v_add_u32 v30, 131072, v30
    ds_read_b64_tr_b16 v[56:57], v30 offset:0
    v_mfma_f32_16x16x32_bf16 v[84:87], v[36:39], v[216:219], v[84:87]
    ds_read_b64_tr_b16 v[58:59], v30 offset:4096
    s_waitcnt lgkmcnt(8)
    v_mfma_f32_16x16x32_bf16 v[88:91], v[40:43], v[208:211], v[88:91]
    v_add_u32 v31, 131072, v31
    ds_read_b64_tr_b16 v[60:61], v31 offset:0
    v_mfma_f32_16x16x32_bf16 v[92:95], v[40:43], v[212:215], v[92:95]
    ds_read_b64_tr_b16 v[62:63], v31 offset:4096
    v_mfma_f32_16x16x32_bf16 v[96:99], v[40:43], v[216:219], v[96:99]
    s_waitcnt lgkmcnt(8)
    v_mfma_f32_16x16x32_bf16 v[100:103], v[44:47], v[208:211], v[100:103]
    v_mfma_f32_16x16x32_bf16 v[104:107], v[44:47], v[212:215], v[104:107]
    v_mfma_f32_16x16x32_bf16 v[108:111], v[44:47], v[216:219], v[108:111]
    s_waitcnt vmcnt(4)
    s_waitcnt lgkmcnt(0)
    s_barrier
    v_max_f32 v156, v18, v148
    v_max_f32 v157, v19, v149
    v_max_f32 v158, v20, v150
    v_sub_f32 v18, v18, v156
    v_sub_f32 v148, v148, v156
    v_sub_f32 v19, v19, v157
    v_sub_f32 v149, v149, v157
    v_sub_f32 v20, v20, v158
    v_sub_f32 v150, v150, v158
    v_exp_f32 v18, v18
    v_exp_f32 v148, v148
    v_exp_f32 v19, v19
    v_exp_f32 v149, v149
    v_exp_f32 v20, v20
    v_exp_f32 v150, v150
    v_mul_f32 v156, v18, v21
    v_mul_f32 v157, v19, v22
    v_mul_f32 v158, v20, v23
    v_fma_f32 v156, v148, v151, v156
    v_fma_f32 v157, v149, v152, v157
    v_fma_f32 v158, v150, v153, v158
    v_rcp_f32 v156, v156
    v_rcp_f32 v157, v157
    v_rcp_f32 v158, v158
    v_mul_f32 v18, v18, v156
    v_mul_f32 v21, v148, v156
    v_mul_f32 v19, v19, v157
    v_mul_f32 v22, v149, v157
    v_mul_f32 v20, v20, v158
    v_mul_f32 v23, v150, v158
    v_mfma_f32_16x16x32_bf16 v[112:115], v[48:51], v[208:211], v[112:115]
    v_subrev_u32 v24, 131072, v24
    ds_read_b64_tr_b16 v[32:33], v24 offset:0
    v_mfma_f32_16x16x32_bf16 v[116:119], v[48:51], v[212:215], v[116:119]
    ds_read_b64_tr_b16 v[34:35], v24 offset:4096
    v_mfma_f32_16x16x32_bf16 v[120:123], v[48:51], v[216:219], v[120:123]
    v_subrev_u32 v25, 131072, v25
    ds_read_b64_tr_b16 v[36:37], v25 offset:0
    v_mfma_f32_16x16x32_bf16 v[124:127], v[52:55], v[208:211], v[124:127]
    ds_read_b64_tr_b16 v[38:39], v25 offset:4096
    v_mfma_f32_16x16x32_bf16 v[128:131], v[52:55], v[212:215], v[128:131]
    v_subrev_u32 v26, 131072, v26
    ds_read_b64_tr_b16 v[40:41], v26 offset:0
    v_mfma_f32_16x16x32_bf16 v[132:135], v[52:55], v[216:219], v[132:135]
    ds_read_b64_tr_b16 v[42:43], v26 offset:4096
    v_mfma_f32_16x16x32_bf16 v[136:139], v[56:59], v[208:211], v[136:139]
    v_subrev_u32 v27, 131072, v27
    ds_read_b64_tr_b16 v[44:45], v27 offset:0
    v_mfma_f32_16x16x32_bf16 v[140:143], v[56:59], v[212:215], v[140:143]
    ds_read_b64_tr_b16 v[46:47], v27 offset:4096
    v_mfma_f32_16x16x32_bf16 v[144:147], v[56:59], v[216:219], v[144:147]
    v_mfma_f32_16x16x32_bf16 v[244:247], v[60:63], v[208:211], v[244:247]
    v_mfma_f32_16x16x32_bf16 v[248:251], v[60:63], v[212:215], v[248:251]
    v_mfma_f32_16x16x32_bf16 v[252:255], v[60:63], v[216:219], v[252:255]
    s_waitcnt lgkmcnt(6)
    v_mfma_f32_16x16x32_bf16 v[64:67], v[32:35], v[220:223], v[64:67]
    v_subrev_u32 v28, 131072, v28
    ds_read_b64_tr_b16 v[48:49], v28 offset:0
    v_mfma_f32_16x16x32_bf16 v[68:71], v[32:35], v[224:227], v[68:71]
    ds_read_b64_tr_b16 v[50:51], v28 offset:4096
    v_mfma_f32_16x16x32_bf16 v[72:75], v[32:35], v[228:231], v[72:75]
    v_subrev_u32 v29, 131072, v29
    ds_read_b64_tr_b16 v[52:53], v29 offset:0
    s_waitcnt lgkmcnt(7)
    v_mfma_f32_16x16x32_bf16 v[76:79], v[36:39], v[220:223], v[76:79]
    ds_read_b64_tr_b16 v[54:55], v29 offset:4096
    v_mfma_f32_16x16x32_bf16 v[80:83], v[36:39], v[224:227], v[80:83]
    v_subrev_u32 v30, 131072, v30
    ds_read_b64_tr_b16 v[56:57], v30 offset:0
    v_mfma_f32_16x16x32_bf16 v[84:87], v[36:39], v[228:231], v[84:87]
    ds_read_b64_tr_b16 v[58:59], v30 offset:4096
    s_waitcnt lgkmcnt(8)
    v_mfma_f32_16x16x32_bf16 v[88:91], v[40:43], v[220:223], v[88:91]
    v_subrev_u32 v31, 131072, v31
    ds_read_b64_tr_b16 v[60:61], v31 offset:0
    v_mfma_f32_16x16x32_bf16 v[92:95], v[40:43], v[224:227], v[92:95]
    ds_read_b64_tr_b16 v[62:63], v31 offset:4096
    v_mfma_f32_16x16x32_bf16 v[96:99], v[40:43], v[228:231], v[96:99]
    s_waitcnt lgkmcnt(8)
    v_mfma_f32_16x16x32_bf16 v[100:103], v[44:47], v[220:223], v[100:103]
    v_mfma_f32_16x16x32_bf16 v[104:107], v[44:47], v[224:227], v[104:107]
    v_mfma_f32_16x16x32_bf16 v[108:111], v[44:47], v[228:231], v[108:111]
    s_waitcnt vmcnt(0)
    s_waitcnt lgkmcnt(0)
    s_barrier
    v_mfma_f32_16x16x32_bf16 v[112:115], v[48:51], v[220:223], v[112:115]
    ds_read_b64_tr_b16 v[32:33], v24 offset:16384
    v_mfma_f32_16x16x32_bf16 v[116:119], v[48:51], v[224:227], v[116:119]
    ds_read_b64_tr_b16 v[34:35], v24 offset:20480
    s_add_u32 s65, s46, 0
    s_and_b32 s65, s65, 7
    s_mul_i32 s65, s65, 40960
    s_add_u32 s65, s65, s43
    buffer_load_dwordx4 v[148:151], v7, s[24:27], s65 offen offset:0 sc1
    v_mfma_f32_16x16x32_bf16 v[120:123], v[48:51], v[228:231], v[120:123]
    ds_read_b64_tr_b16 v[36:37], v25 offset:16384
    v_mfma_f32_16x16x32_bf16 v[124:127], v[52:55], v[220:223], v[124:127]
    ds_read_b64_tr_b16 v[38:39], v25 offset:20480
    buffer_load_dwordx4 v[152:155], v7, s[24:27], s65 offen offset:1024 sc1
    v_mfma_f32_16x16x32_bf16 v[128:131], v[52:55], v[224:227], v[128:131]
    ds_read_b64_tr_b16 v[40:41], v26 offset:16384
    v_mfma_f32_16x16x32_bf16 v[132:135], v[52:55], v[228:231], v[132:135]
    ds_read_b64_tr_b16 v[42:43], v26 offset:20480
    buffer_load_dwordx4 v[156:159], v7, s[24:27], s65 offen offset:2048 sc1
    v_mfma_f32_16x16x32_bf16 v[136:139], v[56:59], v[220:223], v[136:139]
    ds_read_b64_tr_b16 v[44:45], v27 offset:16384
    v_mfma_f32_16x16x32_bf16 v[140:143], v[56:59], v[224:227], v[140:143]
    ds_read_b64_tr_b16 v[46:47], v27 offset:20480
    buffer_load_dwordx4 v[160:163], v7, s[24:27], s65 offen offset:3072 sc1
    v_mfma_f32_16x16x32_bf16 v[144:147], v[56:59], v[228:231], v[144:147]
    v_mfma_f32_16x16x32_bf16 v[244:247], v[60:63], v[220:223], v[244:247]
    buffer_load_dwordx4 v[164:167], v8, s[24:27], s65 offen offset:0 sc1
    v_mfma_f32_16x16x32_bf16 v[248:251], v[60:63], v[224:227], v[248:251]
    v_mfma_f32_16x16x32_bf16 v[252:255], v[60:63], v[228:231], v[252:255]
    s_add_u32 s65, s46, 1
    s_and_b32 s65, s65, 7
    s_mul_i32 s65, s65, 40960
    s_add_u32 s65, s65, s43
    buffer_load_dwordx4 v[168:171], v7, s[24:27], s65 offen offset:0 sc1
    buffer_load_dwordx4 v[172:175], v7, s[24:27], s65 offen offset:1024 sc1
    s_waitcnt lgkmcnt(6)
    v_mfma_f32_16x16x32_bf16 v[64:67], v[32:35], v[232:235], v[64:67]
    ds_read_b64_tr_b16 v[48:49], v28 offset:16384
    v_mfma_f32_16x16x32_bf16 v[68:71], v[32:35], v[236:239], v[68:71]
    ds_read_b64_tr_b16 v[50:51], v28 offset:20480
    buffer_load_dwordx4 v[176:179], v7, s[24:27], s65 offen offset:2048 sc1
    v_mfma_f32_16x16x32_bf16 v[72:75], v[32:35], v[240:243], v[72:75]
    ds_read_b64_tr_b16 v[52:53], v29 offset:16384
    s_waitcnt lgkmcnt(7)
    v_mfma_f32_16x16x32_bf16 v[76:79], v[36:39], v[232:235], v[76:79]
    ds_read_b64_tr_b16 v[54:55], v29 offset:20480
    buffer_load_dwordx4 v[180:183], v7, s[24:27], s65 offen offset:3072 sc1
    v_mfma_f32_16x16x32_bf16 v[80:83], v[36:39], v[236:239], v[80:83]
    ds_read_b64_tr_b16 v[56:57], v30 offset:16384
    v_mfma_f32_16x16x32_bf16 v[84:87], v[36:39], v[240:243], v[84:87]
    ds_read_b64_tr_b16 v[58:59], v30 offset:20480
    buffer_load_dwordx4 v[184:187], v8, s[24:27], s65 offen offset:0 sc1
    s_waitcnt lgkmcnt(8)
    v_mfma_f32_16x16x32_bf16 v[88:91], v[40:43], v[232:235], v[88:91]
    ds_read_b64_tr_b16 v[60:61], v31 offset:16384
    v_mfma_f32_16x16x32_bf16 v[92:95], v[40:43], v[236:239], v[92:95]
    ds_read_b64_tr_b16 v[62:63], v31 offset:20480
    s_add_u32 s65, s46, 2
    s_and_b32 s65, s65, 7
    s_mul_i32 s65, s65, 40960
    s_add_u32 s65, s65, s43
    buffer_load_dwordx4 v[188:191], v7, s[24:27], s65 offen offset:0 sc1
    v_mfma_f32_16x16x32_bf16 v[96:99], v[40:43], v[240:243], v[96:99]
    s_waitcnt lgkmcnt(8)
    v_mfma_f32_16x16x32_bf16 v[100:103], v[44:47], v[232:235], v[100:103]
    buffer_load_dwordx4 v[192:195], v7, s[24:27], s65 offen offset:1024 sc1
    v_mfma_f32_16x16x32_bf16 v[104:107], v[44:47], v[236:239], v[104:107]
    v_mfma_f32_16x16x32_bf16 v[108:111], v[44:47], v[240:243], v[108:111]
    buffer_load_dwordx4 v[196:199], v7, s[24:27], s65 offen offset:2048 sc1
    buffer_load_dwordx4 v[200:203], v7, s[24:27], s65 offen offset:3072 sc1
    buffer_load_dwordx4 v[204:207], v8, s[24:27], s65 offen offset:0 sc1
    s_add_u32 s56, s52, 1
    s_lshl_b32 s56, s56, 14
    s_cmp_eq_u32 s52, 0
    s_cselect_b32 s56, 0, s56
    s_cmp_eq_u32 s52, 3
    s_cselect_b32 s56, 131072, s56
    v_add_u32 v2, s56, v7
    s_waitcnt lgkmcnt(0)
    v_mfma_f32_16x16x32_bf16 v[112:115], v[48:51], v[232:235], v[112:115]
    ds_write_b128 v2, v[64:67] offset:0
    v_mfma_f32_16x16x32_bf16 v[116:119], v[48:51], v[236:239], v[116:119]
    ds_write_b128 v2, v[68:71] offset:1024
    v_mfma_f32_16x16x32_bf16 v[120:123], v[48:51], v[240:243], v[120:123]
    ds_write_b128 v2, v[72:75] offset:2048
    v_mfma_f32_16x16x32_bf16 v[124:127], v[52:55], v[232:235], v[124:127]
    ds_write_b128 v2, v[76:79] offset:3072
    v_mfma_f32_16x16x32_bf16 v[128:131], v[52:55], v[236:239], v[128:131]
    ds_write_b128 v2, v[80:83] offset:4096
    v_mfma_f32_16x16x32_bf16 v[132:135], v[52:55], v[240:243], v[132:135]
    ds_write_b128 v2, v[84:87] offset:5120
    v_mfma_f32_16x16x32_bf16 v[136:139], v[56:59], v[232:235], v[136:139]
    ds_write_b128 v2, v[88:91] offset:6144
    v_mfma_f32_16x16x32_bf16 v[140:143], v[56:59], v[236:239], v[140:143]
    ds_write_b128 v2, v[92:95] offset:7168
    v_mfma_f32_16x16x32_bf16 v[144:147], v[56:59], v[240:243], v[144:147]
    ds_write_b128 v2, v[96:99] offset:8192
    v_mfma_f32_16x16x32_bf16 v[244:247], v[60:63], v[232:235], v[244:247]
    ds_write_b128 v2, v[100:103] offset:9216
    v_mfma_f32_16x16x32_bf16 v[248:251], v[60:63], v[236:239], v[248:251]
    ds_write_b128 v2, v[104:107] offset:10240
    v_mfma_f32_16x16x32_bf16 v[252:255], v[60:63], v[240:243], v[252:255]
    ds_write_b128 v2, v[108:111] offset:11264
    s_waitcnt lgkmcnt(0)
    s_barrier
    s_xor_b32 s57, s52, 2
    s_add_u32 s56, s57, 1
    s_lshl_b32 s56, s56, 14
    s_cmp_eq_u32 s57, 0
    s_cselect_b32 s56, 0, s56
    s_cmp_eq_u32 s57, 3
    s_cselect_b32 s56, 131072, s56
    v_add_u32 v2, s56, v7
    ds_read_b128 v[64:67], v2 offset:0
    ds_read_b128 v[68:71], v2 offset:1024
    ds_read_b128 v[72:75], v2 offset:2048
    ds_read_b128 v[76:79], v2 offset:3072
    ds_read_b128 v[80:83], v2 offset:4096
    ds_read_b128 v[84:87], v2 offset:5120
    ds_read_b128 v[88:91], v2 offset:6144
    ds_read_b128 v[92:95], v2 offset:7168
    ds_read_b128 v[96:99], v2 offset:8192
    ds_read_b128 v[100:103], v2 offset:9216
    ds_read_b128 v[104:107], v2 offset:10240
    ds_read_b128 v[108:111], v2 offset:11264
    s_lshl_b32 s56, s54, 1
    s_add_u32 s56, s56, s50
    s_lshl_b32 s56, s56, 7
    s_lshl_b32 s57, s67, 2
    s_add_u32 s56, s56, s57
    s_lshl_b32 s57, s51, 1
    s_add_u32 s56, s56, s57
    s_mul_i32 s56, s56, 3072
    s_add_u32 s57, s56, 3072
    v_mul_f32 v112, v112, v18
    v_mul_f32 v113, v113, v18
    v_mul_f32 v114, v114, v18
    v_mul_f32 v115, v115, v18
    v_mul_f32 v116, v116, v19
    v_mul_f32 v117, v117, v19
    v_mul_f32 v118, v118, v19
    v_mul_f32 v119, v119, v19
    v_mul_f32 v120, v120, v20
    v_mul_f32 v121, v121, v20
    v_mul_f32 v122, v122, v20
    v_mul_f32 v123, v123, v20
    s_waitcnt lgkmcnt(9)
    v_fmac_f32 v112, v64, v21
    v_fmac_f32 v113, v65, v21
    v_fmac_f32 v114, v66, v21
    v_fmac_f32 v115, v67, v21
    v_cvt_pk_bf16_f32 v208, v112, v113
    v_cvt_pk_bf16_f32 v209, v114, v115
    v_fmac_f32 v116, v68, v22
    v_fmac_f32 v117, v69, v22
    v_fmac_f32 v118, v70, v22
    v_fmac_f32 v119, v71, v22
    v_cvt_pk_bf16_f32 v212, v116, v117
    v_cvt_pk_bf16_f32 v213, v118, v119
    v_fmac_f32 v120, v72, v23
    v_fmac_f32 v121, v73, v23
    v_fmac_f32 v122, v74, v23
    v_fmac_f32 v123, v75, v23
    v_cvt_pk_bf16_f32 v216, v120, v121
    v_cvt_pk_bf16_f32 v217, v122, v123
    v_mul_f32 v124, v124, v18
    v_mul_f32 v125, v125, v18
    v_mul_f32 v126, v126, v18
    v_mul_f32 v127, v127, v18
    v_mul_f32 v128, v128, v19
    v_mul_f32 v129, v129, v19
    v_mul_f32 v130, v130, v19
    v_mul_f32 v131, v131, v19
    v_mul_f32 v132, v132, v20
    v_mul_f32 v133, v133, v20
    v_mul_f32 v134, v134, v20
    v_mul_f32 v135, v135, v20
    s_waitcnt lgkmcnt(6)
    v_fmac_f32 v124, v76, v21
    v_fmac_f32 v125, v77, v21
    v_fmac_f32 v126, v78, v21
    v_fmac_f32 v127, v79, v21
    v_cvt_pk_bf16_f32 v210, v124, v125
    v_cvt_pk_bf16_f32 v211, v126, v127
    v_fmac_f32 v128, v80, v22
    v_fmac_f32 v129, v81, v22
    v_fmac_f32 v130, v82, v22
    v_fmac_f32 v131, v83, v22
    v_cvt_pk_bf16_f32 v214, v128, v129
    v_cvt_pk_bf16_f32 v215, v130, v131
    v_fmac_f32 v132, v84, v23
    v_fmac_f32 v133, v85, v23
    v_fmac_f32 v134, v86, v23
    v_fmac_f32 v135, v87, v23
    v_cvt_pk_bf16_f32 v218, v132, v133
    v_cvt_pk_bf16_f32 v219, v134, v135
    buffer_store_dwordx4 v[208:211], v7, s[24:27], s56 offen offset:0 sc1
    buffer_store_dwordx4 v[212:215], v7, s[24:27], s56 offen offset:1024 sc1
    buffer_store_dwordx4 v[216:219], v7, s[24:27], s56 offen offset:2048 sc1
    v_mul_f32 v136, v136, v18
    v_mul_f32 v137, v137, v18
    v_mul_f32 v138, v138, v18
    v_mul_f32 v139, v139, v18
    v_mul_f32 v140, v140, v19
    v_mul_f32 v141, v141, v19
    v_mul_f32 v142, v142, v19
    v_mul_f32 v143, v143, v19
    v_mul_f32 v144, v144, v20
    v_mul_f32 v145, v145, v20
    v_mul_f32 v146, v146, v20
    v_mul_f32 v147, v147, v20
    s_waitcnt lgkmcnt(3)
    v_fmac_f32 v136, v88, v21
    v_fmac_f32 v137, v89, v21
    v_fmac_f32 v138, v90, v21
    v_fmac_f32 v139, v91, v21
    v_cvt_pk_bf16_f32 v220, v136, v137
    v_cvt_pk_bf16_f32 v221, v138, v139
    v_fmac_f32 v140, v92, v22
    v_fmac_f32 v141, v93, v22
    v_fmac_f32 v142, v94, v22
    v_fmac_f32 v143, v95, v22
    v_cvt_pk_bf16_f32 v224, v140, v141
    v_cvt_pk_bf16_f32 v225, v142, v143
    v_fmac_f32 v144, v96, v23
    v_fmac_f32 v145, v97, v23
    v_fmac_f32 v146, v98, v23
    v_fmac_f32 v147, v99, v23
    v_cvt_pk_bf16_f32 v228, v144, v145
    v_cvt_pk_bf16_f32 v229, v146, v147
    v_mul_f32 v244, v244, v18
    v_mul_f32 v245, v245, v18
    v_mul_f32 v246, v246, v18
    v_mul_f32 v247, v247, v18
    v_mul_f32 v248, v248, v19
    v_mul_f32 v249, v249, v19
    v_mul_f32 v250, v250, v19
    v_mul_f32 v251, v251, v19
    v_mul_f32 v252, v252, v20
    v_mul_f32 v253, v253, v20
    v_mul_f32 v254, v254, v20
    v_mul_f32 v255, v255, v20
    s_waitcnt lgkmcnt(0)
    v_fmac_f32 v244, v100, v21
    v_fmac_f32 v245, v101, v21
    v_fmac_f32 v246, v102, v21
    v_fmac_f32 v247, v103, v21
    v_cvt_pk_bf16_f32 v222, v244, v245
    v_cvt_pk_bf16_f32 v223, v246, v247
    v_fmac_f32 v248, v104, v22
    v_fmac_f32 v249, v105, v22
    v_fmac_f32 v250, v106, v22
    v_fmac_f32 v251, v107, v22
    v_cvt_pk_bf16_f32 v226, v248, v249
    v_cvt_pk_bf16_f32 v227, v250, v251
    v_fmac_f32 v252, v108, v23
    v_fmac_f32 v253, v109, v23
    v_fmac_f32 v254, v110, v23
    v_fmac_f32 v255, v111, v23
    v_cvt_pk_bf16_f32 v230, v252, v253
    v_cvt_pk_bf16_f32 v231, v254, v255
    buffer_store_dwordx4 v[220:223], v7, s[24:27], s57 offen offset:0 sc1
    buffer_store_dwordx4 v[224:227], v7, s[24:27], s57 offen offset:1024 sc1
    buffer_store_dwordx4 v[228:231], v7, s[24:27], s57 offen offset:2048 sc1
    s_branch K1_TAIL
K1_SLOW_0:
    s_nop 7
    v_mov_b32 v144, v136
    v_mov_b32 v145, v137
    v_mov_b32 v146, v138
    v_permlane32_swap_b32 v136, v144
    v_permlane32_swap_b32 v137, v145
    v_permlane32_swap_b32 v138, v146
    v_max_f32 v136, v136, v144
    v_max_f32 v137, v137, v145
    v_max_f32 v138, v138, v146
    v_mov_b32 v144, v136
    v_mov_b32 v145, v137
    v_mov_b32 v146, v138
    v_permlane16_swap_b32 v136, v144
    v_permlane16_swap_b32 v137, v145
    v_permlane16_swap_b32 v138, v146
    v_max_f32 v136, v136, v144
    v_max_f32 v137, v137, v145
    v_max_f32 v138, v138, v146
    v_ceil_f32 v136, v136
    v_max_f32 v136, 0, v136
    v_add_f32 v18, v18, v136
    v_sub_f32 v112, v112, v136
    v_sub_f32 v113, v113, v136
    v_sub_f32 v114, v114, v136
    v_sub_f32 v115, v115, v136
    v_sub_f32 v116, v116, v136
    v_sub_f32 v117, v117, v136
    v_sub_f32 v118, v118, v136
    v_sub_f32 v119, v119, v136
    v_sub_f32 v140, 0, v136
    v_exp_f32 v140, v140
    s_nop 0
    v_mul_f32 v21, v21, v140
    v_ceil_f32 v137, v137
    v_max_f32 v137, 0, v137
    v_add_f32 v19, v19, v137
    v_sub_f32 v120, v120, v137
    v_sub_f32 v121, v121, v137
    v_sub_f32 v122, v122, v137
    v_sub_f32 v123, v123, v137
    v_sub_f32 v124, v124, v137
    v_sub_f32 v125, v125, v137
    v_sub_f32 v126, v126, v137
    v_sub_f32 v127, v127, v137
    v_sub_f32 v141, 0, v137
    v_exp_f32 v141, v141
    s_nop 0
    v_mul_f32 v22, v22, v141
    v_ceil_f32 v138, v138
    v_max_f32 v138, 0, v138
    v_add_f32 v20, v20, v138
    v_sub_f32 v128, v128, v138
    v_sub_f32 v129, v129, v138
    v_sub_f32 v130, v130, v138
    v_sub_f32 v131, v131, v138
    v_sub_f32 v132, v132, v138
    v_sub_f32 v133, v133, v138
    v_sub_f32 v134, v134, v138
    v_sub_f32 v135, v135, v138
    v_sub_f32 v142, 0, v138
    v_exp_f32 v142, v142
    s_nop 0
    v_mul_f32 v23, v23, v142
    v_lshlrev_b32 v144, 16, v148
    v_and_b32 v145, 0xffff0000, v148
    v_mul_f32 v144, v144, v140
    v_mul_f32 v145, v145, v140
    v_cvt_pk_bf16_f32 v148, v144, v145
    v_lshlrev_b32 v144, 16, v149
    v_and_b32 v145, 0xffff0000, v149
    v_mul_f32 v144, v144, v140
    v_mul_f32 v145, v145, v140
    v_cvt_pk_bf16_f32 v149, v144, v145
    v_lshlrev_b32 v144, 16, v150
    v_and_b32 v145, 0xffff0000, v150
    v_mul_f32 v144, v144, v140
    v_mul_f32 v145, v145, v140
    v_cvt_pk_bf16_f32 v150, v144, v145
    v_lshlrev_b32 v144, 16, v151
    v_and_b32 v145, 0xffff0000, v151
    v_mul_f32 v144, v144, v140
    v_mul_f32 v145, v145, v140
    v_cvt_pk_bf16_f32 v151, v144, v145
    v_lshlrev_b32 v144, 16, v152
    v_and_b32 v145, 0xffff0000, v152
    v_mul_f32 v144, v144, v141
    v_mul_f32 v145, v145, v141
    v_cvt_pk_bf16_f32 v152, v144, v145
    v_lshlrev_b32 v144, 16, v153
    v_and_b32 v145, 0xffff0000, v153
    v_mul_f32 v144, v144, v141
    v_mul_f32 v145, v145, v141
    v_cvt_pk_bf16_f32 v153, v144, v145
    v_lshlrev_b32 v144, 16, v154
    v_and_b32 v145, 0xffff0000, v154
    v_mul_f32 v144, v144, v141
    v_mul_f32 v145, v145, v141
    v_cvt_pk_bf16_f32 v154, v144, v145
    v_lshlrev_b32 v144, 16, v155
    v_and_b32 v145, 0xffff0000, v155
    v_mul_f32 v144, v144, v141
    v_mul_f32 v145, v145, v141
    v_cvt_pk_bf16_f32 v155, v144, v145
    v_lshlrev_b32 v144, 16, v156
    v_and_b32 v145, 0xffff0000, v156
    v_mul_f32 v144, v144, v142
    v_mul_f32 v145, v145, v142
    v_cvt_pk_bf16_f32 v156, v144, v145
    v_lshlrev_b32 v144, 16, v157
    v_and_b32 v145, 0xffff0000, v157
    v_mul_f32 v144, v144, v142
    v_mul_f32 v145, v145, v142
    v_cvt_pk_bf16_f32 v157, v144, v145
    v_lshlrev_b32 v144, 16, v158
    v_and_b32 v145, 0xffff0000, v158
    v_mul_f32 v144, v144, v142
    v_mul_f32 v145, v145, v142
    v_cvt_pk_bf16_f32 v158, v144, v145
    v_lshlrev_b32 v144, 16, v159
    v_and_b32 v145, 0xffff0000, v159
    v_mul_f32 v144, v144, v142
    v_mul_f32 v145, v145, v142
    v_cvt_pk_bf16_f32 v159, v144, v145
    s_cmp_le_u32 s28, 1
    s_cbranch_scc1 K1_SLOW_DONE_0
    v_lshlrev_b32 v144, 16, v160
    v_and_b32 v145, 0xffff0000, v160
    v_mul_f32 v144, v144, v140
    v_mul_f32 v145, v145, v140
    v_cvt_pk_bf16_f32 v160, v144, v145
    v_lshlrev_b32 v144, 16, v161
    v_and_b32 v145, 0xffff0000, v161
    v_mul_f32 v144, v144, v140
    v_mul_f32 v145, v145, v140
    v_cvt_pk_bf16_f32 v161, v144, v145
    v_lshlrev_b32 v144, 16, v162
    v_and_b32 v145, 0xffff0000, v162
    v_mul_f32 v144, v144, v140
    v_mul_f32 v145, v145, v140
    v_cvt_pk_bf16_f32 v162, v144, v145
    v_lshlrev_b32 v144, 16, v163
    v_and_b32 v145, 0xffff0000, v163
    v_mul_f32 v144, v144, v140
    v_mul_f32 v145, v145, v140
    v_cvt_pk_bf16_f32 v163, v144, v145
    v_lshlrev_b32 v144, 16, v164
    v_and_b32 v145, 0xffff0000, v164
    v_mul_f32 v144, v144, v141
    v_mul_f32 v145, v145, v141
    v_cvt_pk_bf16_f32 v164, v144, v145
    v_lshlrev_b32 v144, 16, v165
    v_and_b32 v145, 0xffff0000, v165
    v_mul_f32 v144, v144, v141
    v_mul_f32 v145, v145, v141
    v_cvt_pk_bf16_f32 v165, v144, v145
    v_lshlrev_b32 v144, 16, v166
    v_and_b32 v145, 0xffff0000, v166
    v_mul_f32 v144, v144, v141
    v_mul_f32 v145, v145, v141
    v_cvt_pk_bf16_f32 v166, v144, v145
    v_lshlrev_b32 v144, 16, v167
    v_and_b32 v145, 0xffff0000, v167
    v_mul_f32 v144, v144, v141
    v_mul_f32 v145, v145, v141
    v_cvt_pk_bf16_f32 v167, v144, v145
    v_lshlrev_b32 v144, 16, v168
    v_and_b32 v145, 0xffff0000, v168
    v_mul_f32 v144, v144, v142
    v_mul_f32 v145, v145, v142
    v_cvt_pk_bf16_f32 v168, v144, v145
    v_lshlrev_b32 v144, 16, v169
    v_and_b32 v145, 0xffff0000, v169
    v_mul_f32 v144, v144, v142
    v_mul_f32 v145, v145, v142
    v_cvt_pk_bf16_f32 v169, v144, v145
    v_lshlrev_b32 v144, 16, v170
    v_and_b32 v145, 0xffff0000, v170
    v_mul_f32 v144, v144, v142
    v_mul_f32 v145, v145, v142
    v_cvt_pk_bf16_f32 v170, v144, v145
    v_lshlrev_b32 v144, 16, v171
    v_and_b32 v145, 0xffff0000, v171
    v_mul_f32 v144, v144, v142
    v_mul_f32 v145, v145, v142
    v_cvt_pk_bf16_f32 v171, v144, v145
    s_cmp_le_u32 s28, 2
    s_cbranch_scc1 K1_SLOW_DONE_0
    v_lshlrev_b32 v144, 16, v172
    v_and_b32 v145, 0xffff0000, v172
    v_mul_f32 v144, v144, v140
    v_mul_f32 v145, v145, v140
    v_cvt_pk_bf16_f32 v172, v144, v145
    v_lshlrev_b32 v144, 16, v173
    v_and_b32 v145, 0xffff0000, v173
    v_mul_f32 v144, v144, v140
    v_mul_f32 v145, v145, v140
    v_cvt_pk_bf16_f32 v173, v144, v145
    v_lshlrev_b32 v144, 16, v174
    v_and_b32 v145, 0xffff0000, v174
    v_mul_f32 v144, v144, v140
    v_mul_f32 v145, v145, v140
    v_cvt_pk_bf16_f32 v174, v144, v145
    v_lshlrev_b32 v144, 16, v175
    v_and_b32 v145, 0xffff0000, v175
    v_mul_f32 v144, v144, v140
    v_mul_f32 v145, v145, v140
    v_cvt_pk_bf16_f32 v175, v144, v145
    v_lshlrev_b32 v144, 16, v176
    v_and_b32 v145, 0xffff0000, v176
    v_mul_f32 v144, v144, v141
    v_mul_f32 v145, v145, v141
    v_cvt_pk_bf16_f32 v176, v144, v145
    v_lshlrev_b32 v144, 16, v177
    v_and_b32 v145, 0xffff0000, v177
    v_mul_f32 v144, v144, v141
    v_mul_f32 v145, v145, v141
    v_cvt_pk_bf16_f32 v177, v144, v145
    v_lshlrev_b32 v144, 16, v178
    v_and_b32 v145, 0xffff0000, v178
    v_mul_f32 v144, v144, v141
    v_mul_f32 v145, v145, v141
    v_cvt_pk_bf16_f32 v178, v144, v145
    v_lshlrev_b32 v144, 16, v179
    v_and_b32 v145, 0xffff0000, v179
    v_mul_f32 v144, v144, v141
    v_mul_f32 v145, v145, v141
    v_cvt_pk_bf16_f32 v179, v144, v145
    v_lshlrev_b32 v144, 16, v180
    v_and_b32 v145, 0xffff0000, v180
    v_mul_f32 v144, v144, v142
    v_mul_f32 v145, v145, v142
    v_cvt_pk_bf16_f32 v180, v144, v145
    v_lshlrev_b32 v144, 16, v181
    v_and_b32 v145, 0xffff0000, v181
    v_mul_f32 v144, v144, v142
    v_mul_f32 v145, v145, v142
    v_cvt_pk_bf16_f32 v181, v144, v145
    v_lshlrev_b32 v144, 16, v182
    v_and_b32 v145, 0xffff0000, v182
    v_mul_f32 v144, v144, v142
    v_mul_f32 v145, v145, v142
    v_cvt_pk_bf16_f32 v182, v144, v145
    v_lshlrev_b32 v144, 16, v183
    v_and_b32 v145, 0xffff0000, v183
    v_mul_f32 v144, v144, v142
    v_mul_f32 v145, v145, v142
    v_cvt_pk_bf16_f32 v183, v144, v145
    s_cmp_le_u32 s28, 3
    s_cbranch_scc1 K1_SLOW_DONE_0
    v_lshlrev_b32 v144, 16, v184
    v_and_b32 v145, 0xffff0000, v184
    v_mul_f32 v144, v144, v140
    v_mul_f32 v145, v145, v140
    v_cvt_pk_bf16_f32 v184, v144, v145
    v_lshlrev_b32 v144, 16, v185
    v_and_b32 v145, 0xffff0000, v185
    v_mul_f32 v144, v144, v140
    v_mul_f32 v145, v145, v140
    v_cvt_pk_bf16_f32 v185, v144, v145
    v_lshlrev_b32 v144, 16, v186
    v_and_b32 v145, 0xffff0000, v186
    v_mul_f32 v144, v144, v140
    v_mul_f32 v145, v145, v140
    v_cvt_pk_bf16_f32 v186, v144, v145
    v_lshlrev_b32 v144, 16, v187
    v_and_b32 v145, 0xffff0000, v187
    v_mul_f32 v144, v144, v140
    v_mul_f32 v145, v145, v140
    v_cvt_pk_bf16_f32 v187, v144, v145
    v_lshlrev_b32 v144, 16, v188
    v_and_b32 v145, 0xffff0000, v188
    v_mul_f32 v144, v144, v141
    v_mul_f32 v145, v145, v141
    v_cvt_pk_bf16_f32 v188, v144, v145
    v_lshlrev_b32 v144, 16, v189
    v_and_b32 v145, 0xffff0000, v189
    v_mul_f32 v144, v144, v141
    v_mul_f32 v145, v145, v141
    v_cvt_pk_bf16_f32 v189, v144, v145
    v_lshlrev_b32 v144, 16, v190
    v_and_b32 v145, 0xffff0000, v190
    v_mul_f32 v144, v144, v141
    v_mul_f32 v145, v145, v141
    v_cvt_pk_bf16_f32 v190, v144, v145
    v_lshlrev_b32 v144, 16, v191
    v_and_b32 v145, 0xffff0000, v191
    v_mul_f32 v144, v144, v141
    v_mul_f32 v145, v145, v141
    v_cvt_pk_bf16_f32 v191, v144, v145
    v_lshlrev_b32 v144, 16, v192
    v_and_b32 v145, 0xffff0000, v192
    v_mul_f32 v144, v144, v142
    v_mul_f32 v145, v145, v142
    v_cvt_pk_bf16_f32 v192, v144, v145
    v_lshlrev_b32 v144, 16, v193
    v_and_b32 v145, 0xffff0000, v193
    v_mul_f32 v144, v144, v142
    v_mul_f32 v145, v145, v142
    v_cvt_pk_bf16_f32 v193, v144, v145
    v_lshlrev_b32 v144, 16, v194
    v_and_b32 v145, 0xffff0000, v194
    v_mul_f32 v144, v144, v142
    v_mul_f32 v145, v145, v142
    v_cvt_pk_bf16_f32 v194, v144, v145
    v_lshlrev_b32 v144, 16, v195
    v_and_b32 v145, 0xffff0000, v195
    v_mul_f32 v144, v144, v142
    v_mul_f32 v145, v145, v142
    v_cvt_pk_bf16_f32 v195, v144, v145
    s_cmp_le_u32 s28, 4
    s_cbranch_scc1 K1_SLOW_DONE_0
    v_lshlrev_b32 v144, 16, v196
    v_and_b32 v145, 0xffff0000, v196
    v_mul_f32 v144, v144, v140
    v_mul_f32 v145, v145, v140
    v_cvt_pk_bf16_f32 v196, v144, v145
    v_lshlrev_b32 v144, 16, v197
    v_and_b32 v145, 0xffff0000, v197
    v_mul_f32 v144, v144, v140
    v_mul_f32 v145, v145, v140
    v_cvt_pk_bf16_f32 v197, v144, v145
    v_lshlrev_b32 v144, 16, v198
    v_and_b32 v145, 0xffff0000, v198
    v_mul_f32 v144, v144, v140
    v_mul_f32 v145, v145, v140
    v_cvt_pk_bf16_f32 v198, v144, v145
    v_lshlrev_b32 v144, 16, v199
    v_and_b32 v145, 0xffff0000, v199
    v_mul_f32 v144, v144, v140
    v_mul_f32 v145, v145, v140
    v_cvt_pk_bf16_f32 v199, v144, v145
    v_lshlrev_b32 v144, 16, v200
    v_and_b32 v145, 0xffff0000, v200
    v_mul_f32 v144, v144, v141
    v_mul_f32 v145, v145, v141
    v_cvt_pk_bf16_f32 v200, v144, v145
    v_lshlrev_b32 v144, 16, v201
    v_and_b32 v145, 0xffff0000, v201
    v_mul_f32 v144, v144, v141
    v_mul_f32 v145, v145, v141
    v_cvt_pk_bf16_f32 v201, v144, v145
    v_lshlrev_b32 v144, 16, v202
    v_and_b32 v145, 0xffff0000, v202
    v_mul_f32 v144, v144, v141
    v_mul_f32 v145, v145, v141
    v_cvt_pk_bf16_f32 v202, v144, v145
    v_lshlrev_b32 v144, 16, v203
    v_and_b32 v145, 0xffff0000, v203
    v_mul_f32 v144, v144, v141
    v_mul_f32 v145, v145, v141
    v_cvt_pk_bf16_f32 v203, v144, v145
    v_lshlrev_b32 v144, 16, v204
    v_and_b32 v145, 0xffff0000, v204
    v_mul_f32 v144, v144, v142
    v_mul_f32 v145, v145, v142
    v_cvt_pk_bf16_f32 v204, v144, v145
    v_lshlrev_b32 v144, 16, v205
    v_and_b32 v145, 0xffff0000, v205
    v_mul_f32 v144, v144, v142
    v_mul_f32 v145, v145, v142
    v_cvt_pk_bf16_f32 v205, v144, v145
    v_lshlrev_b32 v144, 16, v206
    v_and_b32 v145, 0xffff0000, v206
    v_mul_f32 v144, v144, v142
    v_mul_f32 v145, v145, v142
    v_cvt_pk_bf16_f32 v206, v144, v145
    v_lshlrev_b32 v144, 16, v207
    v_and_b32 v145, 0xffff0000, v207
    v_mul_f32 v144, v144, v142
    v_mul_f32 v145, v145, v142
    v_cvt_pk_bf16_f32 v207, v144, v145
    s_cmp_le_u32 s28, 5
    s_cbranch_scc1 K1_SLOW_DONE_0
    v_lshlrev_b32 v144, 16, v208
    v_and_b32 v145, 0xffff0000, v208
    v_mul_f32 v144, v144, v140
    v_mul_f32 v145, v145, v140
    v_cvt_pk_bf16_f32 v208, v144, v145
    v_lshlrev_b32 v144, 16, v209
    v_and_b32 v145, 0xffff0000, v209
    v_mul_f32 v144, v144, v140
    v_mul_f32 v145, v145, v140
    v_cvt_pk_bf16_f32 v209, v144, v145
    v_lshlrev_b32 v144, 16, v210
    v_and_b32 v145, 0xffff0000, v210
    v_mul_f32 v144, v144, v140
    v_mul_f32 v145, v145, v140
    v_cvt_pk_bf16_f32 v210, v144, v145
    v_lshlrev_b32 v144, 16, v211
    v_and_b32 v145, 0xffff0000, v211
    v_mul_f32 v144, v144, v140
    v_mul_f32 v145, v145, v140
    v_cvt_pk_bf16_f32 v211, v144, v145
    v_lshlrev_b32 v144, 16, v212
    v_and_b32 v145, 0xffff0000, v212
    v_mul_f32 v144, v144, v141
    v_mul_f32 v145, v145, v141
    v_cvt_pk_bf16_f32 v212, v144, v145
    v_lshlrev_b32 v144, 16, v213
    v_and_b32 v145, 0xffff0000, v213
    v_mul_f32 v144, v144, v141
    v_mul_f32 v145, v145, v141
    v_cvt_pk_bf16_f32 v213, v144, v145
    v_lshlrev_b32 v144, 16, v214
    v_and_b32 v145, 0xffff0000, v214
    v_mul_f32 v144, v144, v141
    v_mul_f32 v145, v145, v141
    v_cvt_pk_bf16_f32 v214, v144, v145
    v_lshlrev_b32 v144, 16, v215
    v_and_b32 v145, 0xffff0000, v215
    v_mul_f32 v144, v144, v141
    v_mul_f32 v145, v145, v141
    v_cvt_pk_bf16_f32 v215, v144, v145
    v_lshlrev_b32 v144, 16, v216
    v_and_b32 v145, 0xffff0000, v216
    v_mul_f32 v144, v144, v142
    v_mul_f32 v145, v145, v142
    v_cvt_pk_bf16_f32 v216, v144, v145
    v_lshlrev_b32 v144, 16, v217
    v_and_b32 v145, 0xffff0000, v217
    v_mul_f32 v144, v144, v142
    v_mul_f32 v145, v145, v142
    v_cvt_pk_bf16_f32 v217, v144, v145
    v_lshlrev_b32 v144, 16, v218
    v_and_b32 v145, 0xffff0000, v218
    v_mul_f32 v144, v144, v142
    v_mul_f32 v145, v145, v142
    v_cvt_pk_bf16_f32 v218, v144, v145
    v_lshlrev_b32 v144, 16, v219
    v_and_b32 v145, 0xffff0000, v219
    v_mul_f32 v144, v144, v142
    v_mul_f32 v145, v145, v142
    v_cvt_pk_bf16_f32 v219, v144, v145
    s_cmp_le_u32 s28, 6
    s_cbranch_scc1 K1_SLOW_DONE_0
    v_lshlrev_b32 v144, 16, v220
    v_and_b32 v145, 0xffff0000, v220
    v_mul_f32 v144, v144, v140
    v_mul_f32 v145, v145, v140
    v_cvt_pk_bf16_f32 v220, v144, v145
    v_lshlrev_b32 v144, 16, v221
    v_and_b32 v145, 0xffff0000, v221
    v_mul_f32 v144, v144, v140
    v_mul_f32 v145, v145, v140
    v_cvt_pk_bf16_f32 v221, v144, v145
    v_lshlrev_b32 v144, 16, v222
    v_and_b32 v145, 0xffff0000, v222
    v_mul_f32 v144, v144, v140
    v_mul_f32 v145, v145, v140
    v_cvt_pk_bf16_f32 v222, v144, v145
    v_lshlrev_b32 v144, 16, v223
    v_and_b32 v145, 0xffff0000, v223
    v_mul_f32 v144, v144, v140
    v_mul_f32 v145, v145, v140
    v_cvt_pk_bf16_f32 v223, v144, v145
    v_lshlrev_b32 v144, 16, v224
    v_and_b32 v145, 0xffff0000, v224
    v_mul_f32 v144, v144, v141
    v_mul_f32 v145, v145, v141
    v_cvt_pk_bf16_f32 v224, v144, v145
    v_lshlrev_b32 v144, 16, v225
    v_and_b32 v145, 0xffff0000, v225
    v_mul_f32 v144, v144, v141
    v_mul_f32 v145, v145, v141
    v_cvt_pk_bf16_f32 v225, v144, v145
    v_lshlrev_b32 v144, 16, v226
    v_and_b32 v145, 0xffff0000, v226
    v_mul_f32 v144, v144, v141
    v_mul_f32 v145, v145, v141
    v_cvt_pk_bf16_f32 v226, v144, v145
    v_lshlrev_b32 v144, 16, v227
    v_and_b32 v145, 0xffff0000, v227
    v_mul_f32 v144, v144, v141
    v_mul_f32 v145, v145, v141
    v_cvt_pk_bf16_f32 v227, v144, v145
    v_lshlrev_b32 v144, 16, v228
    v_and_b32 v145, 0xffff0000, v228
    v_mul_f32 v144, v144, v142
    v_mul_f32 v145, v145, v142
    v_cvt_pk_bf16_f32 v228, v144, v145
    v_lshlrev_b32 v144, 16, v229
    v_and_b32 v145, 0xffff0000, v229
    v_mul_f32 v144, v144, v142
    v_mul_f32 v145, v145, v142
    v_cvt_pk_bf16_f32 v229, v144, v145
    v_lshlrev_b32 v144, 16, v230
    v_and_b32 v145, 0xffff0000, v230
    v_mul_f32 v144, v144, v142
    v_mul_f32 v145, v145, v142
    v_cvt_pk_bf16_f32 v230, v144, v145
    v_lshlrev_b32 v144, 16, v231
    v_and_b32 v145, 0xffff0000, v231
    v_mul_f32 v144, v144, v142
    v_mul_f32 v145, v145, v142
    v_cvt_pk_bf16_f32 v231, v144, v145
K1_SLOW_DONE_0:
    s_nop 3
    s_cmp_eq_u32 s28, 1
    s_cbranch_scc1 K1_RET1_0
    s_cmp_eq_u32 s28, 2
    s_cbranch_scc1 K1_RET2_0
    s_cmp_eq_u32 s28, 3
    s_cbranch_scc1 K1_RET3_0
    s_cmp_eq_u32 s28, 4
    s_cbranch_scc1 K1_RET4_0
    s_cmp_eq_u32 s28, 5
    s_cbranch_scc1 K1_RET5_0
    s_cmp_eq_u32 s28, 6
    s_cbranch_scc1 K1_RET6_0
    s_branch K1_RET7_0
K1_G1:
    s_lshr_b32 s56, s2, 1
    s_lshl_b32 s56, s56, 5
    s_lshl_b32 s57, s48, 2
    s_add_u32 s56, s56, s57
    s_mul_i32 s56, s56, 1280
    s_and_b32 s58, s2, 1
    s_mul_i32 s58, s58, 640
    s_add_u32 s56, s56, s58
    s_mul_i32 s57, s48, 2560
    s_mov_b32 exec_hi, 0xff
    s_mov_b32 m0, s57
    s_nop 0
    buffer_load_dwordx4 v7, s[20:23], s56 offen lds
    s_add_u32 s56, s56, 1280
    s_add_u32 s57, s57, 640
    s_mov_b32 m0, s57
    s_nop 0
    buffer_load_dwordx4 v7, s[20:23], s56 offen lds
    s_add_u32 s56, s56, 1280
    s_add_u32 s57, s57, 640
    s_mov_b32 m0, s57
    s_nop 0
    buffer_load_dwordx4 v7, s[20:23], s56 offen lds
    s_add_u32 s56, s56, 1280
    s_add_u32 s57, s57, 640
    s_mov_b32 m0, s57
    s_nop 0
    buffer_load_dwordx4 v7, s[20:23], s56 offen lds
    s_add_u32 s56, s56, 1280
    s_add_u32 s57, s57, 640
    s_mov_b32 exec_hi, -1
    s_waitcnt vmcnt(15)
    s_waitcnt vmcnt(13)
    s_barrier
    ds_read_b128 v[48:51], v18 offset:0
    ds_read_b128 v[52:55], v18 offset:2048
    ds_read_b128 v[56:59], v18 offset:4096
    ds_read_b64_tr_b16 v[32:33], v28 offset:0
    ds_read_b64_tr_b16 v[34:35], v28 offset:2048
    ds_read_b64_tr_b16 v[36:37], v29 offset:0
    ds_read_b64_tr_b16 v[38:39], v29 offset:2048
    ds_read_b64_tr_b16 v[40:41], v30 offset:0
    ds_read_b64_tr_b16 v[42:43], v30 offset:2048
    ds_read_b64_tr_b16 v[44:45], v60 offset:0
    ds_read_b64_tr_b16 v[46:47], v60 offset:2048
    s_waitcnt vmcnt(11)
    s_waitcnt lgkmcnt(0)
    s_barrier
    v_mfma_f32_16x16x32_bf16 v[64:67], v[32:35], v[48:51], 0
    ds_read_b128 v[128:131], v19 offset:0
    v_mfma_f32_16x16x32_bf16 v[68:71], v[32:35], v[52:55], 0
    ds_read_b128 v[132:135], v19 offset:2048
    v_mfma_f32_16x16x32_bf16 v[72:75], v[32:35], v[56:59], 0
    ds_read_b128 v[136:139], v19 offset:4096
    v_mfma_f32_16x16x32_bf16 v[76:79], v[36:39], v[48:51], 0
    ds_read_b64_tr_b16 v[112:113], v28 offset:16384
    ds_read_b64_tr_b16 v[114:115], v28 offset:18432
    v_mfma_f32_16x16x32_bf16 v[80:83], v[36:39], v[52:55], 0
    ds_read_b64_tr_b16 v[116:117], v29 offset:16384
    ds_read_b64_tr_b16 v[118:119], v29 offset:18432
    v_mfma_f32_16x16x32_bf16 v[84:87], v[36:39], v[56:59], 0
    ds_read_b64_tr_b16 v[120:121], v30 offset:16384
    ds_read_b64_tr_b16 v[122:123], v30 offset:18432
    v_mfma_f32_16x16x32_bf16 v[88:91], v[40:43], v[48:51], 0
    ds_read_b64_tr_b16 v[124:125], v60 offset:16384
    ds_read_b64_tr_b16 v[126:127], v60 offset:18432
    v_mfma_f32_16x16x32_bf16 v[92:95], v[40:43], v[52:55], 0
    s_mov_b32 m0, s62
    s_lshl_b32 s65, s3, 19
    buffer_load_dwordx4 v24, s[16:19], s65 offen lds
    buffer_load_dwordx4 v25, s[16:19], s65 offen offset:1024 lds
    v_mfma_f32_16x16x32_bf16 v[96:99], v[40:43], v[56:59], 0
    v_mfma_f32_16x16x32_bf16 v[100:103], v[44:47], v[48:51], 0
    v_mfma_f32_16x16x32_bf16 v[104:107], v[44:47], v[52:55], 0
    v_mfma_f32_16x16x32_bf16 v[108:111], v[44:47], v[56:59], 0
    s_waitcnt vmcnt(10)
    s_waitcnt vmcnt(8)
    s_waitcnt lgkmcnt(0)
    s_barrier
    v_mfma_f32_16x16x32_bf16 v[64:67], v[112:115], v[128:131], v[64:67]
    ds_read_b128 v[48:51], v18 offset:12288
    v_mfma_f32_16x16x32_bf16 v[68:71], v[112:115], v[132:135], v[68:71]
    ds_read_b128 v[52:55], v18 offset:14336
    v_mfma_f32_16x16x32_bf16 v[72:75], v[112:115], v[136:139], v[72:75]
    ds_read_b128 v[56:59], v18 offset:16384
    v_mfma_f32_16x16x32_bf16 v[76:79], v[116:119], v[128:131], v[76:79]
    v_xor_b32 v28, 0x10000, v28
    ds_read_b64_tr_b16 v[32:33], v28 offset:0
    ds_read_b64_tr_b16 v[34:35], v28 offset:2048
    v_mfma_f32_16x16x32_bf16 v[80:83], v[116:119], v[132:135], v[80:83]
    v_xor_b32 v29, 0x10000, v29
    ds_read_b64_tr_b16 v[36:37], v29 offset:0
    ds_read_b64_tr_b16 v[38:39], v29 offset:2048
    v_mfma_f32_16x16x32_bf16 v[84:87], v[116:119], v[136:139], v[84:87]
    v_xor_b32 v30, 0x10000, v30
    ds_read_b64_tr_b16 v[40:41], v30 offset:0
    ds_read_b64_tr_b16 v[42:43], v30 offset:2048
    v_mfma_f32_16x16x32_bf16 v[88:91], v[120:123], v[128:131], v[88:91]
    v_xor_b32 v60, 0x10000, v60
    ds_read_b64_tr_b16 v[44:45], v60 offset:0
    ds_read_b64_tr_b16 v[46:47], v60 offset:2048
    v_mfma_f32_16x16x32_bf16 v[92:95], v[120:123], v[132:135], v[92:95]
    s_mov_b32 m0, s63
    s_lshl_b32 s66, s47, 7
    buffer_load_dwordx4 v26, s[4:7], s66 offen lds
    s_mov_b32 exec_hi, 0
    buffer_load_dwordx4 v27, s[4:7], s66 offen offset:1024 lds
    s_mov_b32 exec_hi, -1
    s_add_u32 s47, s47, 1
    s_cmp_eq_u32 s47, 10
    s_cselect_b32 s47, 0, s47
    v_mfma_f32_16x16x32_bf16 v[96:99], v[120:123], v[136:139], v[96:99]
    v_mfma_f32_16x16x32_bf16 v[100:103], v[124:127], v[128:131], v[100:103]
    v_mfma_f32_16x16x32_bf16 v[104:107], v[124:127], v[132:135], v[104:107]
    s_add_u32 m0, s62, 16384
    s_add_u32 s65, s65, 262144
    buffer_load_dwordx4 v24, s[16:19], s65 offen lds
    buffer_load_dwordx4 v25, s[16:19], s65 offen offset:1024 lds
    s_add_u32 s3, s3, 1
    s_cmp_eq_u32 s3, 10
    s_cselect_b32 s3, 0, s3
    v_mfma_f32_16x16x32_bf16 v[108:111], v[124:127], v[136:139], v[108:111]
    s_waitcnt vmcnt(10)
    s_waitcnt lgkmcnt(0)
    s_barrier
    v_mfma_f32_16x16x32_bf16 v[64:67], v[32:35], v[48:51], v[64:67]
    ds_read_b128 v[128:131], v19 offset:12288
    v_mfma_f32_16x16x32_bf16 v[68:71], v[32:35], v[52:55], v[68:71]
    ds_read_b128 v[132:135], v19 offset:14336
    v_mfma_f32_16x16x32_bf16 v[72:75], v[32:35], v[56:59], v[72:75]
    ds_read_b128 v[136:139], v19 offset:16384
    v_mfma_f32_16x16x32_bf16 v[76:79], v[36:39], v[48:51], v[76:79]
    ds_read_b64_tr_b16 v[112:113], v28 offset:16384
    ds_read_b64_tr_b16 v[114:115], v28 offset:18432
    v_mfma_f32_16x16x32_bf16 v[80:83], v[36:39], v[52:55], v[80:83]
    ds_read_b64_tr_b16 v[116:117], v29 offset:16384
    ds_read_b64_tr_b16 v[118:119], v29 offset:18432
    v_mfma_f32_16x16x32_bf16 v[84:87], v[36:39], v[56:59], v[84:87]
    ds_read_b64_tr_b16 v[120:121], v30 offset:16384
    ds_read_b64_tr_b16 v[122:123], v30 offset:18432
    v_mfma_f32_16x16x32_bf16 v[88:91], v[40:43], v[48:51], v[88:91]
    ds_read_b64_tr_b16 v[124:125], v60 offset:16384
    ds_read_b64_tr_b16 v[126:127], v60 offset:18432
    v_mfma_f32_16x16x32_bf16 v[92:95], v[40:43], v[52:55], v[92:95]
    s_add_u32 m0, s62, 65536
    s_lshl_b32 s65, s3, 19
    buffer_load_dwordx4 v24, s[16:19], s65 offen lds
    buffer_load_dwordx4 v25, s[16:19], s65 offen offset:1024 lds
    v_mfma_f32_16x16x32_bf16 v[96:99], v[40:43], v[56:59], v[96:99]
    v_mfma_f32_16x16x32_bf16 v[100:103], v[44:47], v[48:51], v[100:103]
    v_mfma_f32_16x16x32_bf16 v[104:107], v[44:47], v[52:55], v[104:107]
    v_mfma_f32_16x16x32_bf16 v[108:111], v[44:47], v[56:59], v[108:111]
    s_waitcnt vmcnt(4)
    s_waitcnt lgkmcnt(0)
    s_barrier
    v_mfma_f32_16x16x32_bf16 v[64:67], v[112:115], v[128:131], v[64:67]
    ds_read_b128 v[48:51], v18 offset:0
    v_mfma_f32_16x16x32_bf16 v[68:71], v[112:115], v[132:135], v[68:71]
    ds_read_b128 v[52:55], v18 offset:2048
    v_mfma_f32_16x16x32_bf16 v[72:75], v[112:115], v[136:139], v[72:75]
    ds_read_b128 v[56:59], v18 offset:4096
    v_mfma_f32_16x16x32_bf16 v[76:79], v[116:119], v[128:131], v[76:79]
    v_xor_b32 v28, 0x10000, v28
    ds_read_b64_tr_b16 v[32:33], v28 offset:0
    ds_read_b64_tr_b16 v[34:35], v28 offset:2048
    v_mfma_f32_16x16x32_bf16 v[80:83], v[116:119], v[132:135], v[80:83]
    v_xor_b32 v29, 0x10000, v29
    ds_read_b64_tr_b16 v[36:37], v29 offset:0
    ds_read_b64_tr_b16 v[38:39], v29 offset:2048
    v_mfma_f32_16x16x32_bf16 v[84:87], v[116:119], v[136:139], v[84:87]
    v_xor_b32 v30, 0x10000, v30
    ds_read_b64_tr_b16 v[40:41], v30 offset:0
    ds_read_b64_tr_b16 v[42:43], v30 offset:2048
    v_mfma_f32_16x16x32_bf16 v[88:91], v[120:123], v[128:131], v[88:91]
    v_xor_b32 v60, 0x10000, v60
    ds_read_b64_tr_b16 v[44:45], v60 offset:0
    ds_read_b64_tr_b16 v[46:47], v60 offset:2048
    v_mfma_f32_16x16x32_bf16 v[92:95], v[120:123], v[132:135], v[92:95]
    v_bfe_u32 v1, v0, 2, 2
    v_lshl_add_u32 v1, v5, 2, v1
    v_mul_u32_u24 v1, 640, v1
    v_and_b32 v2, 3, v0
    v_lshl_add_u32 v1, v2, 3, v1
    s_lshl_b32 s56, s48, 5
    v_add_u32 v1, s56, v1
    ds_read_b64_tr_b16 v[144:145], v1 offset:0
    ds_read_b64_tr_b16 v[146:147], v1 offset:10240
    ds_read_b64_tr_b16 v[148:149], v1 offset:256
    ds_read_b64_tr_b16 v[150:151], v1 offset:10496
    v_mov_b32 v61, 0
    buffer_load_dwordx2 v[62:63], v61, s[36:39], 0 offen sc1
    v_mfma_f32_16x16x32_bf16 v[96:99], v[120:123], v[136:139], v[96:99]
    v_mfma_f32_16x16x32_bf16 v[100:103], v[124:127], v[128:131], v[100:103]
    v_mfma_f32_16x16x32_bf16 v[104:107], v[124:127], v[132:135], v[104:107]
    s_add_u32 m0, s63, 12288
    s_lshl_b32 s66, s47, 7
    buffer_load_dwordx4 v26, s[4:7], s66 offen lds
    s_mov_b32 exec_hi, 0
    buffer_load_dwordx4 v27, s[4:7], s66 offen offset:1024 lds
    s_mov_b32 exec_hi, -1
    s_add_u32 s47, s47, 1
    s_cmp_eq_u32 s47, 10
    s_cselect_b32 s47, 0, s47
    v_mfma_f32_16x16x32_bf16 v[108:111], v[124:127], v[136:139], v[108:111]
    s_add_u32 m0, s62, 81920
    s_add_u32 s65, s65, 262144
    buffer_load_dwordx4 v24, s[16:19], s65 offen lds
    buffer_load_dwordx4 v25, s[16:19], s65 offen offset:1024 lds
    s_add_u32 s3, s3, 1
    s_cmp_eq_u32 s3, 10
    s_cselect_b32 s3, 0, s3
    s_waitcnt vmcnt(7)
    s_waitcnt lgkmcnt(0)
    s_barrier
    v_mfma_f32_16x16x32_bf16 v[64:67], v[32:35], v[48:51], v[64:67]
    ds_read_b128 v[128:131], v19 offset:0
    v_mfma_f32_16x16x32_bf16 v[68:71], v[32:35], v[52:55], v[68:71]
    ds_read_b128 v[132:135], v19 offset:2048
    v_mfma_f32_16x16x32_bf16 v[72:75], v[32:35], v[56:59], v[72:75]
    ds_read_b128 v[136:139], v19 offset:4096
    v_mfma_f32_16x16x32_bf16 v[76:79], v[36:39], v[48:51], v[76:79]
    ds_read_b64_tr_b16 v[112:113], v28 offset:16384
    ds_read_b64_tr_b16 v[114:115], v28 offset:18432
    v_mfma_f32_16x16x32_bf16 v[80:83], v[36:39], v[52:55], v[80:83]
    ds_read_b64_tr_b16 v[116:117], v29 offset:16384
    ds_read_b64_tr_b16 v[118:119], v29 offset:18432
    v_mfma_f32_16x16x32_bf16 v[84:87], v[36:39], v[56:59], v[84:87]
    ds_read_b64_tr_b16 v[120:121], v30 offset:16384
    ds_read_b64_tr_b16 v[122:123], v30 offset:18432
    v_mfma_f32_16x16x32_bf16 v[88:91], v[40:43], v[48:51], v[88:91]
    ds_read_b64_tr_b16 v[124:125], v60 offset:16384
    ds_read_b64_tr_b16 v[126:127], v60 offset:18432
    v_mfma_f32_16x16x32_bf16 v[92:95], v[40:43], v[52:55], v[92:95]
    s_mov_b32 m0, s62
    s_lshl_b32 s65, s3, 19
    buffer_load_dwordx4 v24, s[16:19], s65 offen lds
    buffer_load_dwordx4 v25, s[16:19], s65 offen offset:1024 lds
    v_mfma_f32_16x16x32_bf16 v[96:99], v[40:43], v[56:59], v[96:99]
    v_mfma_f32_16x16x32_bf16 v[100:103], v[44:47], v[48:51], v[100:103]
    v_mfma_f32_16x16x32_bf16 v[104:107], v[44:47], v[52:55], v[104:107]
    s_mul_i32 s56, s2, 20
    s_add_u32 s56, s56, s48
    s_lshl_b32 s56, s56, 10
    s_add_u32 s56, s56, 16777216
    buffer_store_dwordx4 v[144:147], v7, s[24:27], s56 offen sc1
    s_add_u32 s56, s56, 8192
    buffer_store_dwordx4 v[148:151], v7, s[24:27], s56 offen sc1
    v_mfma_f32_16x16x32_bf16 v[108:111], v[44:47], v[56:59], v[108:111]
    s_waitcnt vmcnt(6)
    s_waitcnt lgkmcnt(0)
    s_barrier
    v_mfma_f32_16x16x32_bf16 v[64:67], v[112:115], v[128:131], v[64:67]
    ds_read_b128 v[48:51], v18 offset:12288
    v_mfma_f32_16x16x32_bf16 v[68:71], v[112:115], v[132:135], v[68:71]
    ds_read_b128 v[52:55], v18 offset:14336
    v_mfma_f32_16x16x32_bf16 v[72:75], v[112:115], v[136:139], v[72:75]
    ds_read_b128 v[56:59], v18 offset:16384
    v_mfma_f32_16x16x32_bf16 v[76:79], v[116:119], v[128:131], v[76:79]
    v_xor_b32 v28, 0x10000, v28
    ds_read_b64_tr_b16 v[32:33], v28 offset:0
    ds_read_b64_tr_b16 v[34:35], v28 offset:2048
    v_mfma_f32_16x16x32_bf16 v[80:83], v[116:119], v[132:135], v[80:83]
    v_xor_b32 v29, 0x10000, v29
    ds_read_b64_tr_b16 v[36:37], v29 offset:0
    ds_read_b64_tr_b16 v[38:39], v29 offset:2048
    v_mfma_f32_16x16x32_bf16 v[84:87], v[116:119], v[136:139], v[84:87]
    v_xor_b32 v30, 0x10000, v30
    ds_read_b64_tr_b16 v[40:41], v30 offset:0
    ds_read_b64_tr_b16 v[42:43], v30 offset:2048
    v_mfma_f32_16x16x32_bf16 v[88:91], v[120:123], v[128:131], v[88:91]
    v_xor_b32 v60, 0x10000, v60
    ds_read_b64_tr_b16 v[44:45], v60 offset:0
    ds_read_b64_tr_b16 v[46:47], v60 offset:2048
    v_mfma_f32_16x16x32_bf16 v[92:95], v[120:123], v[132:135], v[92:95]
    s_mov_b32 m0, s63
    s_lshl_b32 s66, s47, 7
    buffer_load_dwordx4 v26, s[4:7], s66 offen lds
    s_mov_b32 exec_hi, 0
    buffer_load_dwordx4 v27, s[4:7], s66 offen offset:1024 lds
    s_mov_b32 exec_hi, -1
    s_add_u32 s47, s47, 1
    s_cmp_eq_u32 s47, 10
    s_cselect_b32 s47, 0, s47
    v_mfma_f32_16x16x32_bf16 v[96:99], v[120:123], v[136:139], v[96:99]
    v_mfma_f32_16x16x32_bf16 v[100:103], v[124:127], v[128:131], v[100:103]
    v_mfma_f32_16x16x32_bf16 v[104:107], v[124:127], v[132:135], v[104:107]
    s_add_u32 m0, s62, 16384
    s_add_u32 s65, s65, 262144
    buffer_load_dwordx4 v24, s[16:19], s65 offen lds
    buffer_load_dwordx4 v25, s[16:19], s65 offen offset:1024 lds
    s_add_u32 s3, s3, 1
    s_cmp_eq_u32 s3, 10
    s_cselect_b32 s3, 0, s3
    v_mfma_f32_16x16x32_bf16 v[108:111], v[124:127], v[136:139], v[108:111]
    s_waitcnt vmcnt(8)
    s_mov_b32 s57, 0
K1_N_1_CMP:
    v_readfirstlane_b32 s30, v62
    v_readfirstlane_b32 s31, v63
    s_add_u32 s57, s57, 1
    s_cmp_lg_u32 s31, 0
    s_cbranch_scc1 K1_N_1_OK
    s_cmp_ge_u32 s57, 0x40000
    s_cbranch_scc1 K1_N_1_OK
    s_sleep 4
    buffer_load_dwordx2 v[62:63], v61, s[36:39], 0 offen sc1
    s_waitcnt vmcnt(0)
    s_branch K1_N_1_CMP
K1_N_1_OK:
    s_nop 3
    s_waitcnt lgkmcnt(0)
    s_barrier
    v_mfma_f32_16x16x32_bf16 v[64:67], v[32:35], v[48:51], v[64:67]
    ds_read_b128 v[128:131], v19 offset:12288
    v_mfma_f32_16x16x32_bf16 v[68:71], v[32:35], v[52:55], v[68:71]
    ds_read_b128 v[132:135], v19 offset:14336
    v_mfma_f32_16x16x32_bf16 v[72:75], v[32:35], v[56:59], v[72:75]
    ds_read_b128 v[136:139], v19 offset:16384
    v_mfma_f32_16x16x32_bf16 v[76:79], v[36:39], v[48:51], v[76:79]
    ds_read_b64_tr_b16 v[112:113], v28 offset:16384
    ds_read_b64_tr_b16 v[114:115], v28 offset:18432
    v_mfma_f32_16x16x32_bf16 v[80:83], v[36:39], v[52:55], v[80:83]
    ds_read_b64_tr_b16 v[116:117], v29 offset:16384
    ds_read_b64_tr_b16 v[118:119], v29 offset:18432
    v_mfma_f32_16x16x32_bf16 v[84:87], v[36:39], v[56:59], v[84:87]
    ds_read_b64_tr_b16 v[120:121], v30 offset:16384
    ds_read_b64_tr_b16 v[122:123], v30 offset:18432
    v_mfma_f32_16x16x32_bf16 v[88:91], v[40:43], v[48:51], v[88:91]
    ds_read_b64_tr_b16 v[124:125], v60 offset:16384
    ds_read_b64_tr_b16 v[126:127], v60 offset:18432
    v_mfma_f32_16x16x32_bf16 v[92:95], v[40:43], v[52:55], v[92:95]
    s_add_u32 m0, s62, 65536
    s_lshl_b32 s65, s3, 19
    buffer_load_dwordx4 v24, s[16:19], s65 offen lds
    buffer_load_dwordx4 v25, s[16:19], s65 offen offset:1024 lds
    v_mfma_f32_16x16x32_bf16 v[96:99], v[40:43], v[56:59], v[96:99]
    v_mfma_f32_16x16x32_bf16 v[100:103], v[44:47], v[48:51], v[100:103]
    v_mfma_f32_16x16x32_bf16 v[104:107], v[44:47], v[52:55], v[104:107]
    v_mfma_f32_16x16x32_bf16 v[108:111], v[44:47], v[56:59], v[108:111]
    s_waitcnt vmcnt(4)
    s_waitcnt lgkmcnt(0)
    s_barrier
    v_mfma_f32_16x16x32_bf16 v[64:67], v[112:115], v[128:131], v[64:67]
    ds_read_b128 v[48:51], v18 offset:0
    v_mfma_f32_16x16x32_bf16 v[68:71], v[112:115], v[132:135], v[68:71]
    ds_read_b128 v[52:55], v18 offset:2048
    v_mfma_f32_16x16x32_bf16 v[72:75], v[112:115], v[136:139], v[72:75]
    ds_read_b128 v[56:59], v18 offset:4096
    v_mfma_f32_16x16x32_bf16 v[76:79], v[116:119], v[128:131], v[76:79]
    v_xor_b32 v28, 0x10000, v28
    ds_read_b64_tr_b16 v[32:33], v28 offset:0
    ds_read_b64_tr_b16 v[34:35], v28 offset:2048
    v_mfma_f32_16x16x32_bf16 v[80:83], v[116:119], v[132:135], v[80:83]
    v_xor_b32 v29, 0x10000, v29
    ds_read_b64_tr_b16 v[36:37], v29 offset:0
    ds_read_b64_tr_b16 v[38:39], v29 offset:2048
    v_mfma_f32_16x16x32_bf16 v[84:87], v[116:119], v[136:139], v[84:87]
    v_xor_b32 v30, 0x10000, v30
    ds_read_b64_tr_b16 v[40:41], v30 offset:0
    ds_read_b64_tr_b16 v[42:43], v30 offset:2048
    v_mfma_f32_16x16x32_bf16 v[88:91], v[120:123], v[128:131], v[88:91]
    v_xor_b32 v60, 0x10000, v60
    ds_read_b64_tr_b16 v[44:45], v60 offset:0
    ds_read_b64_tr_b16 v[46:47], v60 offset:2048
    v_mfma_f32_16x16x32_bf16 v[92:95], v[120:123], v[132:135], v[92:95]
    s_add_u32 m0, s63, 12288
    s_lshl_b32 s66, s47, 7
    buffer_load_dwordx4 v26, s[4:7], s66 offen lds
    s_mov_b32 exec_hi, 0
    buffer_load_dwordx4 v27, s[4:7], s66 offen offset:1024 lds
    s_mov_b32 exec_hi, -1
    s_add_u32 s47, s47, 1
    s_cmp_eq_u32 s47, 10
    s_cselect_b32 s47, 0, s47
    v_mfma_f32_16x16x32_bf16 v[96:99], v[120:123], v[136:139], v[96:99]
    v_mfma_f32_16x16x32_bf16 v[100:103], v[124:127], v[128:131], v[100:103]
    v_mfma_f32_16x16x32_bf16 v[104:107], v[124:127], v[132:135], v[104:107]
    s_add_u32 m0, s62, 81920
    s_add_u32 s65, s65, 262144
    buffer_load_dwordx4 v24, s[16:19], s65 offen lds
    buffer_load_dwordx4 v25, s[16:19], s65 offen offset:1024 lds
    s_add_u32 s3, s3, 1
    s_cmp_eq_u32 s3, 10
    s_cselect_b32 s3, 0, s3
    v_mfma_f32_16x16x32_bf16 v[108:111], v[124:127], v[136:139], v[108:111]
    s_mov_b32 m0, s61
    s_mov_b32 s64, s55
    buffer_load_dwordx4 v8, s[8:11], s64 offen offset:0 nt lds
    s_mov_b32 m0, s61
    s_mov_b32 s64, s55
    buffer_load_dwordx4 v9, s[8:11], s64 offen offset:1024 nt lds
    s_mov_b32 m0, s61
    s_mov_b32 s64, s55
    buffer_load_dwordx4 v10, s[8:11], s64 offen offset:2048 nt lds
    s_mov_b32 m0, s61
    s_mov_b32 s64, s55
    buffer_load_dwordx4 v11, s[8:11], s64 offen offset:3072 nt lds
    s_waitcnt vmcnt(10)
    s_waitcnt lgkmcnt(0)
    s_barrier
    v_mfma_f32_16x16x32_bf16 v[64:67], v[32:35], v[48:51], v[64:67]
    ds_read_b128 v[128:131], v19 offset:0
    v_mfma_f32_16x16x32_bf16 v[68:71], v[32:35], v[52:55], v[68:71]
    ds_read_b128 v[132:135], v19 offset:2048
    v_mfma_f32_16x16x32_bf16 v[72:75], v[32:35], v[56:59], v[72:75]
    ds_read_b128 v[136:139], v19 offset:4096
    v_mfma_f32_16x16x32_bf16 v[76:79], v[36:39], v[48:51], v[76:79]
    ds_read_b64_tr_b16 v[112:113], v28 offset:16384
    ds_read_b64_tr_b16 v[114:115], v28 offset:18432
    v_mfma_f32_16x16x32_bf16 v[80:83], v[36:39], v[52:55], v[80:83]
    ds_read_b64_tr_b16 v[116:117], v29 offset:16384
    ds_read_b64_tr_b16 v[118:119], v29 offset:18432
    v_mfma_f32_16x16x32_bf16 v[84:87], v[36:39], v[56:59], v[84:87]
    ds_read_b64_tr_b16 v[120:121], v30 offset:16384
    ds_read_b64_tr_b16 v[122:123], v30 offset:18432
    v_mfma_f32_16x16x32_bf16 v[88:91], v[40:43], v[48:51], v[88:91]
    ds_read_b64_tr_b16 v[124:125], v60 offset:16384
    ds_read_b64_tr_b16 v[126:127], v60 offset:18432
    v_mfma_f32_16x16x32_bf16 v[92:95], v[40:43], v[52:55], v[92:95]
    s_mov_b32 m0, s62
    s_lshl_b32 s65, s3, 19
    buffer_load_dwordx4 v24, s[16:19], s65 offen lds
    buffer_load_dwordx4 v25, s[16:19], s65 offen offset:1024 lds
    v_mfma_f32_16x16x32_bf16 v[96:99], v[40:43], v[56:59], v[96:99]
    v_mfma_f32_16x16x32_bf16 v[100:103], v[44:47], v[48:51], v[100:103]
    v_mfma_f32_16x16x32_bf16 v[104:107], v[44:47], v[52:55], v[104:107]
    v_mfma_f32_16x16x32_bf16 v[108:111], v[44:47], v[56:59], v[108:111]
    s_waitcnt vmcnt(8)
    s_waitcnt lgkmcnt(0)
    s_barrier
    v_mfma_f32_16x16x32_bf16 v[64:67], v[112:115], v[128:131], v[64:67]
    ds_read_b128 v[48:51], v18 offset:12288
    v_mfma_f32_16x16x32_bf16 v[68:71], v[112:115], v[132:135], v[68:71]
    ds_read_b128 v[52:55], v18 offset:14336
    v_mfma_f32_16x16x32_bf16 v[72:75], v[112:115], v[136:139], v[72:75]
    ds_read_b128 v[56:59], v18 offset:16384
    v_mfma_f32_16x16x32_bf16 v[76:79], v[116:119], v[128:131], v[76:79]
    v_xor_b32 v28, 0x10000, v28
    ds_read_b64_tr_b16 v[32:33], v28 offset:0
    ds_read_b64_tr_b16 v[34:35], v28 offset:2048
    v_mfma_f32_16x16x32_bf16 v[80:83], v[116:119], v[132:135], v[80:83]
    v_xor_b32 v29, 0x10000, v29
    ds_read_b64_tr_b16 v[36:37], v29 offset:0
    ds_read_b64_tr_b16 v[38:39], v29 offset:2048
    v_mfma_f32_16x16x32_bf16 v[84:87], v[116:119], v[136:139], v[84:87]
    v_xor_b32 v30, 0x10000, v30
    ds_read_b64_tr_b16 v[40:41], v30 offset:0
    ds_read_b64_tr_b16 v[42:43], v30 offset:2048
    v_mfma_f32_16x16x32_bf16 v[88:91], v[120:123], v[128:131], v[88:91]
    v_xor_b32 v60, 0x10000, v60
    ds_read_b64_tr_b16 v[44:45], v60 offset:0
    ds_read_b64_tr_b16 v[46:47], v60 offset:2048
    v_mfma_f32_16x16x32_bf16 v[92:95], v[120:123], v[132:135], v[92:95]
    s_mov_b32 m0, s63
    s_lshl_b32 s66, s47, 7
    buffer_load_dwordx4 v26, s[4:7], s66 offen lds
    s_mov_b32 exec_hi, 0
    buffer_load_dwordx4 v27, s[4:7], s66 offen offset:1024 lds
    s_mov_b32 exec_hi, -1
    s_add_u32 s47, s47, 1
    s_cmp_eq_u32 s47, 10
    s_cselect_b32 s47, 0, s47
    v_mfma_f32_16x16x32_bf16 v[96:99], v[120:123], v[136:139], v[96:99]
    v_mfma_f32_16x16x32_bf16 v[100:103], v[124:127], v[128:131], v[100:103]
    v_mfma_f32_16x16x32_bf16 v[104:107], v[124:127], v[132:135], v[104:107]
    s_add_u32 m0, s62, 16384
    s_add_u32 s65, s65, 262144
    buffer_load_dwordx4 v24, s[16:19], s65 offen lds
    buffer_load_dwordx4 v25, s[16:19], s65 offen offset:1024 lds
    s_add_u32 s3, s3, 1
    s_cmp_eq_u32 s3, 10
    s_cselect_b32 s3, 0, s3
    v_mfma_f32_16x16x32_bf16 v[108:111], v[124:127], v[136:139], v[108:111]
    s_waitcnt vmcnt(10)
    s_waitcnt lgkmcnt(0)
    s_barrier
    v_mfma_f32_16x16x32_bf16 v[64:67], v[32:35], v[48:51], v[64:67]
    ds_read_b128 v[128:131], v19 offset:12288
    v_mfma_f32_16x16x32_bf16 v[68:71], v[32:35], v[52:55], v[68:71]
    ds_read_b128 v[132:135], v19 offset:14336
    v_mfma_f32_16x16x32_bf16 v[72:75], v[32:35], v[56:59], v[72:75]
    ds_read_b128 v[136:139], v19 offset:16384
    v_mfma_f32_16x16x32_bf16 v[76:79], v[36:39], v[48:51], v[76:79]
    ds_read_b64_tr_b16 v[112:113], v28 offset:16384
    ds_read_b64_tr_b16 v[114:115], v28 offset:18432
    v_mfma_f32_16x16x32_bf16 v[80:83], v[36:39], v[52:55], v[80:83]
    ds_read_b64_tr_b16 v[116:117], v29 offset:16384
    ds_read_b64_tr_b16 v[118:119], v29 offset:18432
    v_mfma_f32_16x16x32_bf16 v[84:87], v[36:39], v[56:59], v[84:87]
    ds_read_b64_tr_b16 v[120:121], v30 offset:16384
    ds_read_b64_tr_b16 v[122:123], v30 offset:18432
    v_mfma_f32_16x16x32_bf16 v[88:91], v[40:43], v[48:51], v[88:91]
    ds_read_b64_tr_b16 v[124:125], v60 offset:16384
    ds_read_b64_tr_b16 v[126:127], v60 offset:18432
    v_mfma_f32_16x16x32_bf16 v[92:95], v[40:43], v[52:55], v[92:95]
    s_add_u32 m0, s62, 65536
    s_lshl_b32 s65, s3, 19
    buffer_load_dwordx4 v24, s[16:19], s65 offen lds
    buffer_load_dwordx4 v25, s[16:19], s65 offen offset:1024 lds
    v_mfma_f32_16x16x32_bf16 v[96:99], v[40:43], v[56:59], v[96:99]
    v_mfma_f32_16x16x32_bf16 v[100:103], v[44:47], v[48:51], v[100:103]
    v_mfma_f32_16x16x32_bf16 v[104:107], v[44:47], v[52:55], v[104:107]
    s_add_u32 m0, s61, 16384
    s_xor_b32 s64, s55, 16384
    buffer_load_dwordx4 v8, s[8:11], s64 offen offset:0 nt lds
    v_mfma_f32_16x16x32_bf16 v[108:111], v[44:47], v[56:59], v[108:111]
    s_add_u32 m0, s61, 16384
    s_xor_b32 s64, s55, 16384
    buffer_load_dwordx4 v9, s[8:11], s64 offen offset:1024 nt lds
    s_add_u32 m0, s61, 16384
    s_xor_b32 s64, s55, 16384
    buffer_load_dwordx4 v10, s[8:11], s64 offen offset:2048 nt lds
    s_add_u32 m0, s61, 16384
    s_xor_b32 s64, s55, 16384
    buffer_load_dwordx4 v11, s[8:11], s64 offen offset:3072 nt lds
    s_waitcnt vmcnt(8)
    s_waitcnt lgkmcnt(0)
    s_barrier
    v_mfma_f32_16x16x32_bf16 v[64:67], v[112:115], v[128:131], v[64:67]
    ds_read_b128 v[48:51], v18 offset:0
    v_mfma_f32_16x16x32_bf16 v[68:71], v[112:115], v[132:135], v[68:71]
    ds_read_b128 v[52:55], v18 offset:2048
    v_mfma_f32_16x16x32_bf16 v[72:75], v[112:115], v[136:139], v[72:75]
    ds_read_b128 v[56:59], v18 offset:4096
    v_mfma_f32_16x16x32_bf16 v[76:79], v[116:119], v[128:131], v[76:79]
    v_xor_b32 v28, 0x10000, v28
    ds_read_b64_tr_b16 v[32:33], v28 offset:0
    ds_read_b64_tr_b16 v[34:35], v28 offset:2048
    v_mfma_f32_16x16x32_bf16 v[80:83], v[116:119], v[132:135], v[80:83]
    v_xor_b32 v29, 0x10000, v29
    ds_read_b64_tr_b16 v[36:37], v29 offset:0
    ds_read_b64_tr_b16 v[38:39], v29 offset:2048
    v_mfma_f32_16x16x32_bf16 v[84:87], v[116:119], v[136:139], v[84:87]
    v_xor_b32 v30, 0x10000, v30
    ds_read_b64_tr_b16 v[40:41], v30 offset:0
    ds_read_b64_tr_b16 v[42:43], v30 offset:2048
    v_mfma_f32_16x16x32_bf16 v[88:91], v[120:123], v[128:131], v[88:91]
    v_xor_b32 v60, 0x10000, v60
    ds_read_b64_tr_b16 v[44:45], v60 offset:0
    ds_read_b64_tr_b16 v[46:47], v60 offset:2048
    v_mfma_f32_16x16x32_bf16 v[92:95], v[120:123], v[132:135], v[92:95]
    s_add_u32 m0, s63, 12288
    s_lshl_b32 s66, s47, 7
    buffer_load_dwordx4 v26, s[4:7], s66 offen lds
    s_mov_b32 exec_hi, 0
    buffer_load_dwordx4 v27, s[4:7], s66 offen offset:1024 lds
    s_mov_b32 exec_hi, -1
    s_add_u32 s47, s47, 1
    s_cmp_eq_u32 s47, 10
    s_cselect_b32 s47, 0, s47
    v_mfma_f32_16x16x32_bf16 v[96:99], v[120:123], v[136:139], v[96:99]
    v_mfma_f32_16x16x32_bf16 v[100:103], v[124:127], v[128:131], v[100:103]
    v_mfma_f32_16x16x32_bf16 v[104:107], v[124:127], v[132:135], v[104:107]
    s_add_u32 m0, s62, 81920
    s_add_u32 s65, s65, 262144
    buffer_load_dwordx4 v24, s[16:19], s65 offen lds
    buffer_load_dwordx4 v25, s[16:19], s65 offen offset:1024 lds
    s_add_u32 s3, s3, 1
    s_cmp_eq_u32 s3, 10
    s_cselect_b32 s3, 0, s3
    v_mfma_f32_16x16x32_bf16 v[108:111], v[124:127], v[136:139], v[108:111]
    s_waitcnt vmcnt(10)
    s_waitcnt lgkmcnt(0)
    s_barrier
    v_mfma_f32_16x16x32_bf16 v[64:67], v[32:35], v[48:51], v[64:67]
    ds_read_b128 v[128:131], v19 offset:0
    v_mfma_f32_16x16x32_bf16 v[68:71], v[32:35], v[52:55], v[68:71]
    ds_read_b128 v[132:135], v19 offset:2048
    v_mfma_f32_16x16x32_bf16 v[72:75], v[32:35], v[56:59], v[72:75]
    ds_read_b128 v[136:139], v19 offset:4096
    v_mfma_f32_16x16x32_bf16 v[76:79], v[36:39], v[48:51], v[76:79]
    ds_read_b64_tr_b16 v[112:113], v28 offset:16384
    ds_read_b64_tr_b16 v[114:115], v28 offset:18432
    v_mfma_f32_16x16x32_bf16 v[80:83], v[36:39], v[52:55], v[80:83]
    ds_read_b64_tr_b16 v[116:117], v29 offset:16384
    ds_read_b64_tr_b16 v[118:119], v29 offset:18432
    v_mfma_f32_16x16x32_bf16 v[84:87], v[36:39], v[56:59], v[84:87]
    ds_read_b64_tr_b16 v[120:121], v30 offset:16384
    ds_read_b64_tr_b16 v[122:123], v30 offset:18432
    v_mfma_f32_16x16x32_bf16 v[88:91], v[40:43], v[48:51], v[88:91]
    ds_read_b64_tr_b16 v[124:125], v60 offset:16384
    ds_read_b64_tr_b16 v[126:127], v60 offset:18432
    v_mfma_f32_16x16x32_bf16 v[92:95], v[40:43], v[52:55], v[92:95]
    s_mov_b32 m0, s62
    s_lshl_b32 s65, s3, 19
    buffer_load_dwordx4 v24, s[16:19], s65 offen lds
    buffer_load_dwordx4 v25, s[16:19], s65 offen offset:1024 lds
    v_mfma_f32_16x16x32_bf16 v[96:99], v[40:43], v[56:59], v[96:99]
    v_mfma_f32_16x16x32_bf16 v[100:103], v[44:47], v[48:51], v[100:103]
    v_mfma_f32_16x16x32_bf16 v[104:107], v[44:47], v[52:55], v[104:107]
    v_mfma_f32_16x16x32_bf16 v[108:111], v[44:47], v[56:59], v[108:111]
    s_waitcnt vmcnt(4)
    s_waitcnt lgkmcnt(0)
    s_barrier
    v_mfma_f32_16x16x32_bf16 v[64:67], v[112:115], v[128:131], v[64:67]
    ds_read_b128 v[48:51], v18 offset:12288
    v_mfma_f32_16x16x32_bf16 v[68:71], v[112:115], v[132:135], v[68:71]
    ds_read_b128 v[52:55], v18 offset:14336
    v_mfma_f32_16x16x32_bf16 v[72:75], v[112:115], v[136:139], v[72:75]
    ds_read_b128 v[56:59], v18 offset:16384
    v_mfma_f32_16x16x32_bf16 v[76:79], v[116:119], v[128:131], v[76:79]
    v_xor_b32 v28, 0x10000, v28
    ds_read_b64_tr_b16 v[32:33], v28 offset:0
    ds_read_b64_tr_b16 v[34:35], v28 offset:2048
    v_mfma_f32_16x16x32_bf16 v[80:83], v[116:119], v[132:135], v[80:83]
    v_xor_b32 v29, 0x10000, v29
    ds_read_b64_tr_b16 v[36:37], v29 offset:0
    ds_read_b64_tr_b16 v[38:39], v29 offset:2048
    v_mfma_f32_16x16x32_bf16 v[84:87], v[116:119], v[136:139], v[84:87]
    v_xor_b32 v30, 0x10000, v30
    ds_read_b64_tr_b16 v[40:41], v30 offset:0
    ds_read_b64_tr_b16 v[42:43], v30 offset:2048
    v_mfma_f32_16x16x32_bf16 v[88:91], v[120:123], v[128:131], v[88:91]
    v_xor_b32 v60, 0x10000, v60
    ds_read_b64_tr_b16 v[44:45], v60 offset:0
    ds_read_b64_tr_b16 v[46:47], v60 offset:2048
    v_mfma_f32_16x16x32_bf16 v[92:95], v[120:123], v[132:135], v[92:95]
    s_mov_b32 m0, s63
    s_lshl_b32 s66, s47, 7
    buffer_load_dwordx4 v26, s[4:7], s66 offen lds
    s_mov_b32 exec_hi, 0
    buffer_load_dwordx4 v27, s[4:7], s66 offen offset:1024 lds
    s_mov_b32 exec_hi, -1
    s_add_u32 s47, s47, 1
    s_cmp_eq_u32 s47, 10
    s_cselect_b32 s47, 0, s47
    v_mfma_f32_16x16x32_bf16 v[96:99], v[120:123], v[136:139], v[96:99]
    v_mfma_f32_16x16x32_bf16 v[100:103], v[124:127], v[128:131], v[100:103]
    v_mfma_f32_16x16x32_bf16 v[104:107], v[124:127], v[132:135], v[104:107]
    s_add_u32 m0, s62, 16384
    s_add_u32 s65, s65, 262144
    buffer_load_dwordx4 v24, s[16:19], s65 offen lds
    buffer_load_dwordx4 v25, s[16:19], s65 offen offset:1024 lds
    s_add_u32 s3, s3, 1
    s_cmp_eq_u32 s3, 10
    s_cselect_b32 s3, 0, s3
    v_mfma_f32_16x16x32_bf16 v[108:111], v[124:127], v[136:139], v[108:111]
    s_xor_b32 s64, s55, 32768
    buffer_load_dwordx4 v[160:163], v8, s[8:11], s64 offen offset:0 nt
    s_xor_b32 s64, s55, 32768
    buffer_load_dwordx4 v[164:167], v9, s[8:11], s64 offen offset:1024 nt
    s_xor_b32 s64, s55, 32768
    buffer_load_dwordx4 v[168:171], v10, s[8:11], s64 offen offset:2048 nt
    s_xor_b32 s64, s55, 32768
    buffer_load_dwordx4 v[172:175], v11, s[8:11], s64 offen offset:3072 nt
    s_waitcnt vmcnt(10)
    s_waitcnt lgkmcnt(0)
    s_barrier
    v_mfma_f32_16x16x32_bf16 v[64:67], v[32:35], v[48:51], v[64:67]
    ds_read_b128 v[128:131], v19 offset:12288
    v_mfma_f32_16x16x32_bf16 v[68:71], v[32:35], v[52:55], v[68:71]
    ds_read_b128 v[132:135], v19 offset:14336
    v_mfma_f32_16x16x32_bf16 v[72:75], v[32:35], v[56:59], v[72:75]
    ds_read_b128 v[136:139], v19 offset:16384
    v_mfma_f32_16x16x32_bf16 v[76:79], v[36:39], v[48:51], v[76:79]
    ds_read_b64_tr_b16 v[112:113], v28 offset:16384
    ds_read_b64_tr_b16 v[114:115], v28 offset:18432
    v_mfma_f32_16x16x32_bf16 v[80:83], v[36:39], v[52:55], v[80:83]
    ds_read_b64_tr_b16 v[116:117], v29 offset:16384
    ds_read_b64_tr_b16 v[118:119], v29 offset:18432
    v_mfma_f32_16x16x32_bf16 v[84:87], v[36:39], v[56:59], v[84:87]
    ds_read_b64_tr_b16 v[120:121], v30 offset:16384
    ds_read_b64_tr_b16 v[122:123], v30 offset:18432
    v_mfma_f32_16x16x32_bf16 v[88:91], v[40:43], v[48:51], v[88:91]
    ds_read_b64_tr_b16 v[124:125], v60 offset:16384
    ds_read_b64_tr_b16 v[126:127], v60 offset:18432
    v_mfma_f32_16x16x32_bf16 v[92:95], v[40:43], v[52:55], v[92:95]
    s_add_u32 m0, s62, 65536
    s_lshl_b32 s65, s3, 19
    buffer_load_dwordx4 v24, s[16:19], s65 offen lds
    buffer_load_dwordx4 v25, s[16:19], s65 offen offset:1024 lds
    v_mfma_f32_16x16x32_bf16 v[96:99], v[40:43], v[56:59], v[96:99]
    v_mfma_f32_16x16x32_bf16 v[100:103], v[44:47], v[48:51], v[100:103]
    v_mfma_f32_16x16x32_bf16 v[104:107], v[44:47], v[52:55], v[104:107]
    v_mfma_f32_16x16x32_bf16 v[108:111], v[44:47], v[56:59], v[108:111]
    s_waitcnt vmcnt(8)
    s_waitcnt lgkmcnt(0)
    s_barrier
    v_mfma_f32_16x16x32_bf16 v[64:67], v[112:115], v[128:131], v[64:67]
    ds_read_b128 v[48:51], v18 offset:0
    v_mfma_f32_16x16x32_bf16 v[68:71], v[112:115], v[132:135], v[68:71]
    ds_read_b128 v[52:55], v18 offset:2048
    v_mfma_f32_16x16x32_bf16 v[72:75], v[112:115], v[136:139], v[72:75]
    ds_read_b128 v[56:59], v18 offset:4096
    v_mfma_f32_16x16x32_bf16 v[76:79], v[116:119], v[128:131], v[76:79]
    v_xor_b32 v28, 0x10000, v28
    ds_read_b64_tr_b16 v[32:33], v28 offset:0
    ds_read_b64_tr_b16 v[34:35], v28 offset:2048
    v_mfma_f32_16x16x32_bf16 v[80:83], v[116:119], v[132:135], v[80:83]
    v_xor_b32 v29, 0x10000, v29
    ds_read_b64_tr_b16 v[36:37], v29 offset:0
    ds_read_b64_tr_b16 v[38:39], v29 offset:2048
    v_mfma_f32_16x16x32_bf16 v[84:87], v[116:119], v[136:139], v[84:87]
    v_xor_b32 v30, 0x10000, v30
    ds_read_b64_tr_b16 v[40:41], v30 offset:0
    ds_read_b64_tr_b16 v[42:43], v30 offset:2048
    v_mfma_f32_16x16x32_bf16 v[88:91], v[120:123], v[128:131], v[88:91]
    v_xor_b32 v60, 0x10000, v60
    ds_read_b64_tr_b16 v[44:45], v60 offset:0
    ds_read_b64_tr_b16 v[46:47], v60 offset:2048
    v_mfma_f32_16x16x32_bf16 v[92:95], v[120:123], v[132:135], v[92:95]
    s_add_u32 m0, s63, 12288
    s_lshl_b32 s66, s47, 7
    buffer_load_dwordx4 v26, s[4:7], s66 offen lds
    s_mov_b32 exec_hi, 0
    buffer_load_dwordx4 v27, s[4:7], s66 offen offset:1024 lds
    s_mov_b32 exec_hi, -1
    s_add_u32 s47, s47, 1
    s_cmp_eq_u32 s47, 10
    s_cselect_b32 s47, 0, s47
    v_mfma_f32_16x16x32_bf16 v[96:99], v[120:123], v[136:139], v[96:99]
    v_mfma_f32_16x16x32_bf16 v[100:103], v[124:127], v[128:131], v[100:103]
    v_mfma_f32_16x16x32_bf16 v[104:107], v[124:127], v[132:135], v[104:107]
    s_add_u32 m0, s62, 81920
    s_add_u32 s65, s65, 262144
    buffer_load_dwordx4 v24, s[16:19], s65 offen lds
    buffer_load_dwordx4 v25, s[16:19], s65 offen offset:1024 lds
    s_add_u32 s3, s3, 1
    s_cmp_eq_u32 s3, 10
    s_cselect_b32 s3, 0, s3
    v_mfma_f32_16x16x32_bf16 v[108:111], v[124:127], v[136:139], v[108:111]
    s_waitcnt vmcnt(10)
    s_waitcnt lgkmcnt(0)
    s_barrier
    v_mfma_f32_16x16x32_bf16 v[64:67], v[32:35], v[48:51], v[64:67]
    ds_read_b128 v[128:131], v19 offset:0
    v_mfma_f32_16x16x32_bf16 v[68:71], v[32:35], v[52:55], v[68:71]
    ds_read_b128 v[132:135], v19 offset:2048
    v_mfma_f32_16x16x32_bf16 v[72:75], v[32:35], v[56:59], v[72:75]
    ds_read_b128 v[136:139], v19 offset:4096
    v_mfma_f32_16x16x32_bf16 v[76:79], v[36:39], v[48:51], v[76:79]
    ds_read_b64_tr_b16 v[112:113], v28 offset:16384
    ds_read_b64_tr_b16 v[114:115], v28 offset:18432
    v_mfma_f32_16x16x32_bf16 v[80:83], v[36:39], v[52:55], v[80:83]
    ds_read_b64_tr_b16 v[116:117], v29 offset:16384
    ds_read_b64_tr_b16 v[118:119], v29 offset:18432
    v_mfma_f32_16x16x32_bf16 v[84:87], v[36:39], v[56:59], v[84:87]
    ds_read_b64_tr_b16 v[120:121], v30 offset:16384
    ds_read_b64_tr_b16 v[122:123], v30 offset:18432
    v_mfma_f32_16x16x32_bf16 v[88:91], v[40:43], v[48:51], v[88:91]
    ds_read_b64_tr_b16 v[124:125], v60 offset:16384
    ds_read_b64_tr_b16 v[126:127], v60 offset:18432
    v_mfma_f32_16x16x32_bf16 v[92:95], v[40:43], v[52:55], v[92:95]
    s_xor_b32 s64, s55, 49152
    buffer_load_dwordx4 v[176:179], v8, s[8:11], s64 offen offset:0 nt
    v_mfma_f32_16x16x32_bf16 v[96:99], v[40:43], v[56:59], v[96:99]
    v_mfma_f32_16x16x32_bf16 v[100:103], v[44:47], v[48:51], v[100:103]
    v_mfma_f32_16x16x32_bf16 v[104:107], v[44:47], v[52:55], v[104:107]
    s_xor_b32 s64, s55, 49152
    buffer_load_dwordx4 v[180:183], v9, s[8:11], s64 offen offset:1024 nt
    v_mfma_f32_16x16x32_bf16 v[108:111], v[44:47], v[56:59], v[108:111]
    s_xor_b32 s64, s55, 49152
    buffer_load_dwordx4 v[184:187], v10, s[8:11], s64 offen offset:2048 nt
    s_xor_b32 s64, s55, 49152
    buffer_load_dwordx4 v[188:191], v11, s[8:11], s64 offen offset:3072 nt
    s_waitcnt vmcnt(6)
    s_waitcnt lgkmcnt(0)
    s_barrier
    v_mfma_f32_16x16x32_bf16 v[64:67], v[112:115], v[128:131], v[64:67]
    ds_read_b128 v[48:51], v18 offset:12288
    v_mfma_f32_16x16x32_bf16 v[68:71], v[112:115], v[132:135], v[68:71]
    ds_read_b128 v[52:55], v18 offset:14336
    v_mfma_f32_16x16x32_bf16 v[72:75], v[112:115], v[136:139], v[72:75]
    ds_read_b128 v[56:59], v18 offset:16384
    v_mfma_f32_16x16x32_bf16 v[76:79], v[116:119], v[128:131], v[76:79]
    v_xor_b32 v28, 0x10000, v28
    ds_read_b64_tr_b16 v[32:33], v28 offset:0
    ds_read_b64_tr_b16 v[34:35], v28 offset:2048
    v_mfma_f32_16x16x32_bf16 v[80:83], v[116:119], v[132:135], v[80:83]
    v_xor_b32 v29, 0x10000, v29
    ds_read_b64_tr_b16 v[36:37], v29 offset:0
    ds_read_b64_tr_b16 v[38:39], v29 offset:2048
    v_mfma_f32_16x16x32_bf16 v[84:87], v[116:119], v[136:139], v[84:87]
    v_xor_b32 v30, 0x10000, v30
    ds_read_b64_tr_b16 v[40:41], v30 offset:0
    ds_read_b64_tr_b16 v[42:43], v30 offset:2048
    v_mfma_f32_16x16x32_bf16 v[88:91], v[120:123], v[128:131], v[88:91]
    v_xor_b32 v60, 0x10000, v60
    ds_read_b64_tr_b16 v[44:45], v60 offset:0
    ds_read_b64_tr_b16 v[46:47], v60 offset:2048
    v_mfma_f32_16x16x32_bf16 v[92:95], v[120:123], v[132:135], v[92:95]
    v_mfma_f32_16x16x32_bf16 v[96:99], v[120:123], v[136:139], v[96:99]
    v_mfma_f32_16x16x32_bf16 v[100:103], v[124:127], v[128:131], v[100:103]
    v_mfma_f32_16x16x32_bf16 v[104:107], v[124:127], v[132:135], v[104:107]
    v_mfma_f32_16x16x32_bf16 v[108:111], v[124:127], v[136:139], v[108:111]
    s_waitcnt vmcnt(4)
    s_waitcnt lgkmcnt(0)
    s_barrier
    v_mfma_f32_16x16x32_bf16 v[64:67], v[32:35], v[48:51], v[64:67]
    ds_read_b128 v[128:131], v19 offset:12288
    v_mfma_f32_16x16x32_bf16 v[68:71], v[32:35], v[52:55], v[68:71]
    ds_read_b128 v[132:135], v19 offset:14336
    v_mfma_f32_16x16x32_bf16 v[72:75], v[32:35], v[56:59], v[72:75]
    ds_read_b128 v[136:139], v19 offset:16384
    v_mfma_f32_16x16x32_bf16 v[76:79], v[36:39], v[48:51], v[76:79]
    ds_read_b64_tr_b16 v[112:113], v28 offset:16384
    ds_read_b64_tr_b16 v[114:115], v28 offset:18432
    v_mfma_f32_16x16x32_bf16 v[80:83], v[36:39], v[52:55], v[80:83]
    ds_read_b64_tr_b16 v[116:117], v29 offset:16384
    ds_read_b64_tr_b16 v[118:119], v29 offset:18432
    v_mfma_f32_16x16x32_bf16 v[84:87], v[36:39], v[56:59], v[84:87]
    ds_read_b64_tr_b16 v[120:121], v30 offset:16384
    ds_read_b64_tr_b16 v[122:123], v30 offset:18432
    v_mfma_f32_16x16x32_bf16 v[88:91], v[40:43], v[48:51], v[88:91]
    ds_read_b64_tr_b16 v[124:125], v60 offset:16384
    ds_read_b64_tr_b16 v[126:127], v60 offset:18432
    v_mfma_f32_16x16x32_bf16 v[92:95], v[40:43], v[52:55], v[92:95]
    v_mfma_f32_16x16x32_bf16 v[96:99], v[40:43], v[56:59], v[96:99]
    v_mfma_f32_16x16x32_bf16 v[100:103], v[44:47], v[48:51], v[100:103]
    v_mfma_f32_16x16x32_bf16 v[104:107], v[44:47], v[52:55], v[104:107]
    v_mfma_f32_16x16x32_bf16 v[108:111], v[44:47], v[56:59], v[108:111]
    s_waitcnt lgkmcnt(0)
    s_barrier
    v_mfma_f32_16x16x32_bf16 v[64:67], v[112:115], v[128:131], v[64:67]
    v_mfma_f32_16x16x32_bf16 v[68:71], v[112:115], v[132:135], v[68:71]
    v_mfma_f32_16x16x32_bf16 v[72:75], v[112:115], v[136:139], v[72:75]
    v_mfma_f32_16x16x32_bf16 v[76:79], v[116:119], v[128:131], v[76:79]
    v_mfma_f32_16x16x32_bf16 v[80:83], v[116:119], v[132:135], v[80:83]
    v_mfma_f32_16x16x32_bf16 v[84:87], v[116:119], v[136:139], v[84:87]
    v_mfma_f32_16x16x32_bf16 v[88:91], v[120:123], v[128:131], v[88:91]
    v_mfma_f32_16x16x32_bf16 v[92:95], v[120:123], v[132:135], v[92:95]
    s_xor_b32 s64, s55, 65536
    buffer_load_dwordx4 v[192:195], v8, s[8:11], s64 offen offset:0 nt
    v_mfma_f32_16x16x32_bf16 v[96:99], v[120:123], v[136:139], v[96:99]
    v_mfma_f32_16x16x32_bf16 v[100:103], v[124:127], v[128:131], v[100:103]
    v_mfma_f32_16x16x32_bf16 v[104:107], v[124:127], v[132:135], v[104:107]
    s_xor_b32 s64, s55, 65536
    buffer_load_dwordx4 v[196:199], v9, s[8:11], s64 offen offset:1024 nt
    v_mfma_f32_16x16x32_bf16 v[108:111], v[124:127], v[136:139], v[108:111]
    s_xor_b32 s64, s55, 65536
    buffer_load_dwordx4 v[200:203], v10, s[8:11], s64 offen offset:2048 nt
    s_xor_b32 s64, s55, 65536
    buffer_load_dwordx4 v[204:207], v11, s[8:11], s64 offen offset:3072 nt
    v_cvt_pk_bf16_f32 v32, v64, v65
    v_cvt_pk_bf16_f32 v33, v66, v67
    ds_write_b64 v20, v[32:33] offset:0
    v_cvt_pk_bf16_f32 v34, v68, v69
    v_cvt_pk_bf16_f32 v35, v70, v71
    ds_write_b64 v20, v[34:35] offset:4096
    v_cvt_pk_bf16_f32 v36, v72, v73
    v_cvt_pk_bf16_f32 v37, v74, v75
    ds_write_b64 v20, v[36:37] offset:8192
    v_cvt_pk_bf16_f32 v38, v76, v77
    v_cvt_pk_bf16_f32 v39, v78, v79
    ds_write_b64 v20, v[38:39] offset:512
    v_cvt_pk_bf16_f32 v40, v80, v81
    v_cvt_pk_bf16_f32 v41, v82, v83
    ds_write_b64 v20, v[40:41] offset:4608
    v_cvt_pk_bf16_f32 v42, v84, v85
    v_cvt_pk_bf16_f32 v43, v86, v87
    ds_write_b64 v20, v[42:43] offset:8704
    v_cvt_pk_bf16_f32 v44, v88, v89
    v_cvt_pk_bf16_f32 v45, v90, v91
    ds_write_b64 v20, v[44:45] offset:1024
    v_cvt_pk_bf16_f32 v46, v92, v93
    v_cvt_pk_bf16_f32 v47, v94, v95
    ds_write_b64 v20, v[46:47] offset:5120
    v_cvt_pk_bf16_f32 v48, v96, v97
    v_cvt_pk_bf16_f32 v49, v98, v99
    ds_write_b64 v20, v[48:49] offset:9216
    v_cvt_pk_bf16_f32 v50, v100, v101
    v_cvt_pk_bf16_f32 v51, v102, v103
    ds_write_b64 v20, v[50:51] offset:1536
    v_cvt_pk_bf16_f32 v52, v104, v105
    v_cvt_pk_bf16_f32 v53, v106, v107
    ds_write_b64 v20, v[52:53] offset:5632
    v_cvt_pk_bf16_f32 v54, v108, v109
    v_cvt_pk_bf16_f32 v55, v110, v111
    ds_write_b64 v20, v[54:55] offset:9728
    v_bfe_u32 v1, v0, 2, 2
    v_and_b32 v2, 1, v5
    v_lshl_add_u32 v2, v2, 2, v1
    s_lshl_b32 s56, s51, 2
    s_xor_b32 s56, s56, 4
    v_xor_b32 v2, s56, v2
    v_lshl_add_u32 v3, v5, 2, v1
    v_lshlrev_b32 v3, 8, v3
    v_and_b32 v4, 3, v0
    v_lshl_add_u32 v3, v4, 3, v3
    s_lshl_b32 s56, s51, 13
    s_add_u32 s56, s56, s60
    v_add_u32 v3, s56, v3
    v_xor_b32 v4, 0, v2
    v_lshl_add_u32 v24, v4, 5, v3
    v_xor_b32 v4, 1, v2
    v_lshl_add_u32 v25, v4, 5, v3
    v_xor_b32 v4, 2, v2
    v_lshl_add_u32 v26, v4, 5, v3
    v_xor_b32 v4, 3, v2
    v_lshl_add_u32 v27, v4, 5, v3
    v_xor_b32 v4, 4, v2
    v_lshl_add_u32 v28, v4, 5, v3
    v_xor_b32 v4, 5, v2
    v_lshl_add_u32 v29, v4, 5, v3
    v_xor_b32 v4, 6, v2
    v_lshl_add_u32 v30, v4, 5, v3
    v_xor_b32 v4, 7, v2
    v_lshl_add_u32 v31, v4, 5, v3
    s_waitcnt lgkmcnt(0)
    s_barrier
    ds_read_b128 v[64:67], v21 offset:0
    ds_read_b128 v[80:83], v21 offset:4096
    ds_read_b128 v[96:99], v21 offset:8192
    ds_read_b128 v[68:71], v21 offset:1024
    ds_read_b128 v[84:87], v21 offset:5120
    ds_read_b128 v[100:103], v21 offset:9216
    ds_read_b128 v[72:75], v21 offset:2048
    ds_read_b128 v[88:91], v21 offset:6144
    ds_read_b128 v[104:107], v21 offset:10240
    ds_read_b128 v[76:79], v21 offset:3072
    ds_read_b128 v[92:95], v21 offset:7168
    ds_read_b128 v[108:111], v21 offset:11264
    ds_read_b128 v[32:35], v12 offset:0
    ds_read_b128 v[36:39], v13 offset:0
    ds_read_b128 v[40:43], v14 offset:0
    ds_read_b128 v[44:47], v15 offset:0
    ds_read_b128 v[48:51], v12 offset:4096
    ds_read_b128 v[52:55], v13 offset:4096
    ds_read_b128 v[56:59], v14 offset:4096
    ds_read_b128 v[60:63], v15 offset:4096
    s_xor_b32 s64, s55, 81920
    buffer_load_dwordx4 v[208:211], v8, s[8:11], s64 offen offset:0 nt
    s_xor_b32 s64, s55, 81920
    buffer_load_dwordx4 v[212:215], v9, s[8:11], s64 offen offset:1024 nt
    s_xor_b32 s64, s55, 81920
    buffer_load_dwordx4 v[216:219], v10, s[8:11], s64 offen offset:2048 nt
    s_xor_b32 s64, s55, 81920
    buffer_load_dwordx4 v[220:223], v11, s[8:11], s64 offen offset:3072 nt
    s_waitcnt lgkmcnt(0)
    s_barrier
    v_mfma_f32_16x16x32_bf16 v[112:115], v[32:35], v[64:67], 0
    v_mfma_f32_16x16x32_bf16 v[120:123], v[32:35], v[80:83], 0
    v_mfma_f32_16x16x32_bf16 v[128:131], v[32:35], v[96:99], 0
    s_add_u32 s58, s61, 32768
    v_add_u32 v4, s58, v7
    ds_write_b128 v4, v[160:163] offset:0
    ds_write_b128 v4, v[164:167] offset:1024
    ds_write_b128 v4, v[168:171] offset:2048
    ds_write_b128 v4, v[172:175] offset:3072
    v_mfma_f32_16x16x32_bf16 v[112:115], v[36:39], v[68:71], v[112:115]
    v_mfma_f32_16x16x32_bf16 v[120:123], v[36:39], v[84:87], v[120:123]
    v_mfma_f32_16x16x32_bf16 v[128:131], v[36:39], v[100:103], v[128:131]
    v_mfma_f32_16x16x32_bf16 v[112:115], v[40:43], v[72:75], v[112:115]
    v_mfma_f32_16x16x32_bf16 v[120:123], v[40:43], v[88:91], v[120:123]
    v_mfma_f32_16x16x32_bf16 v[128:131], v[40:43], v[104:107], v[128:131]
    s_waitcnt vmcnt(8)
    s_add_u32 s58, s61, 49152
    v_add_u32 v4, s58, v7
    ds_write_b128 v4, v[176:179] offset:0
    ds_write_b128 v4, v[180:183] offset:1024
    ds_write_b128 v4, v[184:187] offset:2048
    ds_write_b128 v4, v[188:191] offset:3072
    v_mfma_f32_16x16x32_bf16 v[112:115], v[44:47], v[76:79], v[112:115]
    v_mfma_f32_16x16x32_bf16 v[120:123], v[44:47], v[92:95], v[120:123]
    v_mfma_f32_16x16x32_bf16 v[128:131], v[44:47], v[108:111], v[128:131]
    v_mfma_f32_16x16x32_bf16 v[116:119], v[48:51], v[64:67], 0
    v_mfma_f32_16x16x32_bf16 v[124:127], v[48:51], v[80:83], 0
    v_mfma_f32_16x16x32_bf16 v[132:135], v[48:51], v[96:99], 0
    v_mfma_f32_16x16x32_bf16 v[116:119], v[52:55], v[68:71], v[116:119]
    v_mfma_f32_16x16x32_bf16 v[124:127], v[52:55], v[84:87], v[124:127]
    v_mfma_f32_16x16x32_bf16 v[132:135], v[52:55], v[100:103], v[132:135]
    v_mfma_f32_16x16x32_bf16 v[116:119], v[56:59], v[72:75], v[116:119]
    v_mfma_f32_16x16x32_bf16 v[124:127], v[56:59], v[88:91], v[124:127]
    v_mfma_f32_16x16x32_bf16 v[132:135], v[56:59], v[104:107], v[132:135]
    v_mfma_f32_16x16x32_bf16 v[116:119], v[60:63], v[76:79], v[116:119]
    v_mfma_f32_16x16x32_bf16 v[124:127], v[60:63], v[92:95], v[124:127]
    v_mfma_f32_16x16x32_bf16 v[132:135], v[60:63], v[108:111], v[132:135]
    v_max3_f32 v18, v112, v113, v114
    v_max3_f32 v19, v120, v121, v122
    v_max3_f32 v20, v128, v129, v130
    s_nop 2
    v_max3_f32 v18, v18, v115, v116
    v_max3_f32 v19, v19, v123, v124
    v_max3_f32 v20, v20, v131, v132
    v_max3_f32 v18, v18, v117, v118
    v_max3_f32 v19, v19, v125, v126
    v_max3_f32 v20, v20, v133, v134
    v_max_f32 v18, v18, v119
    v_max_f32 v19, v19, v127
    v_max_f32 v20, v20, v135
    v_mov_b32 v136, v18
    v_mov_b32 v137, v19
    v_mov_b32 v138, v20
    v_permlane32_swap_b32 v18, v136
    v_permlane32_swap_b32 v19, v137
    v_permlane32_swap_b32 v20, v138
    v_max_f32 v18, v18, v136
    v_max_f32 v19, v19, v137
    v_max_f32 v20, v20, v138
    v_mov_b32 v136, v18
    v_mov_b32 v137, v19
    v_mov_b32 v138, v20
    v_permlane16_swap_b32 v18, v136
    v_permlane16_swap_b32 v19, v137
    v_permlane16_swap_b32 v20, v138
    v_max_f32 v18, v18, v136
    v_max_f32 v19, v19, v137
    v_max_f32 v20, v20, v138
    v_mul_f32 v18, s59, v18
    v_mul_f32 v19, s59, v19
    v_mul_f32 v20, s59, v20
    v_fma_f32 v112, v112, s59, -v18
    v_fma_f32 v120, v120, s59, -v19
    v_fma_f32 v128, v128, s59, -v20
    v_fma_f32 v113, v113, s59, -v18
    v_fma_f32 v121, v121, s59, -v19
    v_fma_f32 v129, v129, s59, -v20
    v_fma_f32 v114, v114, s59, -v18
    v_fma_f32 v122, v122, s59, -v19
    v_fma_f32 v130, v130, s59, -v20
    v_fma_f32 v115, v115, s59, -v18
    v_fma_f32 v123, v123, s59, -v19
    v_fma_f32 v131, v131, s59, -v20
    ds_read_b128 v[32:35], v12 offset:16384
    ds_read_b128 v[36:39], v13 offset:16384
    v_fma_f32 v116, v116, s59, -v18
    v_fma_f32 v124, v124, s59, -v19
    v_fma_f32 v132, v132, s59, -v20
    v_fma_f32 v117, v117, s59, -v18
    v_fma_f32 v125, v125, s59, -v19
    v_fma_f32 v133, v133, s59, -v20
    v_fma_f32 v118, v118, s59, -v18
    v_fma_f32 v126, v126, s59, -v19
    v_fma_f32 v134, v134, s59, -v20
    v_fma_f32 v119, v119, s59, -v18
    v_fma_f32 v127, v127, s59, -v19
    v_fma_f32 v135, v135, s59, -v20
    ds_read_b128 v[40:43], v14 offset:16384
    ds_read_b128 v[44:47], v15 offset:16384
    ds_read_b128 v[48:51], v12 offset:20480
    ds_read_b128 v[52:55], v13 offset:20480
    v_exp_f32 v112, v112
    v_exp_f32 v120, v120
    v_exp_f32 v128, v128
    ds_read_b128 v[56:59], v14 offset:20480
    ds_read_b128 v[60:63], v15 offset:20480
    v_exp_f32 v113, v113
    v_exp_f32 v121, v121
    v_exp_f32 v129, v129
    v_exp_f32 v114, v114
    v_exp_f32 v122, v122
    v_exp_f32 v130, v130
    v_add_f32 v21, v112, v113
    v_add_f32 v22, v120, v121
    v_add_f32 v23, v128, v129
    v_cvt_pk_bf16_f32 v148, v112, v113
    v_cvt_pk_bf16_f32 v152, v120, v121
    v_cvt_pk_bf16_f32 v156, v128, v129
    v_exp_f32 v115, v115
    v_exp_f32 v123, v123
    v_exp_f32 v131, v131
    v_add_f32 v21, v21, v114
    v_add_f32 v22, v22, v122
    v_add_f32 v23, v23, v130
    v_exp_f32 v116, v116
    v_exp_f32 v124, v124
    v_exp_f32 v132, v132
    v_add_f32 v21, v21, v115
    v_add_f32 v22, v22, v123
    v_add_f32 v23, v23, v131
    v_cvt_pk_bf16_f32 v149, v114, v115
    v_cvt_pk_bf16_f32 v153, v122, v123
    v_cvt_pk_bf16_f32 v157, v130, v131
    v_exp_f32 v117, v117
    v_exp_f32 v125, v125
    v_exp_f32 v133, v133
    v_add_f32 v21, v21, v116
    v_add_f32 v22, v22, v124
    v_add_f32 v23, v23, v132
    v_exp_f32 v118, v118
    v_exp_f32 v126, v126
    v_exp_f32 v134, v134
    v_add_f32 v21, v21, v117
    v_add_f32 v22, v22, v125
    v_add_f32 v23, v23, v133
    v_cvt_pk_bf16_f32 v150, v116, v117
    v_cvt_pk_bf16_f32 v154, v124, v125
    v_cvt_pk_bf16_f32 v158, v132, v133
    v_exp_f32 v119, v119
    v_exp_f32 v127, v127
    v_exp_f32 v135, v135
    v_add_f32 v21, v21, v118
    v_add_f32 v22, v22, v126
    v_add_f32 v23, v23, v134
    v_add_f32 v21, v21, v119
    v_add_f32 v22, v22, v127
    v_add_f32 v23, v23, v135
    v_cvt_pk_bf16_f32 v151, v118, v119
    v_cvt_pk_bf16_f32 v155, v126, v127
    v_cvt_pk_bf16_f32 v159, v134, v135
    s_waitcnt lgkmcnt(0)
    s_barrier
    v_mfma_f32_16x16x32_bf16 v[112:115], v[32:35], v[64:67], 0
    v_mfma_f32_16x16x32_bf16 v[120:123], v[32:35], v[80:83], 0
    v_mfma_f32_16x16x32_bf16 v[128:131], v[32:35], v[96:99], 0
    s_waitcnt vmcnt(4)
    s_add_u32 s58, s61, 0
    v_add_u32 v4, s58, v7
    ds_write_b128 v4, v[192:195] offset:0
    ds_write_b128 v4, v[196:199] offset:1024
    ds_write_b128 v4, v[200:203] offset:2048
    ds_write_b128 v4, v[204:207] offset:3072
    v_mfma_f32_16x16x32_bf16 v[112:115], v[36:39], v[68:71], v[112:115]
    v_mfma_f32_16x16x32_bf16 v[120:123], v[36:39], v[84:87], v[120:123]
    v_mfma_f32_16x16x32_bf16 v[128:131], v[36:39], v[100:103], v[128:131]
    v_mfma_f32_16x16x32_bf16 v[112:115], v[40:43], v[72:75], v[112:115]
    v_mfma_f32_16x16x32_bf16 v[120:123], v[40:43], v[88:91], v[120:123]
    v_mfma_f32_16x16x32_bf16 v[128:131], v[40:43], v[104:107], v[128:131]
    v_mfma_f32_16x16x32_bf16 v[112:115], v[44:47], v[76:79], v[112:115]
    v_mfma_f32_16x16x32_bf16 v[120:123], v[44:47], v[92:95], v[120:123]
    v_mfma_f32_16x16x32_bf16 v[128:131], v[44:47], v[108:111], v[128:131]
    v_mfma_f32_16x16x32_bf16 v[116:119], v[48:51], v[64:67], 0
    v_mfma_f32_16x16x32_bf16 v[124:127], v[48:51], v[80:83], 0
    v_mfma_f32_16x16x32_bf16 v[132:135], v[48:51], v[96:99], 0
    v_mfma_f32_16x16x32_bf16 v[116:119], v[52:55], v[68:71], v[116:119]
    v_mfma_f32_16x16x32_bf16 v[124:127], v[52:55], v[84:87], v[124:127]
    v_mfma_f32_16x16x32_bf16 v[132:135], v[52:55], v[100:103], v[132:135]
    v_mfma_f32_16x16x32_bf16 v[116:119], v[56:59], v[72:75], v[116:119]
    v_mfma_f32_16x16x32_bf16 v[124:127], v[56:59], v[88:91], v[124:127]
    v_mfma_f32_16x16x32_bf16 v[132:135], v[56:59], v[104:107], v[132:135]
    v_mfma_f32_16x16x32_bf16 v[116:119], v[60:63], v[76:79], v[116:119]
    v_mfma_f32_16x16x32_bf16 v[124:127], v[60:63], v[92:95], v[124:127]
    v_mfma_f32_16x16x32_bf16 v[132:135], v[60:63], v[108:111], v[132:135]
    v_fma_f32 v112, v112, s59, -v18
    v_fma_f32 v120, v120, s59, -v19
    v_fma_f32 v128, v128, s59, -v20
    v_fma_f32 v113, v113, s59, -v18
    v_fma_f32 v121, v121, s59, -v19
    v_fma_f32 v129, v129, s59, -v20
    v_fma_f32 v114, v114, s59, -v18
    v_fma_f32 v122, v122, s59, -v19
    v_fma_f32 v130, v130, s59, -v20
    v_fma_f32 v115, v115, s59, -v18
    v_fma_f32 v123, v123, s59, -v19
    v_fma_f32 v131, v131, s59, -v20
    ds_read_b128 v[32:35], v12 offset:32768
    ds_read_b128 v[36:39], v13 offset:32768
    v_fma_f32 v116, v116, s59, -v18
    v_fma_f32 v124, v124, s59, -v19
    v_fma_f32 v132, v132, s59, -v20
    v_fma_f32 v117, v117, s59, -v18
    v_fma_f32 v125, v125, s59, -v19
    v_fma_f32 v133, v133, s59, -v20
    v_fma_f32 v118, v118, s59, -v18
    v_fma_f32 v126, v126, s59, -v19
    v_fma_f32 v134, v134, s59, -v20
    v_fma_f32 v119, v119, s59, -v18
    v_fma_f32 v127, v127, s59, -v19
    v_fma_f32 v135, v135, s59, -v20
    ds_read_b128 v[40:43], v14 offset:32768
    ds_read_b128 v[44:47], v15 offset:32768
    v_max3_f32 v136, v112, v113, v114
    v_max3_f32 v137, v120, v121, v122
    v_max3_f32 v138, v128, v129, v130
    v_max3_f32 v136, v136, v115, v116
    v_max3_f32 v137, v137, v123, v124
    v_max3_f32 v138, v138, v131, v132
    v_max3_f32 v136, v136, v117, v118
    v_max3_f32 v137, v137, v125, v126
    v_max3_f32 v138, v138, v133, v134
    v_max_f32 v136, v136, v119
    v_max_f32 v137, v137, v127
    v_max_f32 v138, v138, v135
    v_max3_f32 v139, v136, v137, v138
    v_cmp_lt_f32 vcc, s29, v139
    s_mov_b32 s28, 1
    s_nop 3
    s_cbranch_vccnz K1_SLOW_1
K1_RET1_1:
    ds_read_b128 v[48:51], v12 offset:36864
    ds_read_b128 v[52:55], v13 offset:36864
    v_exp_f32 v112, v112
    v_exp_f32 v120, v120
    v_exp_f32 v128, v128
    ds_read_b128 v[56:59], v14 offset:36864
    ds_read_b128 v[60:63], v15 offset:36864
    s_xor_b32 s64, s55, 98304
    buffer_load_dwordx4 v[224:227], v8, s[8:11], s64 offen offset:0 nt
    v_exp_f32 v113, v113
    v_exp_f32 v121, v121
    v_exp_f32 v129, v129
    v_add_f32 v21, v21, v112
    v_add_f32 v22, v22, v120
    v_add_f32 v23, v23, v128
    s_xor_b32 s64, s55, 98304
    buffer_load_dwordx4 v[228:231], v9, s[8:11], s64 offen offset:1024 nt
    v_exp_f32 v114, v114
    v_exp_f32 v122, v122
    v_exp_f32 v130, v130
    v_add_f32 v21, v21, v113
    v_add_f32 v22, v22, v121
    v_add_f32 v23, v23, v129
    v_cvt_pk_bf16_f32 v160, v112, v113
    v_cvt_pk_bf16_f32 v164, v120, v121
    v_cvt_pk_bf16_f32 v168, v128, v129
    s_xor_b32 s64, s55, 98304
    buffer_load_dwordx4 v[232:235], v10, s[8:11], s64 offen offset:2048 nt
    v_exp_f32 v115, v115
    v_exp_f32 v123, v123
    v_exp_f32 v131, v131
    v_add_f32 v21, v21, v114
    v_add_f32 v22, v22, v122
    v_add_f32 v23, v23, v130
    s_xor_b32 s64, s55, 98304
    buffer_load_dwordx4 v[236:239], v11, s[8:11], s64 offen offset:3072 nt
    v_exp_f32 v116, v116
    v_exp_f32 v124, v124
    v_exp_f32 v132, v132
    v_add_f32 v21, v21, v115
    v_add_f32 v22, v22, v123
    v_add_f32 v23, v23, v131
    v_cvt_pk_bf16_f32 v161, v114, v115
    v_cvt_pk_bf16_f32 v165, v122, v123
    v_cvt_pk_bf16_f32 v169, v130, v131
    v_exp_f32 v117, v117
    v_exp_f32 v125, v125
    v_exp_f32 v133, v133
    v_add_f32 v21, v21, v116
    v_add_f32 v22, v22, v124
    v_add_f32 v23, v23, v132
    v_exp_f32 v118, v118
    v_exp_f32 v126, v126
    v_exp_f32 v134, v134
    v_add_f32 v21, v21, v117
    v_add_f32 v22, v22, v125
    v_add_f32 v23, v23, v133
    v_cvt_pk_bf16_f32 v162, v116, v117
    v_cvt_pk_bf16_f32 v166, v124, v125
    v_cvt_pk_bf16_f32 v170, v132, v133
    v_exp_f32 v119, v119
    v_exp_f32 v127, v127
    v_exp_f32 v135, v135
    v_add_f32 v21, v21, v118
    v_add_f32 v22, v22, v126
    v_add_f32 v23, v23, v134
    v_add_f32 v21, v21, v119
    v_add_f32 v22, v22, v127
    v_add_f32 v23, v23, v135
    v_cvt_pk_bf16_f32 v163, v118, v119
    v_cvt_pk_bf16_f32 v167, v126, v127
    v_cvt_pk_bf16_f32 v171, v134, v135
    s_waitcnt lgkmcnt(0)
    s_barrier
    v_mfma_f32_16x16x32_bf16 v[112:115], v[32:35], v[64:67], 0
    v_mfma_f32_16x16x32_bf16 v[120:123], v[32:35], v[80:83], 0
    v_mfma_f32_16x16x32_bf16 v[128:131], v[32:35], v[96:99], 0
    s_waitcnt vmcnt(4)
    s_add_u32 s58, s61, 16384
    v_add_u32 v4, s58, v7
    ds_write_b128 v4, v[208:211] offset:0
    ds_write_b128 v4, v[212:215] offset:1024
    ds_write_b128 v4, v[216:219] offset:2048
    ds_write_b128 v4, v[220:223] offset:3072
    v_mfma_f32_16x16x32_bf16 v[112:115], v[36:39], v[68:71], v[112:115]
    v_mfma_f32_16x16x32_bf16 v[120:123], v[36:39], v[84:87], v[120:123]
    v_mfma_f32_16x16x32_bf16 v[128:131], v[36:39], v[100:103], v[128:131]
    v_mfma_f32_16x16x32_bf16 v[112:115], v[40:43], v[72:75], v[112:115]
    v_mfma_f32_16x16x32_bf16 v[120:123], v[40:43], v[88:91], v[120:123]
    v_mfma_f32_16x16x32_bf16 v[128:131], v[40:43], v[104:107], v[128:131]
    v_mfma_f32_16x16x32_bf16 v[112:115], v[44:47], v[76:79], v[112:115]
    v_mfma_f32_16x16x32_bf16 v[120:123], v[44:47], v[92:95], v[120:123]
    v_mfma_f32_16x16x32_bf16 v[128:131], v[44:47], v[108:111], v[128:131]
    v_mfma_f32_16x16x32_bf16 v[116:119], v[48:51], v[64:67], 0
    v_mfma_f32_16x16x32_bf16 v[124:127], v[48:51], v[80:83], 0
    v_mfma_f32_16x16x32_bf16 v[132:135], v[48:51], v[96:99], 0
    v_mfma_f32_16x16x32_bf16 v[116:119], v[52:55], v[68:71], v[116:119]
    v_mfma_f32_16x16x32_bf16 v[124:127], v[52:55], v[84:87], v[124:127]
    v_mfma_f32_16x16x32_bf16 v[132:135], v[52:55], v[100:103], v[132:135]
    v_mfma_f32_16x16x32_bf16 v[116:119], v[56:59], v[72:75], v[116:119]
    v_mfma_f32_16x16x32_bf16 v[124:127], v[56:59], v[88:91], v[124:127]
    v_mfma_f32_16x16x32_bf16 v[132:135], v[56:59], v[104:107], v[132:135]
    v_mfma_f32_16x16x32_bf16 v[116:119], v[60:63], v[76:79], v[116:119]
    v_mfma_f32_16x16x32_bf16 v[124:127], v[60:63], v[92:95], v[124:127]
    v_mfma_f32_16x16x32_bf16 v[132:135], v[60:63], v[108:111], v[132:135]
    v_fma_f32 v112, v112, s59, -v18
    v_fma_f32 v120, v120, s59, -v19
    v_fma_f32 v128, v128, s59, -v20
    v_fma_f32 v113, v113, s59, -v18
    v_fma_f32 v121, v121, s59, -v19
    v_fma_f32 v129, v129, s59, -v20
    v_fma_f32 v114, v114, s59, -v18
    v_fma_f32 v122, v122, s59, -v19
    v_fma_f32 v130, v130, s59, -v20
    v_fma_f32 v115, v115, s59, -v18
    v_fma_f32 v123, v123, s59, -v19
    v_fma_f32 v131, v131, s59, -v20
    ds_read_b128 v[32:35], v12 offset:49152
    ds_read_b128 v[36:39], v13 offset:49152
    v_fma_f32 v116, v116, s59, -v18
    v_fma_f32 v124, v124, s59, -v19
    v_fma_f32 v132, v132, s59, -v20
    v_fma_f32 v117, v117, s59, -v18
    v_fma_f32 v125, v125, s59, -v19
    v_fma_f32 v133, v133, s59, -v20
    v_fma_f32 v118, v118, s59, -v18
    v_fma_f32 v126, v126, s59, -v19
    v_fma_f32 v134, v134, s59, -v20
    v_fma_f32 v119, v119, s59, -v18
    v_fma_f32 v127, v127, s59, -v19
    v_fma_f32 v135, v135, s59, -v20
    ds_read_b128 v[40:43], v14 offset:49152
    ds_read_b128 v[44:47], v15 offset:49152
    v_max3_f32 v136, v112, v113, v114
    v_max3_f32 v137, v120, v121, v122
    v_max3_f32 v138, v128, v129, v130
    v_max3_f32 v136, v136, v115, v116
    v_max3_f32 v137, v137, v123, v124
    v_max3_f32 v138, v138, v131, v132
    v_max3_f32 v136, v136, v117, v118
    v_max3_f32 v137, v137, v125, v126
    v_max3_f32 v138, v138, v133, v134
    v_max_f32 v136, v136, v119
    v_max_f32 v137, v137, v127
    v_max_f32 v138, v138, v135
    v_max3_f32 v139, v136, v137, v138
    v_cmp_lt_f32 vcc, s29, v139
    s_mov_b32 s28, 2
    s_nop 3
    s_cbranch_vccnz K1_SLOW_1
K1_RET2_1:
    ds_read_b128 v[48:51], v12 offset:53248
    ds_read_b128 v[52:55], v13 offset:53248
    v_exp_f32 v112, v112
    v_exp_f32 v120, v120
    v_exp_f32 v128, v128
    ds_read_b128 v[56:59], v14 offset:53248
    ds_read_b128 v[60:63], v15 offset:53248
    s_xor_b32 s64, s55, 114688
    buffer_load_dwordx4 v[240:243], v8, s[8:11], s64 offen offset:0 nt
    v_exp_f32 v113, v113
    v_exp_f32 v121, v121
    v_exp_f32 v129, v129
    v_add_f32 v21, v21, v112
    v_add_f32 v22, v22, v120
    v_add_f32 v23, v23, v128
    s_xor_b32 s64, s55, 114688
    buffer_load_dwordx4 v[244:247], v9, s[8:11], s64 offen offset:1024 nt
    v_exp_f32 v114, v114
    v_exp_f32 v122, v122
    v_exp_f32 v130, v130
    v_add_f32 v21, v21, v113
    v_add_f32 v22, v22, v121
    v_add_f32 v23, v23, v129
    v_cvt_pk_bf16_f32 v172, v112, v113
    v_cvt_pk_bf16_f32 v176, v120, v121
    v_cvt_pk_bf16_f32 v180, v128, v129
    s_xor_b32 s64, s55, 114688
    buffer_load_dwordx4 v[248:251], v10, s[8:11], s64 offen offset:2048 nt
    v_exp_f32 v115, v115
    v_exp_f32 v123, v123
    v_exp_f32 v131, v131
    v_add_f32 v21, v21, v114
    v_add_f32 v22, v22, v122
    v_add_f32 v23, v23, v130
    s_xor_b32 s64, s55, 114688
    buffer_load_dwordx4 v[252:255], v11, s[8:11], s64 offen offset:3072 nt
    v_exp_f32 v116, v116
    v_exp_f32 v124, v124
    v_exp_f32 v132, v132
    v_add_f32 v21, v21, v115
    v_add_f32 v22, v22, v123
    v_add_f32 v23, v23, v131
    v_cvt_pk_bf16_f32 v173, v114, v115
    v_cvt_pk_bf16_f32 v177, v122, v123
    v_cvt_pk_bf16_f32 v181, v130, v131
    v_exp_f32 v117, v117
    v_exp_f32 v125, v125
    v_exp_f32 v133, v133
    v_add_f32 v21, v21, v116
    v_add_f32 v22, v22, v124
    v_add_f32 v23, v23, v132
    v_exp_f32 v118, v118
    v_exp_f32 v126, v126
    v_exp_f32 v134, v134
    v_add_f32 v21, v21, v117
    v_add_f32 v22, v22, v125
    v_add_f32 v23, v23, v133
    v_cvt_pk_bf16_f32 v174, v116, v117
    v_cvt_pk_bf16_f32 v178, v124, v125
    v_cvt_pk_bf16_f32 v182, v132, v133
    v_exp_f32 v119, v119
    v_exp_f32 v127, v127
    v_exp_f32 v135, v135
    v_add_f32 v21, v21, v118
    v_add_f32 v22, v22, v126
    v_add_f32 v23, v23, v134
    v_add_f32 v21, v21, v119
    v_add_f32 v22, v22, v127
    v_add_f32 v23, v23, v135
    v_cvt_pk_bf16_f32 v175, v118, v119
    v_cvt_pk_bf16_f32 v179, v126, v127
    v_cvt_pk_bf16_f32 v183, v134, v135
    s_waitcnt lgkmcnt(0)
    s_barrier
    v_mfma_f32_16x16x32_bf16 v[112:115], v[32:35], v[64:67], 0
    v_mfma_f32_16x16x32_bf16 v[120:123], v[32:35], v[80:83], 0
    v_mfma_f32_16x16x32_bf16 v[128:131], v[32:35], v[96:99], 0
    s_waitcnt vmcnt(4)
    s_add_u32 s58, s61, 32768
    v_add_u32 v4, s58, v7
    ds_write_b128 v4, v[224:227] offset:0
    ds_write_b128 v4, v[228:231] offset:1024
    ds_write_b128 v4, v[232:235] offset:2048
    ds_write_b128 v4, v[236:239] offset:3072
    v_mfma_f32_16x16x32_bf16 v[112:115], v[36:39], v[68:71], v[112:115]
    v_mfma_f32_16x16x32_bf16 v[120:123], v[36:39], v[84:87], v[120:123]
    v_mfma_f32_16x16x32_bf16 v[128:131], v[36:39], v[100:103], v[128:131]
    v_mfma_f32_16x16x32_bf16 v[112:115], v[40:43], v[72:75], v[112:115]
    v_mfma_f32_16x16x32_bf16 v[120:123], v[40:43], v[88:91], v[120:123]
    v_mfma_f32_16x16x32_bf16 v[128:131], v[40:43], v[104:107], v[128:131]
    v_mfma_f32_16x16x32_bf16 v[112:115], v[44:47], v[76:79], v[112:115]
    v_mfma_f32_16x16x32_bf16 v[120:123], v[44:47], v[92:95], v[120:123]
    v_mfma_f32_16x16x32_bf16 v[128:131], v[44:47], v[108:111], v[128:131]
    v_mfma_f32_16x16x32_bf16 v[116:119], v[48:51], v[64:67], 0
    v_mfma_f32_16x16x32_bf16 v[124:127], v[48:51], v[80:83], 0
    v_mfma_f32_16x16x32_bf16 v[132:135], v[48:51], v[96:99], 0
    v_mfma_f32_16x16x32_bf16 v[116:119], v[52:55], v[68:71], v[116:119]
    v_mfma_f32_16x16x32_bf16 v[124:127], v[52:55], v[84:87], v[124:127]
    v_mfma_f32_16x16x32_bf16 v[132:135], v[52:55], v[100:103], v[132:135]
    v_mfma_f32_16x16x32_bf16 v[116:119], v[56:59], v[72:75], v[116:119]
    v_mfma_f32_16x16x32_bf16 v[124:127], v[56:59], v[88:91], v[124:127]
    v_mfma_f32_16x16x32_bf16 v[132:135], v[56:59], v[104:107], v[132:135]
    v_mfma_f32_16x16x32_bf16 v[116:119], v[60:63], v[76:79], v[116:119]
    v_mfma_f32_16x16x32_bf16 v[124:127], v[60:63], v[92:95], v[124:127]
    v_mfma_f32_16x16x32_bf16 v[132:135], v[60:63], v[108:111], v[132:135]
    v_fma_f32 v112, v112, s59, -v18
    v_fma_f32 v120, v120, s59, -v19
    v_fma_f32 v128, v128, s59, -v20
    v_fma_f32 v113, v113, s59, -v18
    v_fma_f32 v121, v121, s59, -v19
    v_fma_f32 v129, v129, s59, -v20
    v_fma_f32 v114, v114, s59, -v18
    v_fma_f32 v122, v122, s59, -v19
    v_fma_f32 v130, v130, s59, -v20
    v_fma_f32 v115, v115, s59, -v18
    v_fma_f32 v123, v123, s59, -v19
    v_fma_f32 v131, v131, s59, -v20
    ds_read_b128 v[32:35], v12 offset:0
    ds_read_b128 v[36:39], v13 offset:0
    v_fma_f32 v116, v116, s59, -v18
    v_fma_f32 v124, v124, s59, -v19
    v_fma_f32 v132, v132, s59, -v20
    v_fma_f32 v117, v117, s59, -v18
    v_fma_f32 v125, v125, s59, -v19
    v_fma_f32 v133, v133, s59, -v20
    v_fma_f32 v118, v118, s59, -v18
    v_fma_f32 v126, v126, s59, -v19
    v_fma_f32 v134, v134, s59, -v20
    v_fma_f32 v119, v119, s59, -v18
    v_fma_f32 v127, v127, s59, -v19
    v_fma_f32 v135, v135, s59, -v20
    ds_read_b128 v[40:43], v14 offset:0
    ds_read_b128 v[44:47], v15 offset:0
    v_max3_f32 v136, v112, v113, v114
    v_max3_f32 v137, v120, v121, v122
    v_max3_f32 v138, v128, v129, v130
    v_max3_f32 v136, v136, v115, v116
    v_max3_f32 v137, v137, v123, v124
    v_max3_f32 v138, v138, v131, v132
    v_max3_f32 v136, v136, v117, v118
    v_max3_f32 v137, v137, v125, v126
    v_max3_f32 v138, v138, v133, v134
    v_max_f32 v136, v136, v119
    v_max_f32 v137, v137, v127
    v_max_f32 v138, v138, v135
    v_max3_f32 v139, v136, v137, v138
    v_cmp_lt_f32 vcc, s29, v139
    s_mov_b32 s28, 3
    s_nop 3
    s_cbranch_vccnz K1_SLOW_1
K1_RET3_1:
    ds_read_b128 v[48:51], v12 offset:4096
    ds_read_b128 v[52:55], v13 offset:4096
    v_exp_f32 v112, v112
    v_exp_f32 v120, v120
    v_exp_f32 v128, v128
    ds_read_b128 v[56:59], v14 offset:4096
    ds_read_b128 v[60:63], v15 offset:4096
    s_add_u32 m0, s61, 81920
    s_mov_b32 s64, s55
    buffer_load_dwordx4 v16, s[12:15], s64 offen offset:0 nt lds
    v_exp_f32 v113, v113
    v_exp_f32 v121, v121
    v_exp_f32 v129, v129
    v_add_f32 v21, v21, v112
    v_add_f32 v22, v22, v120
    v_add_f32 v23, v23, v128
    s_add_u32 m0, s61, 81920
    s_mov_b32 s64, s55
    buffer_load_dwordx4 v17, s[12:15], s64 offen offset:1024 nt lds
    v_exp_f32 v114, v114
    v_exp_f32 v122, v122
    v_exp_f32 v130, v130
    v_add_f32 v21, v21, v113
    v_add_f32 v22, v22, v121
    v_add_f32 v23, v23, v129
    v_cvt_pk_bf16_f32 v184, v112, v113
    v_cvt_pk_bf16_f32 v188, v120, v121
    v_cvt_pk_bf16_f32 v192, v128, v129
    s_add_u32 m0, s61, 81920
    s_mov_b32 s64, s55
    buffer_load_dwordx4 v16, s[12:15], s64 offen offset:2048 nt lds
    v_exp_f32 v115, v115
    v_exp_f32 v123, v123
    v_exp_f32 v131, v131
    v_add_f32 v21, v21, v114
    v_add_f32 v22, v22, v122
    v_add_f32 v23, v23, v130
    s_add_u32 m0, s61, 81920
    s_mov_b32 s64, s55
    buffer_load_dwordx4 v17, s[12:15], s64 offen offset:3072 nt lds
    v_exp_f32 v116, v116
    v_exp_f32 v124, v124
    v_exp_f32 v132, v132
    v_add_f32 v21, v21, v115
    v_add_f32 v22, v22, v123
    v_add_f32 v23, v23, v131
    v_cvt_pk_bf16_f32 v185, v114, v115
    v_cvt_pk_bf16_f32 v189, v122, v123
    v_cvt_pk_bf16_f32 v193, v130, v131
    v_exp_f32 v117, v117
    v_exp_f32 v125, v125
    v_exp_f32 v133, v133
    v_add_f32 v21, v21, v116
    v_add_f32 v22, v22, v124
    v_add_f32 v23, v23, v132
    v_exp_f32 v118, v118
    v_exp_f32 v126, v126
    v_exp_f32 v134, v134
    v_add_f32 v21, v21, v117
    v_add_f32 v22, v22, v125
    v_add_f32 v23, v23, v133
    v_cvt_pk_bf16_f32 v186, v116, v117
    v_cvt_pk_bf16_f32 v190, v124, v125
    v_cvt_pk_bf16_f32 v194, v132, v133
    v_exp_f32 v119, v119
    v_exp_f32 v127, v127
    v_exp_f32 v135, v135
    v_add_f32 v21, v21, v118
    v_add_f32 v22, v22, v126
    v_add_f32 v23, v23, v134
    v_add_f32 v21, v21, v119
    v_add_f32 v22, v22, v127
    v_add_f32 v23, v23, v135
    v_cvt_pk_bf16_f32 v187, v118, v119
    v_cvt_pk_bf16_f32 v191, v126, v127
    v_cvt_pk_bf16_f32 v195, v134, v135
    s_waitcnt lgkmcnt(0)
    s_barrier
    v_mfma_f32_16x16x32_bf16 v[112:115], v[32:35], v[64:67], 0
    v_mfma_f32_16x16x32_bf16 v[120:123], v[32:35], v[80:83], 0
    v_mfma_f32_16x16x32_bf16 v[128:131], v[32:35], v[96:99], 0
    s_waitcnt vmcnt(4)
    s_add_u32 s58, s61, 49152
    v_add_u32 v4, s58, v7
    ds_write_b128 v4, v[240:243] offset:0
    ds_write_b128 v4, v[244:247] offset:1024
    ds_write_b128 v4, v[248:251] offset:2048
    ds_write_b128 v4, v[252:255] offset:3072
    v_mfma_f32_16x16x32_bf16 v[112:115], v[36:39], v[68:71], v[112:115]
    v_mfma_f32_16x16x32_bf16 v[120:123], v[36:39], v[84:87], v[120:123]
    v_mfma_f32_16x16x32_bf16 v[128:131], v[36:39], v[100:103], v[128:131]
    v_mfma_f32_16x16x32_bf16 v[112:115], v[40:43], v[72:75], v[112:115]
    v_mfma_f32_16x16x32_bf16 v[120:123], v[40:43], v[88:91], v[120:123]
    v_mfma_f32_16x16x32_bf16 v[128:131], v[40:43], v[104:107], v[128:131]
    v_mfma_f32_16x16x32_bf16 v[112:115], v[44:47], v[76:79], v[112:115]
    v_mfma_f32_16x16x32_bf16 v[120:123], v[44:47], v[92:95], v[120:123]
    v_mfma_f32_16x16x32_bf16 v[128:131], v[44:47], v[108:111], v[128:131]
    v_mfma_f32_16x16x32_bf16 v[116:119], v[48:51], v[64:67], 0
    v_mfma_f32_16x16x32_bf16 v[124:127], v[48:51], v[80:83], 0
    v_mfma_f32_16x16x32_bf16 v[132:135], v[48:51], v[96:99], 0
    v_mfma_f32_16x16x32_bf16 v[116:119], v[52:55], v[68:71], v[116:119]
    v_mfma_f32_16x16x32_bf16 v[124:127], v[52:55], v[84:87], v[124:127]
    v_mfma_f32_16x16x32_bf16 v[132:135], v[52:55], v[100:103], v[132:135]
    v_mfma_f32_16x16x32_bf16 v[116:119], v[56:59], v[72:75], v[116:119]
    v_mfma_f32_16x16x32_bf16 v[124:127], v[56:59], v[88:91], v[124:127]
    v_mfma_f32_16x16x32_bf16 v[132:135], v[56:59], v[104:107], v[132:135]
    v_mfma_f32_16x16x32_bf16 v[116:119], v[60:63], v[76:79], v[116:119]
    v_mfma_f32_16x16x32_bf16 v[124:127], v[60:63], v[92:95], v[124:127]
    v_mfma_f32_16x16x32_bf16 v[132:135], v[60:63], v[108:111], v[132:135]
    v_fma_f32 v112, v112, s59, -v18
    v_fma_f32 v120, v120, s59, -v19
    v_fma_f32 v128, v128, s59, -v20
    v_fma_f32 v113, v113, s59, -v18
    v_fma_f32 v121, v121, s59, -v19
    v_fma_f32 v129, v129, s59, -v20
    v_fma_f32 v114, v114, s59, -v18
    v_fma_f32 v122, v122, s59, -v19
    v_fma_f32 v130, v130, s59, -v20
    v_fma_f32 v115, v115, s59, -v18
    v_fma_f32 v123, v123, s59, -v19
    v_fma_f32 v131, v131, s59, -v20
    ds_read_b128 v[32:35], v12 offset:16384
    ds_read_b128 v[36:39], v13 offset:16384
    v_fma_f32 v116, v116, s59, -v18
    v_fma_f32 v124, v124, s59, -v19
    v_fma_f32 v132, v132, s59, -v20
    v_fma_f32 v117, v117, s59, -v18
    v_fma_f32 v125, v125, s59, -v19
    v_fma_f32 v133, v133, s59, -v20
    v_fma_f32 v118, v118, s59, -v18
    v_fma_f32 v126, v126, s59, -v19
    v_fma_f32 v134, v134, s59, -v20
    v_fma_f32 v119, v119, s59, -v18
    v_fma_f32 v127, v127, s59, -v19
    v_fma_f32 v135, v135, s59, -v20
    ds_read_b128 v[40:43], v14 offset:16384
    ds_read_b128 v[44:47], v15 offset:16384
    v_max3_f32 v136, v112, v113, v114
    v_max3_f32 v137, v120, v121, v122
    v_max3_f32 v138, v128, v129, v130
    v_max3_f32 v136, v136, v115, v116
    v_max3_f32 v137, v137, v123, v124
    v_max3_f32 v138, v138, v131, v132
    v_max3_f32 v136, v136, v117, v118
    v_max3_f32 v137, v137, v125, v126
    v_max3_f32 v138, v138, v133, v134
    v_max_f32 v136, v136, v119
    v_max_f32 v137, v137, v127
    v_max_f32 v138, v138, v135
    v_max3_f32 v139, v136, v137, v138
    v_cmp_lt_f32 vcc, s29, v139
    s_mov_b32 s28, 4
    s_nop 3
    s_cbranch_vccnz K1_SLOW_1
K1_RET4_1:
    ds_read_b128 v[48:51], v12 offset:20480
    ds_read_b128 v[52:55], v13 offset:20480
    v_exp_f32 v112, v112
    v_exp_f32 v120, v120
    v_exp_f32 v128, v128
    ds_read_b128 v[56:59], v14 offset:20480
    ds_read_b128 v[60:63], v15 offset:20480
    s_mov_b32 m0, s61
    s_xor_b32 s64, s55, 16384
    buffer_load_dwordx4 v16, s[12:15], s64 offen offset:0 nt lds
    v_exp_f32 v113, v113
    v_exp_f32 v121, v121
    v_exp_f32 v129, v129
    v_add_f32 v21, v21, v112
    v_add_f32 v22, v22, v120
    v_add_f32 v23, v23, v128
    s_mov_b32 m0, s61
    s_xor_b32 s64, s55, 16384
    buffer_load_dwordx4 v17, s[12:15], s64 offen offset:1024 nt lds
    v_exp_f32 v114, v114
    v_exp_f32 v122, v122
    v_exp_f32 v130, v130
    v_add_f32 v21, v21, v113
    v_add_f32 v22, v22, v121
    v_add_f32 v23, v23, v129
    v_cvt_pk_bf16_f32 v196, v112, v113
    v_cvt_pk_bf16_f32 v200, v120, v121
    v_cvt_pk_bf16_f32 v204, v128, v129
    s_mov_b32 m0, s61
    s_xor_b32 s64, s55, 16384
    buffer_load_dwordx4 v16, s[12:15], s64 offen offset:2048 nt lds
    v_exp_f32 v115, v115
    v_exp_f32 v123, v123
    v_exp_f32 v131, v131
    v_add_f32 v21, v21, v114
    v_add_f32 v22, v22, v122
    v_add_f32 v23, v23, v130
    s_mov_b32 m0, s61
    s_xor_b32 s64, s55, 16384
    buffer_load_dwordx4 v17, s[12:15], s64 offen offset:3072 nt lds
    v_exp_f32 v116, v116
    v_exp_f32 v124, v124
    v_exp_f32 v132, v132
    v_add_f32 v21, v21, v115
    v_add_f32 v22, v22, v123
    v_add_f32 v23, v23, v131
    v_cvt_pk_bf16_f32 v197, v114, v115
    v_cvt_pk_bf16_f32 v201, v122, v123
    v_cvt_pk_bf16_f32 v205, v130, v131
    v_exp_f32 v117, v117
    v_exp_f32 v125, v125
    v_exp_f32 v133, v133
    v_add_f32 v21, v21, v116
    v_add_f32 v22, v22, v124
    v_add_f32 v23, v23, v132
    v_exp_f32 v118, v118
    v_exp_f32 v126, v126
    v_exp_f32 v134, v134
    v_add_f32 v21, v21, v117
    v_add_f32 v22, v22, v125
    v_add_f32 v23, v23, v133
    v_cvt_pk_bf16_f32 v198, v116, v117
    v_cvt_pk_bf16_f32 v202, v124, v125
    v_cvt_pk_bf16_f32 v206, v132, v133
    v_exp_f32 v119, v119
    v_exp_f32 v127, v127
    v_exp_f32 v135, v135
    v_add_f32 v21, v21, v118
    v_add_f32 v22, v22, v126
    v_add_f32 v23, v23, v134
    v_add_f32 v21, v21, v119
    v_add_f32 v22, v22, v127
    v_add_f32 v23, v23, v135
    v_cvt_pk_bf16_f32 v199, v118, v119
    v_cvt_pk_bf16_f32 v203, v126, v127
    v_cvt_pk_bf16_f32 v207, v134, v135
    s_waitcnt lgkmcnt(0)
    s_barrier
    v_mfma_f32_16x16x32_bf16 v[112:115], v[32:35], v[64:67], 0
    v_mfma_f32_16x16x32_bf16 v[120:123], v[32:35], v[80:83], 0
    v_mfma_f32_16x16x32_bf16 v[128:131], v[32:35], v[96:99], 0
    v_mfma_f32_16x16x32_bf16 v[112:115], v[36:39], v[68:71], v[112:115]
    v_mfma_f32_16x16x32_bf16 v[120:123], v[36:39], v[84:87], v[120:123]
    v_mfma_f32_16x16x32_bf16 v[128:131], v[36:39], v[100:103], v[128:131]
    v_mfma_f32_16x16x32_bf16 v[112:115], v[40:43], v[72:75], v[112:115]
    v_mfma_f32_16x16x32_bf16 v[120:123], v[40:43], v[88:91], v[120:123]
    v_mfma_f32_16x16x32_bf16 v[128:131], v[40:43], v[104:107], v[128:131]
    v_mfma_f32_16x16x32_bf16 v[112:115], v[44:47], v[76:79], v[112:115]
    v_mfma_f32_16x16x32_bf16 v[120:123], v[44:47], v[92:95], v[120:123]
    v_mfma_f32_16x16x32_bf16 v[128:131], v[44:47], v[108:111], v[128:131]
    v_mfma_f32_16x16x32_bf16 v[116:119], v[48:51], v[64:67], 0
    v_mfma_f32_16x16x32_bf16 v[124:127], v[48:51], v[80:83], 0
    v_mfma_f32_16x16x32_bf16 v[132:135], v[48:51], v[96:99], 0
    v_mfma_f32_16x16x32_bf16 v[116:119], v[52:55], v[68:71], v[116:119]
    v_mfma_f32_16x16x32_bf16 v[124:127], v[52:55], v[84:87], v[124:127]
    v_mfma_f32_16x16x32_bf16 v[132:135], v[52:55], v[100:103], v[132:135]
    v_mfma_f32_16x16x32_bf16 v[116:119], v[56:59], v[72:75], v[116:119]
    v_mfma_f32_16x16x32_bf16 v[124:127], v[56:59], v[88:91], v[124:127]
    v_mfma_f32_16x16x32_bf16 v[132:135], v[56:59], v[104:107], v[132:135]
    v_mfma_f32_16x16x32_bf16 v[116:119], v[60:63], v[76:79], v[116:119]
    v_mfma_f32_16x16x32_bf16 v[124:127], v[60:63], v[92:95], v[124:127]
    v_mfma_f32_16x16x32_bf16 v[132:135], v[60:63], v[108:111], v[132:135]
    v_fma_f32 v112, v112, s59, -v18
    v_fma_f32 v120, v120, s59, -v19
    v_fma_f32 v128, v128, s59, -v20
    v_fma_f32 v113, v113, s59, -v18
    v_fma_f32 v121, v121, s59, -v19
    v_fma_f32 v129, v129, s59, -v20
    v_fma_f32 v114, v114, s59, -v18
    v_fma_f32 v122, v122, s59, -v19
    v_fma_f32 v130, v130, s59, -v20
    v_fma_f32 v115, v115, s59, -v18
    v_fma_f32 v123, v123, s59, -v19
    v_fma_f32 v131, v131, s59, -v20
    ds_read_b128 v[32:35], v12 offset:32768
    ds_read_b128 v[36:39], v13 offset:32768
    v_fma_f32 v116, v116, s59, -v18
    v_fma_f32 v124, v124, s59, -v19
    v_fma_f32 v132, v132, s59, -v20
    v_fma_f32 v117, v117, s59, -v18
    v_fma_f32 v125, v125, s59, -v19
    v_fma_f32 v133, v133, s59, -v20
    v_fma_f32 v118, v118, s59, -v18
    v_fma_f32 v126, v126, s59, -v19
    v_fma_f32 v134, v134, s59, -v20
    v_fma_f32 v119, v119, s59, -v18
    v_fma_f32 v127, v127, s59, -v19
    v_fma_f32 v135, v135, s59, -v20
    ds_read_b128 v[40:43], v14 offset:32768
    ds_read_b128 v[44:47], v15 offset:32768
    v_max3_f32 v136, v112, v113, v114
    v_max3_f32 v137, v120, v121, v122
    v_max3_f32 v138, v128, v129, v130
    v_max3_f32 v136, v136, v115, v116
    v_max3_f32 v137, v137, v123, v124
    v_max3_f32 v138, v138, v131, v132
    v_max3_f32 v136, v136, v117, v118
    v_max3_f32 v137, v137, v125, v126
    v_max3_f32 v138, v138, v133, v134
    v_max_f32 v136, v136, v119
    v_max_f32 v137, v137, v127
    v_max_f32 v138, v138, v135
    v_max3_f32 v139, v136, v137, v138
    v_cmp_lt_f32 vcc, s29, v139
    s_mov_b32 s28, 5
    s_nop 3
    s_cbranch_vccnz K1_SLOW_1
K1_RET5_1:
    ds_read_b128 v[48:51], v12 offset:36864
    ds_read_b128 v[52:55], v13 offset:36864
    v_exp_f32 v112, v112
    v_exp_f32 v120, v120
    v_exp_f32 v128, v128
    ds_read_b128 v[56:59], v14 offset:36864
    ds_read_b128 v[60:63], v15 offset:36864
    s_add_u32 m0, s61, 16384
    s_xor_b32 s64, s55, 32768
    buffer_load_dwordx4 v16, s[12:15], s64 offen offset:0 nt lds
    v_exp_f32 v113, v113
    v_exp_f32 v121, v121
    v_exp_f32 v129, v129
    v_add_f32 v21, v21, v112
    v_add_f32 v22, v22, v120
    v_add_f32 v23, v23, v128
    s_add_u32 m0, s61, 16384
    s_xor_b32 s64, s55, 32768
    buffer_load_dwordx4 v17, s[12:15], s64 offen offset:1024 nt lds
    v_exp_f32 v114, v114
    v_exp_f32 v122, v122
    v_exp_f32 v130, v130
    v_add_f32 v21, v21, v113
    v_add_f32 v22, v22, v121
    v_add_f32 v23, v23, v129
    v_cvt_pk_bf16_f32 v208, v112, v113
    v_cvt_pk_bf16_f32 v212, v120, v121
    v_cvt_pk_bf16_f32 v216, v128, v129
    s_add_u32 m0, s61, 16384
    s_xor_b32 s64, s55, 32768
    buffer_load_dwordx4 v16, s[12:15], s64 offen offset:2048 nt lds
    v_exp_f32 v115, v115
    v_exp_f32 v123, v123
    v_exp_f32 v131, v131
    v_add_f32 v21, v21, v114
    v_add_f32 v22, v22, v122
    v_add_f32 v23, v23, v130
    s_add_u32 m0, s61, 16384
    s_xor_b32 s64, s55, 32768
    buffer_load_dwordx4 v17, s[12:15], s64 offen offset:3072 nt lds
    v_exp_f32 v116, v116
    v_exp_f32 v124, v124
    v_exp_f32 v132, v132
    v_add_f32 v21, v21, v115
    v_add_f32 v22, v22, v123
    v_add_f32 v23, v23, v131
    v_cvt_pk_bf16_f32 v209, v114, v115
    v_cvt_pk_bf16_f32 v213, v122, v123
    v_cvt_pk_bf16_f32 v217, v130, v131
    v_exp_f32 v117, v117
    v_exp_f32 v125, v125
    v_exp_f32 v133, v133
    v_add_f32 v21, v21, v116
    v_add_f32 v22, v22, v124
    v_add_f32 v23, v23, v132
    v_exp_f32 v118, v118
    v_exp_f32 v126, v126
    v_exp_f32 v134, v134
    v_add_f32 v21, v21, v117
    v_add_f32 v22, v22, v125
    v_add_f32 v23, v23, v133
    v_cvt_pk_bf16_f32 v210, v116, v117
    v_cvt_pk_bf16_f32 v214, v124, v125
    v_cvt_pk_bf16_f32 v218, v132, v133
    v_exp_f32 v119, v119
    v_exp_f32 v127, v127
    v_exp_f32 v135, v135
    v_add_f32 v21, v21, v118
    v_add_f32 v22, v22, v126
    v_add_f32 v23, v23, v134
    v_add_f32 v21, v21, v119
    v_add_f32 v22, v22, v127
    v_add_f32 v23, v23, v135
    v_cvt_pk_bf16_f32 v211, v118, v119
    v_cvt_pk_bf16_f32 v215, v126, v127
    v_cvt_pk_bf16_f32 v219, v134, v135
    s_waitcnt lgkmcnt(0)
    s_barrier
    v_mfma_f32_16x16x32_bf16 v[112:115], v[32:35], v[64:67], 0
    v_mfma_f32_16x16x32_bf16 v[120:123], v[32:35], v[80:83], 0
    v_mfma_f32_16x16x32_bf16 v[128:131], v[32:35], v[96:99], 0
    v_mfma_f32_16x16x32_bf16 v[112:115], v[36:39], v[68:71], v[112:115]
    v_mfma_f32_16x16x32_bf16 v[120:123], v[36:39], v[84:87], v[120:123]
    v_mfma_f32_16x16x32_bf16 v[128:131], v[36:39], v[100:103], v[128:131]
    v_mfma_f32_16x16x32_bf16 v[112:115], v[40:43], v[72:75], v[112:115]
    v_mfma_f32_16x16x32_bf16 v[120:123], v[40:43], v[88:91], v[120:123]
    v_mfma_f32_16x16x32_bf16 v[128:131], v[40:43], v[104:107], v[128:131]
    v_mfma_f32_16x16x32_bf16 v[112:115], v[44:47], v[76:79], v[112:115]
    v_mfma_f32_16x16x32_bf16 v[120:123], v[44:47], v[92:95], v[120:123]
    v_mfma_f32_16x16x32_bf16 v[128:131], v[44:47], v[108:111], v[128:131]
    v_mfma_f32_16x16x32_bf16 v[116:119], v[48:51], v[64:67], 0
    v_mfma_f32_16x16x32_bf16 v[124:127], v[48:51], v[80:83], 0
    v_mfma_f32_16x16x32_bf16 v[132:135], v[48:51], v[96:99], 0
    v_mfma_f32_16x16x32_bf16 v[116:119], v[52:55], v[68:71], v[116:119]
    v_mfma_f32_16x16x32_bf16 v[124:127], v[52:55], v[84:87], v[124:127]
    v_mfma_f32_16x16x32_bf16 v[132:135], v[52:55], v[100:103], v[132:135]
    v_mfma_f32_16x16x32_bf16 v[116:119], v[56:59], v[72:75], v[116:119]
    v_mfma_f32_16x16x32_bf16 v[124:127], v[56:59], v[88:91], v[124:127]
    v_mfma_f32_16x16x32_bf16 v[132:135], v[56:59], v[104:107], v[132:135]
    v_mfma_f32_16x16x32_bf16 v[116:119], v[60:63], v[76:79], v[116:119]
    v_mfma_f32_16x16x32_bf16 v[124:127], v[60:63], v[92:95], v[124:127]
    v_mfma_f32_16x16x32_bf16 v[132:135], v[60:63], v[108:111], v[132:135]
    v_fma_f32 v112, v112, s59, -v18
    v_fma_f32 v120, v120, s59, -v19
    v_fma_f32 v128, v128, s59, -v20
    v_fma_f32 v113, v113, s59, -v18
    v_fma_f32 v121, v121, s59, -v19
    v_fma_f32 v129, v129, s59, -v20
    v_fma_f32 v114, v114, s59, -v18
    v_fma_f32 v122, v122, s59, -v19
    v_fma_f32 v130, v130, s59, -v20
    v_fma_f32 v115, v115, s59, -v18
    v_fma_f32 v123, v123, s59, -v19
    v_fma_f32 v131, v131, s59, -v20
    ds_read_b128 v[32:35], v12 offset:49152
    ds_read_b128 v[36:39], v13 offset:49152
    v_fma_f32 v116, v116, s59, -v18
    v_fma_f32 v124, v124, s59, -v19
    v_fma_f32 v132, v132, s59, -v20
    v_fma_f32 v117, v117, s59, -v18
    v_fma_f32 v125, v125, s59, -v19
    v_fma_f32 v133, v133, s59, -v20
    v_fma_f32 v118, v118, s59, -v18
    v_fma_f32 v126, v126, s59, -v19
    v_fma_f32 v134, v134, s59, -v20
    v_fma_f32 v119, v119, s59, -v18
    v_fma_f32 v127, v127, s59, -v19
    v_fma_f32 v135, v135, s59, -v20
    ds_read_b128 v[40:43], v14 offset:49152
    ds_read_b128 v[44:47], v15 offset:49152
    v_max3_f32 v136, v112, v113, v114
    v_max3_f32 v137, v120, v121, v122
    v_max3_f32 v138, v128, v129, v130
    v_max3_f32 v136, v136, v115, v116
    v_max3_f32 v137, v137, v123, v124
    v_max3_f32 v138, v138, v131, v132
    v_max3_f32 v136, v136, v117, v118
    v_max3_f32 v137, v137, v125, v126
    v_max3_f32 v138, v138, v133, v134
    v_max_f32 v136, v136, v119
    v_max_f32 v137, v137, v127
    v_max_f32 v138, v138, v135
    v_max3_f32 v139, v136, v137, v138
    v_cmp_lt_f32 vcc, s29, v139
    s_mov_b32 s28, 6
    s_nop 3
    s_cbranch_vccnz K1_SLOW_1
K1_RET6_1:
    ds_read_b128 v[48:51], v12 offset:53248
    ds_read_b128 v[52:55], v13 offset:53248
    v_exp_f32 v112, v112
    v_exp_f32 v120, v120
    v_exp_f32 v128, v128
    ds_read_b128 v[56:59], v14 offset:53248
    ds_read_b128 v[60:63], v15 offset:53248
    s_add_u32 m0, s61, 32768
    s_xor_b32 s64, s55, 49152
    buffer_load_dwordx4 v16, s[12:15], s64 offen offset:0 nt lds
    v_exp_f32 v113, v113
    v_exp_f32 v121, v121
    v_exp_f32 v129, v129
    v_add_f32 v21, v21, v112
    v_add_f32 v22, v22, v120
    v_add_f32 v23, v23, v128
    s_add_u32 m0, s61, 32768
    s_xor_b32 s64, s55, 49152
    buffer_load_dwordx4 v17, s[12:15], s64 offen offset:1024 nt lds
    v_exp_f32 v114, v114
    v_exp_f32 v122, v122
    v_exp_f32 v130, v130
    v_add_f32 v21, v21, v113
    v_add_f32 v22, v22, v121
    v_add_f32 v23, v23, v129
    v_cvt_pk_bf16_f32 v220, v112, v113
    v_cvt_pk_bf16_f32 v224, v120, v121
    v_cvt_pk_bf16_f32 v228, v128, v129
    s_add_u32 m0, s61, 32768
    s_xor_b32 s64, s55, 49152
    buffer_load_dwordx4 v16, s[12:15], s64 offen offset:2048 nt lds
    v_exp_f32 v115, v115
    v_exp_f32 v123, v123
    v_exp_f32 v131, v131
    v_add_f32 v21, v21, v114
    v_add_f32 v22, v22, v122
    v_add_f32 v23, v23, v130
    s_add_u32 m0, s61, 32768
    s_xor_b32 s64, s55, 49152
    buffer_load_dwordx4 v17, s[12:15], s64 offen offset:3072 nt lds
    v_exp_f32 v116, v116
    v_exp_f32 v124, v124
    v_exp_f32 v132, v132
    v_add_f32 v21, v21, v115
    v_add_f32 v22, v22, v123
    v_add_f32 v23, v23, v131
    v_cvt_pk_bf16_f32 v221, v114, v115
    v_cvt_pk_bf16_f32 v225, v122, v123
    v_cvt_pk_bf16_f32 v229, v130, v131
    v_exp_f32 v117, v117
    v_exp_f32 v125, v125
    v_exp_f32 v133, v133
    v_add_f32 v21, v21, v116
    v_add_f32 v22, v22, v124
    v_add_f32 v23, v23, v132
    v_exp_f32 v118, v118
    v_exp_f32 v126, v126
    v_exp_f32 v134, v134
    v_add_f32 v21, v21, v117
    v_add_f32 v22, v22, v125
    v_add_f32 v23, v23, v133
    v_cvt_pk_bf16_f32 v222, v116, v117
    v_cvt_pk_bf16_f32 v226, v124, v125
    v_cvt_pk_bf16_f32 v230, v132, v133
    v_exp_f32 v119, v119
    v_exp_f32 v127, v127
    v_exp_f32 v135, v135
    v_add_f32 v21, v21, v118
    v_add_f32 v22, v22, v126
    v_add_f32 v23, v23, v134
    v_add_f32 v21, v21, v119
    v_add_f32 v22, v22, v127
    v_add_f32 v23, v23, v135
    v_cvt_pk_bf16_f32 v223, v118, v119
    v_cvt_pk_bf16_f32 v227, v126, v127
    v_cvt_pk_bf16_f32 v231, v134, v135
    s_waitcnt vmcnt(12)
    s_waitcnt lgkmcnt(0)
    s_barrier
    v_and_b32 v4, 7, v0
    v_lshlrev_b32 v4, 7, v4
    s_lshl_b32 s45, s42, 7
    s_lshr_b32 s56, s41, 2
    s_lshl_b32 s56, s56, 6
    s_add_u32 s45, s45, s56
    s_add_u32 s45, s45, 26214400
    buffer_load_dwordx2 v[2:3], v4, s[24:27], s45 offen offset:0 sc1
    v_mfma_f32_16x16x32_bf16 v[112:115], v[32:35], v[64:67], 0
    v_mfma_f32_16x16x32_bf16 v[120:123], v[32:35], v[80:83], 0
    v_mfma_f32_16x16x32_bf16 v[128:131], v[32:35], v[96:99], 0
    v_mfma_f32_16x16x32_bf16 v[112:115], v[36:39], v[68:71], v[112:115]
    v_mfma_f32_16x16x32_bf16 v[120:123], v[36:39], v[84:87], v[120:123]
    v_mfma_f32_16x16x32_bf16 v[128:131], v[36:39], v[100:103], v[128:131]
    v_mfma_f32_16x16x32_bf16 v[112:115], v[40:43], v[72:75], v[112:115]
    v_mfma_f32_16x16x32_bf16 v[120:123], v[40:43], v[88:91], v[120:123]
    v_mfma_f32_16x16x32_bf16 v[128:131], v[40:43], v[104:107], v[128:131]
    v_mfma_f32_16x16x32_bf16 v[112:115], v[44:47], v[76:79], v[112:115]
    v_mfma_f32_16x16x32_bf16 v[120:123], v[44:47], v[92:95], v[120:123]
    v_mfma_f32_16x16x32_bf16 v[128:131], v[44:47], v[108:111], v[128:131]
    v_mfma_f32_16x16x32_bf16 v[116:119], v[48:51], v[64:67], 0
    v_mfma_f32_16x16x32_bf16 v[124:127], v[48:51], v[80:83], 0
    v_mfma_f32_16x16x32_bf16 v[132:135], v[48:51], v[96:99], 0
    v_mfma_f32_16x16x32_bf16 v[116:119], v[52:55], v[68:71], v[116:119]
    v_mfma_f32_16x16x32_bf16 v[124:127], v[52:55], v[84:87], v[124:127]
    v_mfma_f32_16x16x32_bf16 v[132:135], v[52:55], v[100:103], v[132:135]
    v_mfma_f32_16x16x32_bf16 v[116:119], v[56:59], v[72:75], v[116:119]
    v_mfma_f32_16x16x32_bf16 v[124:127], v[56:59], v[88:91], v[124:127]
    v_mfma_f32_16x16x32_bf16 v[132:135], v[56:59], v[104:107], v[132:135]
    v_mfma_f32_16x16x32_bf16 v[116:119], v[60:63], v[76:79], v[116:119]
    v_mfma_f32_16x16x32_bf16 v[124:127], v[60:63], v[92:95], v[124:127]
    v_mfma_f32_16x16x32_bf16 v[132:135], v[60:63], v[108:111], v[132:135]
    v_fma_f32 v112, v112, s59, -v18
    v_fma_f32 v120, v120, s59, -v19
    v_fma_f32 v128, v128, s59, -v20
    v_fma_f32 v113, v113, s59, -v18
    v_fma_f32 v121, v121, s59, -v19
    v_fma_f32 v129, v129, s59, -v20
    v_fma_f32 v114, v114, s59, -v18
    v_fma_f32 v122, v122, s59, -v19
    v_fma_f32 v130, v130, s59, -v20
    v_fma_f32 v115, v115, s59, -v18
    v_fma_f32 v123, v123, s59, -v19
    v_fma_f32 v131, v131, s59, -v20
    v_add_u32 v24, 81920, v24
    ds_read_b64_tr_b16 v[32:33], v24 offset:0
    ds_read_b64_tr_b16 v[34:35], v24 offset:4096
    v_fma_f32 v116, v116, s59, -v18
    v_fma_f32 v124, v124, s59, -v19
    v_fma_f32 v132, v132, s59, -v20
    v_fma_f32 v117, v117, s59, -v18
    v_fma_f32 v125, v125, s59, -v19
    v_fma_f32 v133, v133, s59, -v20
    v_fma_f32 v118, v118, s59, -v18
    v_fma_f32 v126, v126, s59, -v19
    v_fma_f32 v134, v134, s59, -v20
    v_fma_f32 v119, v119, s59, -v18
    v_fma_f32 v127, v127, s59, -v19
    v_fma_f32 v135, v135, s59, -v20
    v_add_u32 v25, 81920, v25
    ds_read_b64_tr_b16 v[36:37], v25 offset:0
    ds_read_b64_tr_b16 v[38:39], v25 offset:4096
    v_max3_f32 v136, v112, v113, v114
    v_max3_f32 v137, v120, v121, v122
    v_max3_f32 v138, v128, v129, v130
    v_max3_f32 v136, v136, v115, v116
    v_max3_f32 v137, v137, v123, v124
    v_max3_f32 v138, v138, v131, v132
    v_max3_f32 v136, v136, v117, v118
    v_max3_f32 v137, v137, v125, v126
    v_max3_f32 v138, v138, v133, v134
    v_max_f32 v136, v136, v119
    v_max_f32 v137, v137, v127
    v_max_f32 v138, v138, v135
    v_max3_f32 v139, v136, v137, v138
    v_cmp_lt_f32 vcc, s29, v139
    s_mov_b32 s28, 7
    s_nop 3
    s_cbranch_vccnz K1_SLOW_1
K1_RET7_1:
    v_add_u32 v26, 81920, v26
    ds_read_b64_tr_b16 v[40:41], v26 offset:0
    ds_read_b64_tr_b16 v[42:43], v26 offset:4096
    v_exp_f32 v112, v112
    v_exp_f32 v120, v120
    v_exp_f32 v128, v128
    v_add_u32 v27, 81920, v27
    ds_read_b64_tr_b16 v[44:45], v27 offset:0
    ds_read_b64_tr_b16 v[46:47], v27 offset:4096
    s_add_u32 m0, s61, 49152
    s_xor_b32 s64, s55, 65536
    buffer_load_dwordx4 v16, s[12:15], s64 offen offset:0 nt lds
    v_exp_f32 v113, v113
    v_exp_f32 v121, v121
    v_exp_f32 v129, v129
    v_add_f32 v21, v21, v112
    v_add_f32 v22, v22, v120
    v_add_f32 v23, v23, v128
    s_add_u32 m0, s61, 49152
    s_xor_b32 s64, s55, 65536
    buffer_load_dwordx4 v17, s[12:15], s64 offen offset:1024 nt lds
    v_exp_f32 v114, v114
    v_exp_f32 v122, v122
    v_exp_f32 v130, v130
    v_add_f32 v21, v21, v113
    v_add_f32 v22, v22, v121
    v_add_f32 v23, v23, v129
    v_cvt_pk_bf16_f32 v232, v112, v113
    v_cvt_pk_bf16_f32 v236, v120, v121
    v_cvt_pk_bf16_f32 v240, v128, v129
    s_add_u32 m0, s61, 49152
    s_xor_b32 s64, s55, 65536
    buffer_load_dwordx4 v16, s[12:15], s64 offen offset:2048 nt lds
    v_exp_f32 v115, v115
    v_exp_f32 v123, v123
    v_exp_f32 v131, v131
    v_add_f32 v21, v21, v114
    v_add_f32 v22, v22, v122
    v_add_f32 v23, v23, v130
    s_add_u32 m0, s61, 49152
    s_xor_b32 s64, s55, 65536
    buffer_load_dwordx4 v17, s[12:15], s64 offen offset:3072 nt lds
    v_exp_f32 v116, v116
    v_exp_f32 v124, v124
    v_exp_f32 v132, v132
    v_add_f32 v21, v21, v115
    v_add_f32 v22, v22, v123
    v_add_f32 v23, v23, v131
    v_cvt_pk_bf16_f32 v233, v114, v115
    v_cvt_pk_bf16_f32 v237, v122, v123
    v_cvt_pk_bf16_f32 v241, v130, v131
    v_exp_f32 v117, v117
    v_exp_f32 v125, v125
    v_exp_f32 v133, v133
    v_add_f32 v21, v21, v116
    v_add_f32 v22, v22, v124
    v_add_f32 v23, v23, v132
    v_exp_f32 v118, v118
    v_exp_f32 v126, v126
    v_exp_f32 v134, v134
    v_add_f32 v21, v21, v117
    v_add_f32 v22, v22, v125
    v_add_f32 v23, v23, v133
    v_cvt_pk_bf16_f32 v234, v116, v117
    v_cvt_pk_bf16_f32 v238, v124, v125
    v_cvt_pk_bf16_f32 v242, v132, v133
    v_exp_f32 v119, v119
    v_exp_f32 v127, v127
    v_exp_f32 v135, v135
    v_add_f32 v21, v21, v118
    v_add_f32 v22, v22, v126
    v_add_f32 v23, v23, v134
    v_add_f32 v21, v21, v119
    v_add_f32 v22, v22, v127
    v_add_f32 v23, v23, v135
    v_cvt_pk_bf16_f32 v235, v118, v119
    v_cvt_pk_bf16_f32 v239, v126, v127
    v_cvt_pk_bf16_f32 v243, v134, v135
    s_waitcnt lgkmcnt(6)
    v_mfma_f32_16x16x32_bf16 v[64:67], v[32:35], v[148:151], 0
    v_add_u32 v28, 81920, v28
    ds_read_b64_tr_b16 v[48:49], v28 offset:0
    v_mfma_f32_16x16x32_bf16 v[68:71], v[32:35], v[152:155], 0
    ds_read_b64_tr_b16 v[50:51], v28 offset:4096
    v_mfma_f32_16x16x32_bf16 v[72:75], v[32:35], v[156:159], 0
    v_add_u32 v29, 81920, v29
    ds_read_b64_tr_b16 v[52:53], v29 offset:0
    s_waitcnt lgkmcnt(7)
    v_mfma_f32_16x16x32_bf16 v[76:79], v[36:39], v[148:151], 0
    ds_read_b64_tr_b16 v[54:55], v29 offset:4096
    v_mfma_f32_16x16x32_bf16 v[80:83], v[36:39], v[152:155], 0
    v_add_u32 v30, 81920, v30
    ds_read_b64_tr_b16 v[56:57], v30 offset:0
    v_mfma_f32_16x16x32_bf16 v[84:87], v[36:39], v[156:159], 0
    ds_read_b64_tr_b16 v[58:59], v30 offset:4096
    s_waitcnt lgkmcnt(8)
    v_mfma_f32_16x16x32_bf16 v[88:91], v[40:43], v[148:151], 0
    v_add_u32 v31, 81920, v31
    ds_read_b64_tr_b16 v[60:61], v31 offset:0
    v_mfma_f32_16x16x32_bf16 v[92:95], v[40:43], v[152:155], 0
    ds_read_b64_tr_b16 v[62:63], v31 offset:4096
    v_mfma_f32_16x16x32_bf16 v[96:99], v[40:43], v[156:159], 0
    s_waitcnt lgkmcnt(8)
    v_mfma_f32_16x16x32_bf16 v[100:103], v[44:47], v[148:151], 0
    v_mfma_f32_16x16x32_bf16 v[104:107], v[44:47], v[152:155], 0
    v_mfma_f32_16x16x32_bf16 v[108:111], v[44:47], v[156:159], 0
    s_waitcnt vmcnt(13)
    s_waitcnt lgkmcnt(0)
    s_barrier
    v_add_u32 v8, 4096, v7
    v_mfma_f32_16x16x32_bf16 v[112:115], v[48:51], v[148:151], 0
    v_subrev_u32 v24, 81920, v24
    ds_read_b64_tr_b16 v[32:33], v24 offset:0
    v_mfma_f32_16x16x32_bf16 v[116:119], v[48:51], v[152:155], 0
    ds_read_b64_tr_b16 v[34:35], v24 offset:4096
    v_mfma_f32_16x16x32_bf16 v[120:123], v[48:51], v[156:159], 0
    v_subrev_u32 v25, 81920, v25
    ds_read_b64_tr_b16 v[36:37], v25 offset:0
    v_mfma_f32_16x16x32_bf16 v[124:127], v[52:55], v[148:151], 0
    ds_read_b64_tr_b16 v[38:39], v25 offset:4096
    v_mfma_f32_16x16x32_bf16 v[128:131], v[52:55], v[152:155], 0
    v_subrev_u32 v26, 81920, v26
    ds_read_b64_tr_b16 v[40:41], v26 offset:0
    v_mfma_f32_16x16x32_bf16 v[132:135], v[52:55], v[156:159], 0
    ds_read_b64_tr_b16 v[42:43], v26 offset:4096
    v_mfma_f32_16x16x32_bf16 v[136:139], v[56:59], v[148:151], 0
    v_subrev_u32 v27, 81920, v27
    ds_read_b64_tr_b16 v[44:45], v27 offset:0
    v_mfma_f32_16x16x32_bf16 v[140:143], v[56:59], v[152:155], 0
    ds_read_b64_tr_b16 v[46:47], v27 offset:4096
    v_mfma_f32_16x16x32_bf16 v[144:147], v[56:59], v[156:159], 0
    v_mfma_f32_16x16x32_bf16 v[244:247], v[60:63], v[148:151], 0
    v_mfma_f32_16x16x32_bf16 v[248:251], v[60:63], v[152:155], 0
    v_mfma_f32_16x16x32_bf16 v[252:255], v[60:63], v[156:159], 0
    s_waitcnt lgkmcnt(6)
    v_mfma_f32_16x16x32_bf16 v[64:67], v[32:35], v[160:163], v[64:67]
    v_subrev_u32 v28, 81920, v28
    ds_read_b64_tr_b16 v[48:49], v28 offset:0
    v_mfma_f32_16x16x32_bf16 v[68:71], v[32:35], v[164:167], v[68:71]
    ds_read_b64_tr_b16 v[50:51], v28 offset:4096
    s_add_u32 m0, s61, 81920
    s_xor_b32 s64, s55, 81920
    buffer_load_dwordx4 v16, s[12:15], s64 offen offset:0 nt lds
    v_mfma_f32_16x16x32_bf16 v[72:75], v[32:35], v[168:171], v[72:75]
    v_subrev_u32 v29, 81920, v29
    ds_read_b64_tr_b16 v[52:53], v29 offset:0
    s_waitcnt lgkmcnt(7)
    v_mfma_f32_16x16x32_bf16 v[76:79], v[36:39], v[160:163], v[76:79]
    ds_read_b64_tr_b16 v[54:55], v29 offset:4096
    s_add_u32 m0, s61, 81920
    s_xor_b32 s64, s55, 81920
    buffer_load_dwordx4 v17, s[12:15], s64 offen offset:1024 nt lds
    v_mfma_f32_16x16x32_bf16 v[80:83], v[36:39], v[164:167], v[80:83]
    v_subrev_u32 v30, 81920, v30
    ds_read_b64_tr_b16 v[56:57], v30 offset:0
    v_mfma_f32_16x16x32_bf16 v[84:87], v[36:39], v[168:171], v[84:87]
    ds_read_b64_tr_b16 v[58:59], v30 offset:4096
    s_add_u32 m0, s61, 81920
    s_xor_b32 s64, s55, 81920
    buffer_load_dwordx4 v16, s[12:15], s64 offen offset:2048 nt lds
    s_waitcnt lgkmcnt(8)
    v_mfma_f32_16x16x32_bf16 v[88:91], v[40:43], v[160:163], v[88:91]
    v_subrev_u32 v31, 81920, v31
    ds_read_b64_tr_b16 v[60:61], v31 offset:0
    v_mfma_f32_16x16x32_bf16 v[92:95], v[40:43], v[164:167], v[92:95]
    ds_read_b64_tr_b16 v[62:63], v31 offset:4096
    s_add_u32 m0, s61, 81920
    s_xor_b32 s64, s55, 81920
    buffer_load_dwordx4 v17, s[12:15], s64 offen offset:3072 nt lds
    v_mfma_f32_16x16x32_bf16 v[96:99], v[40:43], v[168:171], v[96:99]
    s_waitcnt lgkmcnt(8)
    v_mfma_f32_16x16x32_bf16 v[100:103], v[44:47], v[160:163], v[100:103]
    v_mfma_f32_16x16x32_bf16 v[104:107], v[44:47], v[164:167], v[104:107]
    v_mfma_f32_16x16x32_bf16 v[108:111], v[44:47], v[168:171], v[108:111]
    s_waitcnt vmcnt(13)
    s_waitcnt lgkmcnt(0)
    s_barrier
    v_mfma_f32_16x16x32_bf16 v[112:115], v[48:51], v[160:163], v[112:115]
    ds_read_b64_tr_b16 v[32:33], v24 offset:16384
    v_mfma_f32_16x16x32_bf16 v[116:119], v[48:51], v[164:167], v[116:119]
    ds_read_b64_tr_b16 v[34:35], v24 offset:20480
    v_mfma_f32_16x16x32_bf16 v[120:123], v[48:51], v[168:171], v[120:123]
    ds_read_b64_tr_b16 v[36:37], v25 offset:16384
    v_mfma_f32_16x16x32_bf16 v[124:127], v[52:55], v[160:163], v[124:127]
    ds_read_b64_tr_b16 v[38:39], v25 offset:20480
    v_mfma_f32_16x16x32_bf16 v[128:131], v[52:55], v[164:167], v[128:131]
    ds_read_b64_tr_b16 v[40:41], v26 offset:16384
    v_mfma_f32_16x16x32_bf16 v[132:135], v[52:55], v[168:171], v[132:135]
    ds_read_b64_tr_b16 v[42:43], v26 offset:20480
    v_mfma_f32_16x16x32_bf16 v[136:139], v[56:59], v[160:163], v[136:139]
    ds_read_b64_tr_b16 v[44:45], v27 offset:16384
    v_mfma_f32_16x16x32_bf16 v[140:143], v[56:59], v[164:167], v[140:143]
    ds_read_b64_tr_b16 v[46:47], v27 offset:20480
    v_mfma_f32_16x16x32_bf16 v[144:147], v[56:59], v[168:171], v[144:147]
    v_mfma_f32_16x16x32_bf16 v[244:247], v[60:63], v[160:163], v[244:247]
    v_mfma_f32_16x16x32_bf16 v[248:251], v[60:63], v[164:167], v[248:251]
    v_mfma_f32_16x16x32_bf16 v[252:255], v[60:63], v[168:171], v[252:255]
    s_waitcnt lgkmcnt(6)
    v_mfma_f32_16x16x32_bf16 v[64:67], v[32:35], v[172:175], v[64:67]
    ds_read_b64_tr_b16 v[48:49], v28 offset:16384
    v_mfma_f32_16x16x32_bf16 v[68:71], v[32:35], v[176:179], v[68:71]
    ds_read_b64_tr_b16 v[50:51], v28 offset:20480
    s_mov_b32 m0, s61
    s_xor_b32 s64, s55, 98304
    buffer_load_dwordx4 v16, s[12:15], s64 offen offset:0 nt lds
    v_mfma_f32_16x16x32_bf16 v[72:75], v[32:35], v[180:183], v[72:75]
    ds_read_b64_tr_b16 v[52:53], v29 offset:16384
    s_waitcnt lgkmcnt(7)
    v_mfma_f32_16x16x32_bf16 v[76:79], v[36:39], v[172:175], v[76:79]
    ds_read_b64_tr_b16 v[54:55], v29 offset:20480
    s_mov_b32 m0, s61
    s_xor_b32 s64, s55, 98304
    buffer_load_dwordx4 v17, s[12:15], s64 offen offset:1024 nt lds
    v_mfma_f32_16x16x32_bf16 v[80:83], v[36:39], v[176:179], v[80:83]
    ds_read_b64_tr_b16 v[56:57], v30 offset:16384
    v_mfma_f32_16x16x32_bf16 v[84:87], v[36:39], v[180:183], v[84:87]
    ds_read_b64_tr_b16 v[58:59], v30 offset:20480
    s_mov_b32 m0, s61
    s_xor_b32 s64, s55, 98304
    buffer_load_dwordx4 v16, s[12:15], s64 offen offset:2048 nt lds
    s_waitcnt lgkmcnt(8)
    v_mfma_f32_16x16x32_bf16 v[88:91], v[40:43], v[172:175], v[88:91]
    ds_read_b64_tr_b16 v[60:61], v31 offset:16384
    v_mfma_f32_16x16x32_bf16 v[92:95], v[40:43], v[176:179], v[92:95]
    ds_read_b64_tr_b16 v[62:63], v31 offset:20480
    s_mov_b32 m0, s61
    s_xor_b32 s64, s55, 98304
    buffer_load_dwordx4 v17, s[12:15], s64 offen offset:3072 nt lds
    v_mfma_f32_16x16x32_bf16 v[96:99], v[40:43], v[180:183], v[96:99]
    s_waitcnt lgkmcnt(8)
    v_mfma_f32_16x16x32_bf16 v[100:103], v[44:47], v[172:175], v[100:103]
    v_mfma_f32_16x16x32_bf16 v[104:107], v[44:47], v[176:179], v[104:107]
    v_mfma_f32_16x16x32_bf16 v[108:111], v[44:47], v[180:183], v[108:111]
    s_waitcnt vmcnt(13)
    s_waitcnt vmcnt(12)
    s_mov_b32 s57, 0
K1_W_1_CMP:
    v_cmp_ne_u64 vcc, s[30:31], v[2:3]
    s_add_u32 s57, s57, 1
    s_nop 3
    s_cbranch_vccz K1_W_1_OK
    s_cmp_ge_u32 s57, 0x40000
    s_cbranch_scc1 K1_W_1_OK
    s_sleep 4
    buffer_load_dwordx2 v[2:3], v4, s[24:27], s45 offen offset:0 sc1
    s_waitcnt vmcnt(0)
    s_branch K1_W_1_CMP
K1_W_1_OK:
    s_waitcnt lgkmcnt(0)
    s_barrier
    v_mfma_f32_16x16x32_bf16 v[112:115], v[48:51], v[172:175], v[112:115]
    ds_read_b64_tr_b16 v[32:33], v24 offset:32768
    v_mfma_f32_16x16x32_bf16 v[116:119], v[48:51], v[176:179], v[116:119]
    ds_read_b64_tr_b16 v[34:35], v24 offset:36864
    v_mfma_f32_16x16x32_bf16 v[120:123], v[48:51], v[180:183], v[120:123]
    ds_read_b64_tr_b16 v[36:37], v25 offset:32768
    v_mfma_f32_16x16x32_bf16 v[124:127], v[52:55], v[172:175], v[124:127]
    ds_read_b64_tr_b16 v[38:39], v25 offset:36864
    v_mfma_f32_16x16x32_bf16 v[128:131], v[52:55], v[176:179], v[128:131]
    ds_read_b64_tr_b16 v[40:41], v26 offset:32768
    v_mfma_f32_16x16x32_bf16 v[132:135], v[52:55], v[180:183], v[132:135]
    ds_read_b64_tr_b16 v[42:43], v26 offset:36864
    v_mfma_f32_16x16x32_bf16 v[136:139], v[56:59], v[172:175], v[136:139]
    ds_read_b64_tr_b16 v[44:45], v27 offset:32768
    v_mfma_f32_16x16x32_bf16 v[140:143], v[56:59], v[176:179], v[140:143]
    ds_read_b64_tr_b16 v[46:47], v27 offset:36864
    v_mfma_f32_16x16x32_bf16 v[144:147], v[56:59], v[180:183], v[144:147]
    v_mfma_f32_16x16x32_bf16 v[244:247], v[60:63], v[172:175], v[244:247]
    v_mfma_f32_16x16x32_bf16 v[248:251], v[60:63], v[176:179], v[248:251]
    v_mfma_f32_16x16x32_bf16 v[252:255], v[60:63], v[180:183], v[252:255]
    s_waitcnt lgkmcnt(6)
    v_mfma_f32_16x16x32_bf16 v[64:67], v[32:35], v[184:187], v[64:67]
    ds_read_b64_tr_b16 v[48:49], v28 offset:32768
    v_mfma_f32_16x16x32_bf16 v[68:71], v[32:35], v[188:191], v[68:71]
    ds_read_b64_tr_b16 v[50:51], v28 offset:36864
    s_add_u32 m0, s61, 16384
    s_xor_b32 s64, s55, 114688
    buffer_load_dwordx4 v16, s[12:15], s64 offen offset:0 nt lds
    v_mfma_f32_16x16x32_bf16 v[72:75], v[32:35], v[192:195], v[72:75]
    ds_read_b64_tr_b16 v[52:53], v29 offset:32768
    s_waitcnt lgkmcnt(7)
    v_mfma_f32_16x16x32_bf16 v[76:79], v[36:39], v[184:187], v[76:79]
    ds_read_b64_tr_b16 v[54:55], v29 offset:36864
    s_add_u32 m0, s61, 16384
    s_xor_b32 s64, s55, 114688
    buffer_load_dwordx4 v17, s[12:15], s64 offen offset:1024 nt lds
    v_mfma_f32_16x16x32_bf16 v[80:83], v[36:39], v[188:191], v[80:83]
    ds_read_b64_tr_b16 v[56:57], v30 offset:32768
    v_mfma_f32_16x16x32_bf16 v[84:87], v[36:39], v[192:195], v[84:87]
    ds_read_b64_tr_b16 v[58:59], v30 offset:36864
    s_add_u32 m0, s61, 16384
    s_xor_b32 s64, s55, 114688
    buffer_load_dwordx4 v16, s[12:15], s64 offen offset:2048 nt lds
    s_waitcnt lgkmcnt(8)
    v_mfma_f32_16x16x32_bf16 v[88:91], v[40:43], v[184:187], v[88:91]
    ds_read_b64_tr_b16 v[60:61], v31 offset:32768
    v_mfma_f32_16x16x32_bf16 v[92:95], v[40:43], v[188:191], v[92:95]
    ds_read_b64_tr_b16 v[62:63], v31 offset:36864
    s_add_u32 m0, s61, 16384
    s_xor_b32 s64, s55, 114688
    buffer_load_dwordx4 v17, s[12:15], s64 offen offset:3072 nt lds
    v_mfma_f32_16x16x32_bf16 v[96:99], v[40:43], v[192:195], v[96:99]
    s_waitcnt lgkmcnt(8)
    v_mfma_f32_16x16x32_bf16 v[100:103], v[44:47], v[184:187], v[100:103]
    v_mfma_f32_16x16x32_bf16 v[104:107], v[44:47], v[188:191], v[104:107]
    v_mfma_f32_16x16x32_bf16 v[108:111], v[44:47], v[192:195], v[108:111]
    s_waitcnt vmcnt(12)
    s_waitcnt lgkmcnt(0)
    s_barrier
    v_mov_b32 v1, v21
    v_mov_b32 v2, v22
    v_mov_b32 v3, v23
    v_permlane32_swap_b32 v21, v1
    v_permlane32_swap_b32 v22, v2
    v_permlane32_swap_b32 v23, v3
    v_add_f32 v21, v21, v1
    v_add_f32 v22, v22, v2
    v_add_f32 v23, v23, v3
    v_mov_b32 v1, v21
    v_mov_b32 v2, v22
    v_mov_b32 v3, v23
    v_permlane16_swap_b32 v21, v1
    v_permlane16_swap_b32 v22, v2
    v_permlane16_swap_b32 v23, v3
    v_add_f32 v21, v21, v1
    v_add_f32 v22, v22, v2
    v_add_f32 v23, v23, v3
    s_lshl_b32 s56, s52, 9
    s_add_u32 s56, s56, 110592
    v_lshl_add_u32 v4, v6, 5, s56
    ds_write_b128 v4, v[18:21]
    ds_write_b64 v4, v[22:23] offset:16
    v_mfma_f32_16x16x32_bf16 v[112:115], v[48:51], v[184:187], v[112:115]
    ds_read_b64_tr_b16 v[32:33], v24 offset:49152
    v_mfma_f32_16x16x32_bf16 v[116:119], v[48:51], v[188:191], v[116:119]
    ds_read_b64_tr_b16 v[34:35], v24 offset:53248
    v_mfma_f32_16x16x32_bf16 v[120:123], v[48:51], v[192:195], v[120:123]
    ds_read_b64_tr_b16 v[36:37], v25 offset:49152
    v_mfma_f32_16x16x32_bf16 v[124:127], v[52:55], v[184:187], v[124:127]
    ds_read_b64_tr_b16 v[38:39], v25 offset:53248
    v_mfma_f32_16x16x32_bf16 v[128:131], v[52:55], v[188:191], v[128:131]
    ds_read_b64_tr_b16 v[40:41], v26 offset:49152
    v_mfma_f32_16x16x32_bf16 v[132:135], v[52:55], v[192:195], v[132:135]
    ds_read_b64_tr_b16 v[42:43], v26 offset:53248
    v_mfma_f32_16x16x32_bf16 v[136:139], v[56:59], v[184:187], v[136:139]
    ds_read_b64_tr_b16 v[44:45], v27 offset:49152
    v_mfma_f32_16x16x32_bf16 v[140:143], v[56:59], v[188:191], v[140:143]
    ds_read_b64_tr_b16 v[46:47], v27 offset:53248
    v_mfma_f32_16x16x32_bf16 v[144:147], v[56:59], v[192:195], v[144:147]
    v_mfma_f32_16x16x32_bf16 v[244:247], v[60:63], v[184:187], v[244:247]
    v_mfma_f32_16x16x32_bf16 v[248:251], v[60:63], v[188:191], v[248:251]
    v_mfma_f32_16x16x32_bf16 v[252:255], v[60:63], v[192:195], v[252:255]
    s_waitcnt lgkmcnt(6)
    v_mfma_f32_16x16x32_bf16 v[64:67], v[32:35], v[196:199], v[64:67]
    ds_read_b64_tr_b16 v[48:49], v28 offset:49152
    v_mfma_f32_16x16x32_bf16 v[68:71], v[32:35], v[200:203], v[68:71]
    ds_read_b64_tr_b16 v[50:51], v28 offset:53248
    v_mfma_f32_16x16x32_bf16 v[72:75], v[32:35], v[204:207], v[72:75]
    ds_read_b64_tr_b16 v[52:53], v29 offset:49152
    s_waitcnt lgkmcnt(7)
    v_mfma_f32_16x16x32_bf16 v[76:79], v[36:39], v[196:199], v[76:79]
    ds_read_b64_tr_b16 v[54:55], v29 offset:53248
    v_mfma_f32_16x16x32_bf16 v[80:83], v[36:39], v[200:203], v[80:83]
    ds_read_b64_tr_b16 v[56:57], v30 offset:49152
    v_mfma_f32_16x16x32_bf16 v[84:87], v[36:39], v[204:207], v[84:87]
    ds_read_b64_tr_b16 v[58:59], v30 offset:53248
    s_waitcnt lgkmcnt(8)
    v_mfma_f32_16x16x32_bf16 v[88:91], v[40:43], v[196:199], v[88:91]
    ds_read_b64_tr_b16 v[60:61], v31 offset:49152
    v_mfma_f32_16x16x32_bf16 v[92:95], v[40:43], v[200:203], v[92:95]
    ds_read_b64_tr_b16 v[62:63], v31 offset:53248
    v_mfma_f32_16x16x32_bf16 v[96:99], v[40:43], v[204:207], v[96:99]
    s_waitcnt lgkmcnt(8)
    v_mfma_f32_16x16x32_bf16 v[100:103], v[44:47], v[196:199], v[100:103]
    v_mfma_f32_16x16x32_bf16 v[104:107], v[44:47], v[200:203], v[104:107]
    v_mfma_f32_16x16x32_bf16 v[108:111], v[44:47], v[204:207], v[108:111]
    s_waitcnt vmcnt(8)
    s_waitcnt lgkmcnt(0)
    s_barrier
    s_lshl_b32 s56, s52, 9
    s_xor_b32 s56, s56, 1024
    s_add_u32 s56, s56, 110592
    v_lshl_add_u32 v4, v6, 5, s56
    ds_read_b128 v[148:151], v4
    ds_read_b64 v[152:153], v4 offset:16
    v_mfma_f32_16x16x32_bf16 v[112:115], v[48:51], v[196:199], v[112:115]
    v_add_u32 v24, 81920, v24
    ds_read_b64_tr_b16 v[32:33], v24 offset:0
    v_mfma_f32_16x16x32_bf16 v[116:119], v[48:51], v[200:203], v[116:119]
    ds_read_b64_tr_b16 v[34:35], v24 offset:4096
    v_mfma_f32_16x16x32_bf16 v[120:123], v[48:51], v[204:207], v[120:123]
    v_add_u32 v25, 81920, v25
    ds_read_b64_tr_b16 v[36:37], v25 offset:0
    v_mfma_f32_16x16x32_bf16 v[124:127], v[52:55], v[196:199], v[124:127]
    ds_read_b64_tr_b16 v[38:39], v25 offset:4096
    v_mfma_f32_16x16x32_bf16 v[128:131], v[52:55], v[200:203], v[128:131]
    v_add_u32 v26, 81920, v26
    ds_read_b64_tr_b16 v[40:41], v26 offset:0
    v_mfma_f32_16x16x32_bf16 v[132:135], v[52:55], v[204:207], v[132:135]
    ds_read_b64_tr_b16 v[42:43], v26 offset:4096
    v_mfma_f32_16x16x32_bf16 v[136:139], v[56:59], v[196:199], v[136:139]
    v_add_u32 v27, 81920, v27
    ds_read_b64_tr_b16 v[44:45], v27 offset:0
    v_mfma_f32_16x16x32_bf16 v[140:143], v[56:59], v[200:203], v[140:143]
    ds_read_b64_tr_b16 v[46:47], v27 offset:4096
    v_mfma_f32_16x16x32_bf16 v[144:147], v[56:59], v[204:207], v[144:147]
    v_mfma_f32_16x16x32_bf16 v[244:247], v[60:63], v[196:199], v[244:247]
    v_mfma_f32_16x16x32_bf16 v[248:251], v[60:63], v[200:203], v[248:251]
    v_mfma_f32_16x16x32_bf16 v[252:255], v[60:63], v[204:207], v[252:255]
    s_waitcnt lgkmcnt(6)
    v_mfma_f32_16x16x32_bf16 v[64:67], v[32:35], v[208:211], v[64:67]
    v_add_u32 v28, 81920, v28
    ds_read_b64_tr_b16 v[48:49], v28 offset:0
    v_mfma_f32_16x16x32_bf16 v[68:71], v[32:35], v[212:215], v[68:71]
    ds_read_b64_tr_b16 v[50:51], v28 offset:4096
    v_mfma_f32_16x16x32_bf16 v[72:75], v[32:35], v[216:219], v[72:75]
    v_add_u32 v29, 81920, v29
    ds_read_b64_tr_b16 v[52:53], v29 offset:0
    s_waitcnt lgkmcnt(7)
    v_mfma_f32_16x16x32_bf16 v[76:79], v[36:39], v[208:211], v[76:79]
    ds_read_b64_tr_b16 v[54:55], v29 offset:4096
    v_mfma_f32_16x16x32_bf16 v[80:83], v[36:39], v[212:215], v[80:83]
    v_add_u32 v30, 81920, v30
    ds_read_b64_tr_b16 v[56:57], v30 offset:0
    v_mfma_f32_16x16x32_bf16 v[84:87], v[36:39], v[216:219], v[84:87]
    ds_read_b64_tr_b16 v[58:59], v30 offset:4096
    s_waitcnt lgkmcnt(8)
    v_mfma_f32_16x16x32_bf16 v[88:91], v[40:43], v[208:211], v[88:91]
    v_add_u32 v31, 81920, v31
    ds_read_b64_tr_b16 v[60:61], v31 offset:0
    v_mfma_f32_16x16x32_bf16 v[92:95], v[40:43], v[212:215], v[92:95]
    ds_read_b64_tr_b16 v[62:63], v31 offset:4096
    v_mfma_f32_16x16x32_bf16 v[96:99], v[40:43], v[216:219], v[96:99]
    s_waitcnt lgkmcnt(8)
    v_mfma_f32_16x16x32_bf16 v[100:103], v[44:47], v[208:211], v[100:103]
    v_mfma_f32_16x16x32_bf16 v[104:107], v[44:47], v[212:215], v[104:107]
    v_mfma_f32_16x16x32_bf16 v[108:111], v[44:47], v[216:219], v[108:111]
    s_waitcnt vmcnt(4)
    s_waitcnt lgkmcnt(0)
    s_barrier
    v_max_f32 v156, v18, v148
    v_max_f32 v157, v19, v149
    v_max_f32 v158, v20, v150
    v_sub_f32 v18, v18, v156
    v_sub_f32 v148, v148, v156
    v_sub_f32 v19, v19, v157
    v_sub_f32 v149, v149, v157
    v_sub_f32 v20, v20, v158
    v_sub_f32 v150, v150, v158
    v_exp_f32 v18, v18
    v_exp_f32 v148, v148
    v_exp_f32 v19, v19
    v_exp_f32 v149, v149
    v_exp_f32 v20, v20
    v_exp_f32 v150, v150
    v_mul_f32 v156, v18, v21
    v_mul_f32 v157, v19, v22
    v_mul_f32 v158, v20, v23
    v_fma_f32 v156, v148, v151, v156
    v_fma_f32 v157, v149, v152, v157
    v_fma_f32 v158, v150, v153, v158
    v_rcp_f32 v156, v156
    v_rcp_f32 v157, v157
    v_rcp_f32 v158, v158
    v_mul_f32 v18, v18, v156
    v_mul_f32 v21, v148, v156
    v_mul_f32 v19, v19, v157
    v_mul_f32 v22, v149, v157
    v_mul_f32 v20, v20, v158
    v_mul_f32 v23, v150, v158
    v_mfma_f32_16x16x32_bf16 v[112:115], v[48:51], v[208:211], v[112:115]
    v_subrev_u32 v24, 81920, v24
    ds_read_b64_tr_b16 v[32:33], v24 offset:0
    v_mfma_f32_16x16x32_bf16 v[116:119], v[48:51], v[212:215], v[116:119]
    ds_read_b64_tr_b16 v[34:35], v24 offset:4096
    v_mfma_f32_16x16x32_bf16 v[120:123], v[48:51], v[216:219], v[120:123]
    v_subrev_u32 v25, 81920, v25
    ds_read_b64_tr_b16 v[36:37], v25 offset:0
    v_mfma_f32_16x16x32_bf16 v[124:127], v[52:55], v[208:211], v[124:127]
    ds_read_b64_tr_b16 v[38:39], v25 offset:4096
    v_mfma_f32_16x16x32_bf16 v[128:131], v[52:55], v[212:215], v[128:131]
    v_subrev_u32 v26, 81920, v26
    ds_read_b64_tr_b16 v[40:41], v26 offset:0
    v_mfma_f32_16x16x32_bf16 v[132:135], v[52:55], v[216:219], v[132:135]
    ds_read_b64_tr_b16 v[42:43], v26 offset:4096
    v_mfma_f32_16x16x32_bf16 v[136:139], v[56:59], v[208:211], v[136:139]
    v_subrev_u32 v27, 81920, v27
    ds_read_b64_tr_b16 v[44:45], v27 offset:0
    v_mfma_f32_16x16x32_bf16 v[140:143], v[56:59], v[212:215], v[140:143]
    ds_read_b64_tr_b16 v[46:47], v27 offset:4096
    v_mfma_f32_16x16x32_bf16 v[144:147], v[56:59], v[216:219], v[144:147]
    v_mfma_f32_16x16x32_bf16 v[244:247], v[60:63], v[208:211], v[244:247]
    v_mfma_f32_16x16x32_bf16 v[248:251], v[60:63], v[212:215], v[248:251]
    v_mfma_f32_16x16x32_bf16 v[252:255], v[60:63], v[216:219], v[252:255]
    s_waitcnt lgkmcnt(6)
    v_mfma_f32_16x16x32_bf16 v[64:67], v[32:35], v[220:223], v[64:67]
    v_subrev_u32 v28, 81920, v28
    ds_read_b64_tr_b16 v[48:49], v28 offset:0
    v_mfma_f32_16x16x32_bf16 v[68:71], v[32:35], v[224:227], v[68:71]
    ds_read_b64_tr_b16 v[50:51], v28 offset:4096
    v_mfma_f32_16x16x32_bf16 v[72:75], v[32:35], v[228:231], v[72:75]
    v_subrev_u32 v29, 81920, v29
    ds_read_b64_tr_b16 v[52:53], v29 offset:0
    s_waitcnt lgkmcnt(7)
    v_mfma_f32_16x16x32_bf16 v[76:79], v[36:39], v[220:223], v[76:79]
    ds_read_b64_tr_b16 v[54:55], v29 offset:4096
    v_mfma_f32_16x16x32_bf16 v[80:83], v[36:39], v[224:227], v[80:83]
    v_subrev_u32 v30, 81920, v30
    ds_read_b64_tr_b16 v[56:57], v30 offset:0
    v_mfma_f32_16x16x32_bf16 v[84:87], v[36:39], v[228:231], v[84:87]
    ds_read_b64_tr_b16 v[58:59], v30 offset:4096
    s_waitcnt lgkmcnt(8)
    v_mfma_f32_16x16x32_bf16 v[88:91], v[40:43], v[220:223], v[88:91]
    v_subrev_u32 v31, 81920, v31
    ds_read_b64_tr_b16 v[60:61], v31 offset:0
    v_mfma_f32_16x16x32_bf16 v[92:95], v[40:43], v[224:227], v[92:95]
    ds_read_b64_tr_b16 v[62:63], v31 offset:4096
    v_mfma_f32_16x16x32_bf16 v[96:99], v[40:43], v[228:231], v[96:99]
    s_waitcnt lgkmcnt(8)
    v_mfma_f32_16x16x32_bf16 v[100:103], v[44:47], v[220:223], v[100:103]
    v_mfma_f32_16x16x32_bf16 v[104:107], v[44:47], v[224:227], v[104:107]
    v_mfma_f32_16x16x32_bf16 v[108:111], v[44:47], v[228:231], v[108:111]
    s_waitcnt vmcnt(0)
    s_waitcnt lgkmcnt(0)
    s_barrier
    v_mfma_f32_16x16x32_bf16 v[112:115], v[48:51], v[220:223], v[112:115]
    ds_read_b64_tr_b16 v[32:33], v24 offset:16384
    v_mfma_f32_16x16x32_bf16 v[116:119], v[48:51], v[224:227], v[116:119]
    ds_read_b64_tr_b16 v[34:35], v24 offset:20480
    s_add_u32 s65, s46, 0
    s_and_b32 s65, s65, 7
    s_mul_i32 s65, s65, 40960
    s_add_u32 s65, s65, s43
    buffer_load_dwordx4 v[148:151], v7, s[24:27], s65 offen offset:0 sc1
    v_mfma_f32_16x16x32_bf16 v[120:123], v[48:51], v[228:231], v[120:123]
    ds_read_b64_tr_b16 v[36:37], v25 offset:16384
    v_mfma_f32_16x16x32_bf16 v[124:127], v[52:55], v[220:223], v[124:127]
    ds_read_b64_tr_b16 v[38:39], v25 offset:20480
    buffer_load_dwordx4 v[152:155], v7, s[24:27], s65 offen offset:1024 sc1
    v_mfma_f32_16x16x32_bf16 v[128:131], v[52:55], v[224:227], v[128:131]
    ds_read_b64_tr_b16 v[40:41], v26 offset:16384
    v_mfma_f32_16x16x32_bf16 v[132:135], v[52:55], v[228:231], v[132:135]
    ds_read_b64_tr_b16 v[42:43], v26 offset:20480
    buffer_load_dwordx4 v[156:159], v7, s[24:27], s65 offen offset:2048 sc1
    v_mfma_f32_16x16x32_bf16 v[136:139], v[56:59], v[220:223], v[136:139]
    ds_read_b64_tr_b16 v[44:45], v27 offset:16384
    v_mfma_f32_16x16x32_bf16 v[140:143], v[56:59], v[224:227], v[140:143]
    ds_read_b64_tr_b16 v[46:47], v27 offset:20480
    buffer_load_dwordx4 v[160:163], v7, s[24:27], s65 offen offset:3072 sc1
    v_mfma_f32_16x16x32_bf16 v[144:147], v[56:59], v[228:231], v[144:147]
    v_mfma_f32_16x16x32_bf16 v[244:247], v[60:63], v[220:223], v[244:247]
    buffer_load_dwordx4 v[164:167], v8, s[24:27], s65 offen offset:0 sc1
    v_mfma_f32_16x16x32_bf16 v[248:251], v[60:63], v[224:227], v[248:251]
    v_mfma_f32_16x16x32_bf16 v[252:255], v[60:63], v[228:231], v[252:255]
    s_add_u32 s65, s46, 1
    s_and_b32 s65, s65, 7
    s_mul_i32 s65, s65, 40960
    s_add_u32 s65, s65, s43
    buffer_load_dwordx4 v[168:171], v7, s[24:27], s65 offen offset:0 sc1
    buffer_load_dwordx4 v[172:175], v7, s[24:27], s65 offen offset:1024 sc1
    s_waitcnt lgkmcnt(6)
    v_mfma_f32_16x16x32_bf16 v[64:67], v[32:35], v[232:235], v[64:67]
    ds_read_b64_tr_b16 v[48:49], v28 offset:16384
    v_mfma_f32_16x16x32_bf16 v[68:71], v[32:35], v[236:239], v[68:71]
    ds_read_b64_tr_b16 v[50:51], v28 offset:20480
    buffer_load_dwordx4 v[176:179], v7, s[24:27], s65 offen offset:2048 sc1
    v_mfma_f32_16x16x32_bf16 v[72:75], v[32:35], v[240:243], v[72:75]
    ds_read_b64_tr_b16 v[52:53], v29 offset:16384
    s_waitcnt lgkmcnt(7)
    v_mfma_f32_16x16x32_bf16 v[76:79], v[36:39], v[232:235], v[76:79]
    ds_read_b64_tr_b16 v[54:55], v29 offset:20480
    buffer_load_dwordx4 v[180:183], v7, s[24:27], s65 offen offset:3072 sc1
    v_mfma_f32_16x16x32_bf16 v[80:83], v[36:39], v[236:239], v[80:83]
    ds_read_b64_tr_b16 v[56:57], v30 offset:16384
    v_mfma_f32_16x16x32_bf16 v[84:87], v[36:39], v[240:243], v[84:87]
    ds_read_b64_tr_b16 v[58:59], v30 offset:20480
    buffer_load_dwordx4 v[184:187], v8, s[24:27], s65 offen offset:0 sc1
    s_waitcnt lgkmcnt(8)
    v_mfma_f32_16x16x32_bf16 v[88:91], v[40:43], v[232:235], v[88:91]
    ds_read_b64_tr_b16 v[60:61], v31 offset:16384
    v_mfma_f32_16x16x32_bf16 v[92:95], v[40:43], v[236:239], v[92:95]
    ds_read_b64_tr_b16 v[62:63], v31 offset:20480
    s_add_u32 s65, s46, 2
    s_and_b32 s65, s65, 7
    s_mul_i32 s65, s65, 40960
    s_add_u32 s65, s65, s43
    buffer_load_dwordx4 v[188:191], v7, s[24:27], s65 offen offset:0 sc1
    v_mfma_f32_16x16x32_bf16 v[96:99], v[40:43], v[240:243], v[96:99]
    s_waitcnt lgkmcnt(8)
    v_mfma_f32_16x16x32_bf16 v[100:103], v[44:47], v[232:235], v[100:103]
    buffer_load_dwordx4 v[192:195], v7, s[24:27], s65 offen offset:1024 sc1
    v_mfma_f32_16x16x32_bf16 v[104:107], v[44:47], v[236:239], v[104:107]
    v_mfma_f32_16x16x32_bf16 v[108:111], v[44:47], v[240:243], v[108:111]
    buffer_load_dwordx4 v[196:199], v7, s[24:27], s65 offen offset:2048 sc1
    buffer_load_dwordx4 v[200:203], v7, s[24:27], s65 offen offset:3072 sc1
    buffer_load_dwordx4 v[204:207], v8, s[24:27], s65 offen offset:0 sc1
    s_add_u32 s56, s52, 1
    s_lshl_b32 s56, s56, 14
    s_cmp_eq_u32 s52, 0
    s_cselect_b32 s56, 0, s56
    s_cmp_eq_u32 s52, 3
    s_cselect_b32 s56, 81920, s56
    s_add_u32 s56, s56, 65536
    v_add_u32 v2, s56, v7
    s_waitcnt lgkmcnt(0)
    v_mfma_f32_16x16x32_bf16 v[112:115], v[48:51], v[232:235], v[112:115]
    ds_write_b128 v2, v[64:67] offset:0
    v_mfma_f32_16x16x32_bf16 v[116:119], v[48:51], v[236:239], v[116:119]
    ds_write_b128 v2, v[68:71] offset:1024
    v_mfma_f32_16x16x32_bf16 v[120:123], v[48:51], v[240:243], v[120:123]
    ds_write_b128 v2, v[72:75] offset:2048
    v_mfma_f32_16x16x32_bf16 v[124:127], v[52:55], v[232:235], v[124:127]
    ds_write_b128 v2, v[76:79] offset:3072
    v_mfma_f32_16x16x32_bf16 v[128:131], v[52:55], v[236:239], v[128:131]
    ds_write_b128 v2, v[80:83] offset:4096
    v_mfma_f32_16x16x32_bf16 v[132:135], v[52:55], v[240:243], v[132:135]
    ds_write_b128 v2, v[84:87] offset:5120
    v_mfma_f32_16x16x32_bf16 v[136:139], v[56:59], v[232:235], v[136:139]
    ds_write_b128 v2, v[88:91] offset:6144
    v_mfma_f32_16x16x32_bf16 v[140:143], v[56:59], v[236:239], v[140:143]
    ds_write_b128 v2, v[92:95] offset:7168
    v_mfma_f32_16x16x32_bf16 v[144:147], v[56:59], v[240:243], v[144:147]
    ds_write_b128 v2, v[96:99] offset:8192
    v_mfma_f32_16x16x32_bf16 v[244:247], v[60:63], v[232:235], v[244:247]
    ds_write_b128 v2, v[100:103] offset:9216
    v_mfma_f32_16x16x32_bf16 v[248:251], v[60:63], v[236:239], v[248:251]
    ds_write_b128 v2, v[104:107] offset:10240
    v_mfma_f32_16x16x32_bf16 v[252:255], v[60:63], v[240:243], v[252:255]
    ds_write_b128 v2, v[108:111] offset:11264
    s_waitcnt lgkmcnt(0)
    s_barrier
    s_xor_b32 s57, s52, 2
    s_add_u32 s56, s57, 1
    s_lshl_b32 s56, s56, 14
    s_cmp_eq_u32 s57, 0
    s_cselect_b32 s56, 0, s56
    s_cmp_eq_u32 s57, 3
    s_cselect_b32 s56, 81920, s56
    s_add_u32 s56, s56, 65536
    v_add_u32 v2, s56, v7
    ds_read_b128 v[64:67], v2 offset:0
    ds_read_b128 v[68:71], v2 offset:1024
    ds_read_b128 v[72:75], v2 offset:2048
    ds_read_b128 v[76:79], v2 offset:3072
    ds_read_b128 v[80:83], v2 offset:4096
    ds_read_b128 v[84:87], v2 offset:5120
    ds_read_b128 v[88:91], v2 offset:6144
    ds_read_b128 v[92:95], v2 offset:7168
    ds_read_b128 v[96:99], v2 offset:8192
    ds_read_b128 v[100:103], v2 offset:9216
    ds_read_b128 v[104:107], v2 offset:10240
    ds_read_b128 v[108:111], v2 offset:11264
    s_lshl_b32 s56, s54, 1
    s_add_u32 s56, s56, s50
    s_lshl_b32 s56, s56, 7
    s_lshl_b32 s57, s67, 2
    s_add_u32 s56, s56, s57
    s_lshl_b32 s57, s51, 1
    s_add_u32 s56, s56, s57
    s_mul_i32 s56, s56, 3072
    s_add_u32 s57, s56, 3072
    v_mul_f32 v112, v112, v18
    v_mul_f32 v113, v113, v18
    v_mul_f32 v114, v114, v18
    v_mul_f32 v115, v115, v18
    v_mul_f32 v116, v116, v19
    v_mul_f32 v117, v117, v19
    v_mul_f32 v118, v118, v19
    v_mul_f32 v119, v119, v19
    v_mul_f32 v120, v120, v20
    v_mul_f32 v121, v121, v20
    v_mul_f32 v122, v122, v20
    v_mul_f32 v123, v123, v20
    s_waitcnt lgkmcnt(9)
    v_fmac_f32 v112, v64, v21
    v_fmac_f32 v113, v65, v21
    v_fmac_f32 v114, v66, v21
    v_fmac_f32 v115, v67, v21
    v_cvt_pk_bf16_f32 v208, v112, v113
    v_cvt_pk_bf16_f32 v209, v114, v115
    v_fmac_f32 v116, v68, v22
    v_fmac_f32 v117, v69, v22
    v_fmac_f32 v118, v70, v22
    v_fmac_f32 v119, v71, v22
    v_cvt_pk_bf16_f32 v212, v116, v117
    v_cvt_pk_bf16_f32 v213, v118, v119
    v_fmac_f32 v120, v72, v23
    v_fmac_f32 v121, v73, v23
    v_fmac_f32 v122, v74, v23
    v_fmac_f32 v123, v75, v23
    v_cvt_pk_bf16_f32 v216, v120, v121
    v_cvt_pk_bf16_f32 v217, v122, v123
    v_mul_f32 v124, v124, v18
    v_mul_f32 v125, v125, v18
    v_mul_f32 v126, v126, v18
    v_mul_f32 v127, v127, v18
    v_mul_f32 v128, v128, v19
    v_mul_f32 v129, v129, v19
    v_mul_f32 v130, v130, v19
    v_mul_f32 v131, v131, v19
    v_mul_f32 v132, v132, v20
    v_mul_f32 v133, v133, v20
    v_mul_f32 v134, v134, v20
    v_mul_f32 v135, v135, v20
    s_waitcnt lgkmcnt(6)
    v_fmac_f32 v124, v76, v21
    v_fmac_f32 v125, v77, v21
    v_fmac_f32 v126, v78, v21
    v_fmac_f32 v127, v79, v21
    v_cvt_pk_bf16_f32 v210, v124, v125
    v_cvt_pk_bf16_f32 v211, v126, v127
    v_fmac_f32 v128, v80, v22
    v_fmac_f32 v129, v81, v22
    v_fmac_f32 v130, v82, v22
    v_fmac_f32 v131, v83, v22
    v_cvt_pk_bf16_f32 v214, v128, v129
    v_cvt_pk_bf16_f32 v215, v130, v131
    v_fmac_f32 v132, v84, v23
    v_fmac_f32 v133, v85, v23
    v_fmac_f32 v134, v86, v23
    v_fmac_f32 v135, v87, v23
    v_cvt_pk_bf16_f32 v218, v132, v133
    v_cvt_pk_bf16_f32 v219, v134, v135
    buffer_store_dwordx4 v[208:211], v7, s[24:27], s56 offen offset:0 sc1
    buffer_store_dwordx4 v[212:215], v7, s[24:27], s56 offen offset:1024 sc1
    buffer_store_dwordx4 v[216:219], v7, s[24:27], s56 offen offset:2048 sc1
    v_mul_f32 v136, v136, v18
    v_mul_f32 v137, v137, v18
    v_mul_f32 v138, v138, v18
    v_mul_f32 v139, v139, v18
    v_mul_f32 v140, v140, v19
    v_mul_f32 v141, v141, v19
    v_mul_f32 v142, v142, v19
    v_mul_f32 v143, v143, v19
    v_mul_f32 v144, v144, v20
    v_mul_f32 v145, v145, v20
    v_mul_f32 v146, v146, v20
    v_mul_f32 v147, v147, v20
    s_waitcnt lgkmcnt(3)
    v_fmac_f32 v136, v88, v21
    v_fmac_f32 v137, v89, v21
    v_fmac_f32 v138, v90, v21
    v_fmac_f32 v139, v91, v21
    v_cvt_pk_bf16_f32 v220, v136, v137
    v_cvt_pk_bf16_f32 v221, v138, v139
    v_fmac_f32 v140, v92, v22
    v_fmac_f32 v141, v93, v22
    v_fmac_f32 v142, v94, v22
    v_fmac_f32 v143, v95, v22
    v_cvt_pk_bf16_f32 v224, v140, v141
    v_cvt_pk_bf16_f32 v225, v142, v143
    v_fmac_f32 v144, v96, v23
    v_fmac_f32 v145, v97, v23
    v_fmac_f32 v146, v98, v23
    v_fmac_f32 v147, v99, v23
    v_cvt_pk_bf16_f32 v228, v144, v145
    v_cvt_pk_bf16_f32 v229, v146, v147
    v_mul_f32 v244, v244, v18
    v_mul_f32 v245, v245, v18
    v_mul_f32 v246, v246, v18
    v_mul_f32 v247, v247, v18
    v_mul_f32 v248, v248, v19
    v_mul_f32 v249, v249, v19
    v_mul_f32 v250, v250, v19
    v_mul_f32 v251, v251, v19
    v_mul_f32 v252, v252, v20
    v_mul_f32 v253, v253, v20
    v_mul_f32 v254, v254, v20
    v_mul_f32 v255, v255, v20
    s_waitcnt lgkmcnt(0)
    v_fmac_f32 v244, v100, v21
    v_fmac_f32 v245, v101, v21
    v_fmac_f32 v246, v102, v21
    v_fmac_f32 v247, v103, v21
    v_cvt_pk_bf16_f32 v222, v244, v245
    v_cvt_pk_bf16_f32 v223, v246, v247
    v_fmac_f32 v248, v104, v22
    v_fmac_f32 v249, v105, v22
    v_fmac_f32 v250, v106, v22
    v_fmac_f32 v251, v107, v22
    v_cvt_pk_bf16_f32 v226, v248, v249
    v_cvt_pk_bf16_f32 v227, v250, v251
    v_fmac_f32 v252, v108, v23
    v_fmac_f32 v253, v109, v23
    v_fmac_f32 v254, v110, v23
    v_fmac_f32 v255, v111, v23
    v_cvt_pk_bf16_f32 v230, v252, v253
    v_cvt_pk_bf16_f32 v231, v254, v255
    buffer_store_dwordx4 v[220:223], v7, s[24:27], s57 offen offset:0 sc1
    buffer_store_dwordx4 v[224:227], v7, s[24:27], s57 offen offset:1024 sc1
    buffer_store_dwordx4 v[228:231], v7, s[24:27], s57 offen offset:2048 sc1
    s_branch K1_TAIL
K1_SLOW_1:
    s_nop 7
    v_mov_b32 v144, v136
    v_mov_b32 v145, v137
    v_mov_b32 v146, v138
    v_permlane32_swap_b32 v136, v144
    v_permlane32_swap_b32 v137, v145
    v_permlane32_swap_b32 v138, v146
    v_max_f32 v136, v136, v144
    v_max_f32 v137, v137, v145
    v_max_f32 v138, v138, v146
    v_mov_b32 v144, v136
    v_mov_b32 v145, v137
    v_mov_b32 v146, v138
    v_permlane16_swap_b32 v136, v144
    v_permlane16_swap_b32 v137, v145
    v_permlane16_swap_b32 v138, v146
    v_max_f32 v136, v136, v144
    v_max_f32 v137, v137, v145
    v_max_f32 v138, v138, v146
    v_ceil_f32 v136, v136
    v_max_f32 v136, 0, v136
    v_add_f32 v18, v18, v136
    v_sub_f32 v112, v112, v136
    v_sub_f32 v113, v113, v136
    v_sub_f32 v114, v114, v136
    v_sub_f32 v115, v115, v136
    v_sub_f32 v116, v116, v136
    v_sub_f32 v117, v117, v136
    v_sub_f32 v118, v118, v136
    v_sub_f32 v119, v119, v136
    v_sub_f32 v140, 0, v136
    v_exp_f32 v140, v140
    s_nop 0
    v_mul_f32 v21, v21, v140
    v_ceil_f32 v137, v137
    v_max_f32 v137, 0, v137
    v_add_f32 v19, v19, v137
    v_sub_f32 v120, v120, v137
    v_sub_f32 v121, v121, v137
    v_sub_f32 v122, v122, v137
    v_sub_f32 v123, v123, v137
    v_sub_f32 v124, v124, v137
    v_sub_f32 v125, v125, v137
    v_sub_f32 v126, v126, v137
    v_sub_f32 v127, v127, v137
    v_sub_f32 v141, 0, v137
    v_exp_f32 v141, v141
    s_nop 0
    v_mul_f32 v22, v22, v141
    v_ceil_f32 v138, v138
    v_max_f32 v138, 0, v138
    v_add_f32 v20, v20, v138
    v_sub_f32 v128, v128, v138
    v_sub_f32 v129, v129, v138
    v_sub_f32 v130, v130, v138
    v_sub_f32 v131, v131, v138
    v_sub_f32 v132, v132, v138
    v_sub_f32 v133, v133, v138
    v_sub_f32 v134, v134, v138
    v_sub_f32 v135, v135, v138
    v_sub_f32 v142, 0, v138
    v_exp_f32 v142, v142
    s_nop 0
    v_mul_f32 v23, v23, v142
    v_lshlrev_b32 v144, 16, v148
    v_and_b32 v145, 0xffff0000, v148
    v_mul_f32 v144, v144, v140
    v_mul_f32 v145, v145, v140
    v_cvt_pk_bf16_f32 v148, v144, v145
    v_lshlrev_b32 v144, 16, v149
    v_and_b32 v145, 0xffff0000, v149
    v_mul_f32 v144, v144, v140
    v_mul_f32 v145, v145, v140
    v_cvt_pk_bf16_f32 v149, v144, v145
    v_lshlrev_b32 v144, 16, v150
    v_and_b32 v145, 0xffff0000, v150
    v_mul_f32 v144, v144, v140
    v_mul_f32 v145, v145, v140
    v_cvt_pk_bf16_f32 v150, v144, v145
    v_lshlrev_b32 v144, 16, v151
    v_and_b32 v145, 0xffff0000, v151
    v_mul_f32 v144, v144, v140
    v_mul_f32 v145, v145, v140
    v_cvt_pk_bf16_f32 v151, v144, v145
    v_lshlrev_b32 v144, 16, v152
    v_and_b32 v145, 0xffff0000, v152
    v_mul_f32 v144, v144, v141
    v_mul_f32 v145, v145, v141
    v_cvt_pk_bf16_f32 v152, v144, v145
    v_lshlrev_b32 v144, 16, v153
    v_and_b32 v145, 0xffff0000, v153
    v_mul_f32 v144, v144, v141
    v_mul_f32 v145, v145, v141
    v_cvt_pk_bf16_f32 v153, v144, v145
    v_lshlrev_b32 v144, 16, v154
    v_and_b32 v145, 0xffff0000, v154
    v_mul_f32 v144, v144, v141
    v_mul_f32 v145, v145, v141
    v_cvt_pk_bf16_f32 v154, v144, v145
    v_lshlrev_b32 v144, 16, v155
    v_and_b32 v145, 0xffff0000, v155
    v_mul_f32 v144, v144, v141
    v_mul_f32 v145, v145, v141
    v_cvt_pk_bf16_f32 v155, v144, v145
    v_lshlrev_b32 v144, 16, v156
    v_and_b32 v145, 0xffff0000, v156
    v_mul_f32 v144, v144, v142
    v_mul_f32 v145, v145, v142
    v_cvt_pk_bf16_f32 v156, v144, v145
    v_lshlrev_b32 v144, 16, v157
    v_and_b32 v145, 0xffff0000, v157
    v_mul_f32 v144, v144, v142
    v_mul_f32 v145, v145, v142
    v_cvt_pk_bf16_f32 v157, v144, v145
    v_lshlrev_b32 v144, 16, v158
    v_and_b32 v145, 0xffff0000, v158
    v_mul_f32 v144, v144, v142
    v_mul_f32 v145, v145, v142
    v_cvt_pk_bf16_f32 v158, v144, v145
    v_lshlrev_b32 v144, 16, v159
    v_and_b32 v145, 0xffff0000, v159
    v_mul_f32 v144, v144, v142
    v_mul_f32 v145, v145, v142
    v_cvt_pk_bf16_f32 v159, v144, v145
    s_cmp_le_u32 s28, 1
    s_cbranch_scc1 K1_SLOW_DONE_1
    v_lshlrev_b32 v144, 16, v160
    v_and_b32 v145, 0xffff0000, v160
    v_mul_f32 v144, v144, v140
    v_mul_f32 v145, v145, v140
    v_cvt_pk_bf16_f32 v160, v144, v145
    v_lshlrev_b32 v144, 16, v161
    v_and_b32 v145, 0xffff0000, v161
    v_mul_f32 v144, v144, v140
    v_mul_f32 v145, v145, v140
    v_cvt_pk_bf16_f32 v161, v144, v145
    v_lshlrev_b32 v144, 16, v162
    v_and_b32 v145, 0xffff0000, v162
    v_mul_f32 v144, v144, v140
    v_mul_f32 v145, v145, v140
    v_cvt_pk_bf16_f32 v162, v144, v145
    v_lshlrev_b32 v144, 16, v163
    v_and_b32 v145, 0xffff0000, v163
    v_mul_f32 v144, v144, v140
    v_mul_f32 v145, v145, v140
    v_cvt_pk_bf16_f32 v163, v144, v145
    v_lshlrev_b32 v144, 16, v164
    v_and_b32 v145, 0xffff0000, v164
    v_mul_f32 v144, v144, v141
    v_mul_f32 v145, v145, v141
    v_cvt_pk_bf16_f32 v164, v144, v145
    v_lshlrev_b32 v144, 16, v165
    v_and_b32 v145, 0xffff0000, v165
    v_mul_f32 v144, v144, v141
    v_mul_f32 v145, v145, v141
    v_cvt_pk_bf16_f32 v165, v144, v145
    v_lshlrev_b32 v144, 16, v166
    v_and_b32 v145, 0xffff0000, v166
    v_mul_f32 v144, v144, v141
    v_mul_f32 v145, v145, v141
    v_cvt_pk_bf16_f32 v166, v144, v145
    v_lshlrev_b32 v144, 16, v167
    v_and_b32 v145, 0xffff0000, v167
    v_mul_f32 v144, v144, v141
    v_mul_f32 v145, v145, v141
    v_cvt_pk_bf16_f32 v167, v144, v145
    v_lshlrev_b32 v144, 16, v168
    v_and_b32 v145, 0xffff0000, v168
    v_mul_f32 v144, v144, v142
    v_mul_f32 v145, v145, v142
    v_cvt_pk_bf16_f32 v168, v144, v145
    v_lshlrev_b32 v144, 16, v169
    v_and_b32 v145, 0xffff0000, v169
    v_mul_f32 v144, v144, v142
    v_mul_f32 v145, v145, v142
    v_cvt_pk_bf16_f32 v169, v144, v145
    v_lshlrev_b32 v144, 16, v170
    v_and_b32 v145, 0xffff0000, v170
    v_mul_f32 v144, v144, v142
    v_mul_f32 v145, v145, v142
    v_cvt_pk_bf16_f32 v170, v144, v145
    v_lshlrev_b32 v144, 16, v171
    v_and_b32 v145, 0xffff0000, v171
    v_mul_f32 v144, v144, v142
    v_mul_f32 v145, v145, v142
    v_cvt_pk_bf16_f32 v171, v144, v145
    s_cmp_le_u32 s28, 2
    s_cbranch_scc1 K1_SLOW_DONE_1
    v_lshlrev_b32 v144, 16, v172
    v_and_b32 v145, 0xffff0000, v172
    v_mul_f32 v144, v144, v140
    v_mul_f32 v145, v145, v140
    v_cvt_pk_bf16_f32 v172, v144, v145
    v_lshlrev_b32 v144, 16, v173
    v_and_b32 v145, 0xffff0000, v173
    v_mul_f32 v144, v144, v140
    v_mul_f32 v145, v145, v140
    v_cvt_pk_bf16_f32 v173, v144, v145
    v_lshlrev_b32 v144, 16, v174
    v_and_b32 v145, 0xffff0000, v174
    v_mul_f32 v144, v144, v140
    v_mul_f32 v145, v145, v140
    v_cvt_pk_bf16_f32 v174, v144, v145
    v_lshlrev_b32 v144, 16, v175
    v_and_b32 v145, 0xffff0000, v175
    v_mul_f32 v144, v144, v140
    v_mul_f32 v145, v145, v140
    v_cvt_pk_bf16_f32 v175, v144, v145
    v_lshlrev_b32 v144, 16, v176
    v_and_b32 v145, 0xffff0000, v176
    v_mul_f32 v144, v144, v141
    v_mul_f32 v145, v145, v141
    v_cvt_pk_bf16_f32 v176, v144, v145
    v_lshlrev_b32 v144, 16, v177
    v_and_b32 v145, 0xffff0000, v177
    v_mul_f32 v144, v144, v141
    v_mul_f32 v145, v145, v141
    v_cvt_pk_bf16_f32 v177, v144, v145
    v_lshlrev_b32 v144, 16, v178
    v_and_b32 v145, 0xffff0000, v178
    v_mul_f32 v144, v144, v141
    v_mul_f32 v145, v145, v141
    v_cvt_pk_bf16_f32 v178, v144, v145
    v_lshlrev_b32 v144, 16, v179
    v_and_b32 v145, 0xffff0000, v179
    v_mul_f32 v144, v144, v141
    v_mul_f32 v145, v145, v141
    v_cvt_pk_bf16_f32 v179, v144, v145
    v_lshlrev_b32 v144, 16, v180
    v_and_b32 v145, 0xffff0000, v180
    v_mul_f32 v144, v144, v142
    v_mul_f32 v145, v145, v142
    v_cvt_pk_bf16_f32 v180, v144, v145
    v_lshlrev_b32 v144, 16, v181
    v_and_b32 v145, 0xffff0000, v181
    v_mul_f32 v144, v144, v142
    v_mul_f32 v145, v145, v142
    v_cvt_pk_bf16_f32 v181, v144, v145
    v_lshlrev_b32 v144, 16, v182
    v_and_b32 v145, 0xffff0000, v182
    v_mul_f32 v144, v144, v142
    v_mul_f32 v145, v145, v142
    v_cvt_pk_bf16_f32 v182, v144, v145
    v_lshlrev_b32 v144, 16, v183
    v_and_b32 v145, 0xffff0000, v183
    v_mul_f32 v144, v144, v142
    v_mul_f32 v145, v145, v142
    v_cvt_pk_bf16_f32 v183, v144, v145
    s_cmp_le_u32 s28, 3
    s_cbranch_scc1 K1_SLOW_DONE_1
    v_lshlrev_b32 v144, 16, v184
    v_and_b32 v145, 0xffff0000, v184
    v_mul_f32 v144, v144, v140
    v_mul_f32 v145, v145, v140
    v_cvt_pk_bf16_f32 v184, v144, v145
    v_lshlrev_b32 v144, 16, v185
    v_and_b32 v145, 0xffff0000, v185
    v_mul_f32 v144, v144, v140
    v_mul_f32 v145, v145, v140
    v_cvt_pk_bf16_f32 v185, v144, v145
    v_lshlrev_b32 v144, 16, v186
    v_and_b32 v145, 0xffff0000, v186
    v_mul_f32 v144, v144, v140
    v_mul_f32 v145, v145, v140
    v_cvt_pk_bf16_f32 v186, v144, v145
    v_lshlrev_b32 v144, 16, v187
    v_and_b32 v145, 0xffff0000, v187
    v_mul_f32 v144, v144, v140
    v_mul_f32 v145, v145, v140
    v_cvt_pk_bf16_f32 v187, v144, v145
    v_lshlrev_b32 v144, 16, v188
    v_and_b32 v145, 0xffff0000, v188
    v_mul_f32 v144, v144, v141
    v_mul_f32 v145, v145, v141
    v_cvt_pk_bf16_f32 v188, v144, v145
    v_lshlrev_b32 v144, 16, v189
    v_and_b32 v145, 0xffff0000, v189
    v_mul_f32 v144, v144, v141
    v_mul_f32 v145, v145, v141
    v_cvt_pk_bf16_f32 v189, v144, v145
    v_lshlrev_b32 v144, 16, v190
    v_and_b32 v145, 0xffff0000, v190
    v_mul_f32 v144, v144, v141
    v_mul_f32 v145, v145, v141
    v_cvt_pk_bf16_f32 v190, v144, v145
    v_lshlrev_b32 v144, 16, v191
    v_and_b32 v145, 0xffff0000, v191
    v_mul_f32 v144, v144, v141
    v_mul_f32 v145, v145, v141
    v_cvt_pk_bf16_f32 v191, v144, v145
    v_lshlrev_b32 v144, 16, v192
    v_and_b32 v145, 0xffff0000, v192
    v_mul_f32 v144, v144, v142
    v_mul_f32 v145, v145, v142
    v_cvt_pk_bf16_f32 v192, v144, v145
    v_lshlrev_b32 v144, 16, v193
    v_and_b32 v145, 0xffff0000, v193
    v_mul_f32 v144, v144, v142
    v_mul_f32 v145, v145, v142
    v_cvt_pk_bf16_f32 v193, v144, v145
    v_lshlrev_b32 v144, 16, v194
    v_and_b32 v145, 0xffff0000, v194
    v_mul_f32 v144, v144, v142
    v_mul_f32 v145, v145, v142
    v_cvt_pk_bf16_f32 v194, v144, v145
    v_lshlrev_b32 v144, 16, v195
    v_and_b32 v145, 0xffff0000, v195
    v_mul_f32 v144, v144, v142
    v_mul_f32 v145, v145, v142
    v_cvt_pk_bf16_f32 v195, v144, v145
    s_cmp_le_u32 s28, 4
    s_cbranch_scc1 K1_SLOW_DONE_1
    v_lshlrev_b32 v144, 16, v196
    v_and_b32 v145, 0xffff0000, v196
    v_mul_f32 v144, v144, v140
    v_mul_f32 v145, v145, v140
    v_cvt_pk_bf16_f32 v196, v144, v145
    v_lshlrev_b32 v144, 16, v197
    v_and_b32 v145, 0xffff0000, v197
    v_mul_f32 v144, v144, v140
    v_mul_f32 v145, v145, v140
    v_cvt_pk_bf16_f32 v197, v144, v145
    v_lshlrev_b32 v144, 16, v198
    v_and_b32 v145, 0xffff0000, v198
    v_mul_f32 v144, v144, v140
    v_mul_f32 v145, v145, v140
    v_cvt_pk_bf16_f32 v198, v144, v145
    v_lshlrev_b32 v144, 16, v199
    v_and_b32 v145, 0xffff0000, v199
    v_mul_f32 v144, v144, v140
    v_mul_f32 v145, v145, v140
    v_cvt_pk_bf16_f32 v199, v144, v145
    v_lshlrev_b32 v144, 16, v200
    v_and_b32 v145, 0xffff0000, v200
    v_mul_f32 v144, v144, v141
    v_mul_f32 v145, v145, v141
    v_cvt_pk_bf16_f32 v200, v144, v145
    v_lshlrev_b32 v144, 16, v201
    v_and_b32 v145, 0xffff0000, v201
    v_mul_f32 v144, v144, v141
    v_mul_f32 v145, v145, v141
    v_cvt_pk_bf16_f32 v201, v144, v145
    v_lshlrev_b32 v144, 16, v202
    v_and_b32 v145, 0xffff0000, v202
    v_mul_f32 v144, v144, v141
    v_mul_f32 v145, v145, v141
    v_cvt_pk_bf16_f32 v202, v144, v145
    v_lshlrev_b32 v144, 16, v203
    v_and_b32 v145, 0xffff0000, v203
    v_mul_f32 v144, v144, v141
    v_mul_f32 v145, v145, v141
    v_cvt_pk_bf16_f32 v203, v144, v145
    v_lshlrev_b32 v144, 16, v204
    v_and_b32 v145, 0xffff0000, v204
    v_mul_f32 v144, v144, v142
    v_mul_f32 v145, v145, v142
    v_cvt_pk_bf16_f32 v204, v144, v145
    v_lshlrev_b32 v144, 16, v205
    v_and_b32 v145, 0xffff0000, v205
    v_mul_f32 v144, v144, v142
    v_mul_f32 v145, v145, v142
    v_cvt_pk_bf16_f32 v205, v144, v145
    v_lshlrev_b32 v144, 16, v206
    v_and_b32 v145, 0xffff0000, v206
    v_mul_f32 v144, v144, v142
    v_mul_f32 v145, v145, v142
    v_cvt_pk_bf16_f32 v206, v144, v145
    v_lshlrev_b32 v144, 16, v207
    v_and_b32 v145, 0xffff0000, v207
    v_mul_f32 v144, v144, v142
    v_mul_f32 v145, v145, v142
    v_cvt_pk_bf16_f32 v207, v144, v145
    s_cmp_le_u32 s28, 5
    s_cbranch_scc1 K1_SLOW_DONE_1
    v_lshlrev_b32 v144, 16, v208
    v_and_b32 v145, 0xffff0000, v208
    v_mul_f32 v144, v144, v140
    v_mul_f32 v145, v145, v140
    v_cvt_pk_bf16_f32 v208, v144, v145
    v_lshlrev_b32 v144, 16, v209
    v_and_b32 v145, 0xffff0000, v209
    v_mul_f32 v144, v144, v140
    v_mul_f32 v145, v145, v140
    v_cvt_pk_bf16_f32 v209, v144, v145
    v_lshlrev_b32 v144, 16, v210
    v_and_b32 v145, 0xffff0000, v210
    v_mul_f32 v144, v144, v140
    v_mul_f32 v145, v145, v140
    v_cvt_pk_bf16_f32 v210, v144, v145
    v_lshlrev_b32 v144, 16, v211
    v_and_b32 v145, 0xffff0000, v211
    v_mul_f32 v144, v144, v140
    v_mul_f32 v145, v145, v140
    v_cvt_pk_bf16_f32 v211, v144, v145
    v_lshlrev_b32 v144, 16, v212
    v_and_b32 v145, 0xffff0000, v212
    v_mul_f32 v144, v144, v141
    v_mul_f32 v145, v145, v141
    v_cvt_pk_bf16_f32 v212, v144, v145
    v_lshlrev_b32 v144, 16, v213
    v_and_b32 v145, 0xffff0000, v213
    v_mul_f32 v144, v144, v141
    v_mul_f32 v145, v145, v141
    v_cvt_pk_bf16_f32 v213, v144, v145
    v_lshlrev_b32 v144, 16, v214
    v_and_b32 v145, 0xffff0000, v214
    v_mul_f32 v144, v144, v141
    v_mul_f32 v145, v145, v141
    v_cvt_pk_bf16_f32 v214, v144, v145
    v_lshlrev_b32 v144, 16, v215
    v_and_b32 v145, 0xffff0000, v215
    v_mul_f32 v144, v144, v141
    v_mul_f32 v145, v145, v141
    v_cvt_pk_bf16_f32 v215, v144, v145
    v_lshlrev_b32 v144, 16, v216
    v_and_b32 v145, 0xffff0000, v216
    v_mul_f32 v144, v144, v142
    v_mul_f32 v145, v145, v142
    v_cvt_pk_bf16_f32 v216, v144, v145
    v_lshlrev_b32 v144, 16, v217
    v_and_b32 v145, 0xffff0000, v217
    v_mul_f32 v144, v144, v142
    v_mul_f32 v145, v145, v142
    v_cvt_pk_bf16_f32 v217, v144, v145
    v_lshlrev_b32 v144, 16, v218
    v_and_b32 v145, 0xffff0000, v218
    v_mul_f32 v144, v144, v142
    v_mul_f32 v145, v145, v142
    v_cvt_pk_bf16_f32 v218, v144, v145
    v_lshlrev_b32 v144, 16, v219
    v_and_b32 v145, 0xffff0000, v219
    v_mul_f32 v144, v144, v142
    v_mul_f32 v145, v145, v142
    v_cvt_pk_bf16_f32 v219, v144, v145
    s_cmp_le_u32 s28, 6
    s_cbranch_scc1 K1_SLOW_DONE_1
    v_lshlrev_b32 v144, 16, v220
    v_and_b32 v145, 0xffff0000, v220
    v_mul_f32 v144, v144, v140
    v_mul_f32 v145, v145, v140
    v_cvt_pk_bf16_f32 v220, v144, v145
    v_lshlrev_b32 v144, 16, v221
    v_and_b32 v145, 0xffff0000, v221
    v_mul_f32 v144, v144, v140
    v_mul_f32 v145, v145, v140
    v_cvt_pk_bf16_f32 v221, v144, v145
    v_lshlrev_b32 v144, 16, v222
    v_and_b32 v145, 0xffff0000, v222
    v_mul_f32 v144, v144, v140
    v_mul_f32 v145, v145, v140
    v_cvt_pk_bf16_f32 v222, v144, v145
    v_lshlrev_b32 v144, 16, v223
    v_and_b32 v145, 0xffff0000, v223
    v_mul_f32 v144, v144, v140
    v_mul_f32 v145, v145, v140
    v_cvt_pk_bf16_f32 v223, v144, v145
    v_lshlrev_b32 v144, 16, v224
    v_and_b32 v145, 0xffff0000, v224
    v_mul_f32 v144, v144, v141
    v_mul_f32 v145, v145, v141
    v_cvt_pk_bf16_f32 v224, v144, v145
    v_lshlrev_b32 v144, 16, v225
    v_and_b32 v145, 0xffff0000, v225
    v_mul_f32 v144, v144, v141
    v_mul_f32 v145, v145, v141
    v_cvt_pk_bf16_f32 v225, v144, v145
    v_lshlrev_b32 v144, 16, v226
    v_and_b32 v145, 0xffff0000, v226
    v_mul_f32 v144, v144, v141
    v_mul_f32 v145, v145, v141
    v_cvt_pk_bf16_f32 v226, v144, v145
    v_lshlrev_b32 v144, 16, v227
    v_and_b32 v145, 0xffff0000, v227
    v_mul_f32 v144, v144, v141
    v_mul_f32 v145, v145, v141
    v_cvt_pk_bf16_f32 v227, v144, v145
    v_lshlrev_b32 v144, 16, v228
    v_and_b32 v145, 0xffff0000, v228
    v_mul_f32 v144, v144, v142
    v_mul_f32 v145, v145, v142
    v_cvt_pk_bf16_f32 v228, v144, v145
    v_lshlrev_b32 v144, 16, v229
    v_and_b32 v145, 0xffff0000, v229
    v_mul_f32 v144, v144, v142
    v_mul_f32 v145, v145, v142
    v_cvt_pk_bf16_f32 v229, v144, v145
    v_lshlrev_b32 v144, 16, v230
    v_and_b32 v145, 0xffff0000, v230
    v_mul_f32 v144, v144, v142
    v_mul_f32 v145, v145, v142
    v_cvt_pk_bf16_f32 v230, v144, v145
    v_lshlrev_b32 v144, 16, v231
    v_and_b32 v145, 0xffff0000, v231
    v_mul_f32 v144, v144, v142
    v_mul_f32 v145, v145, v142
    v_cvt_pk_bf16_f32 v231, v144, v145
K1_SLOW_DONE_1:
    s_nop 3
    s_cmp_eq_u32 s28, 1
    s_cbranch_scc1 K1_RET1_1
    s_cmp_eq_u32 s28, 2
    s_cbranch_scc1 K1_RET2_1
    s_cmp_eq_u32 s28, 3
    s_cbranch_scc1 K1_RET3_1
    s_cmp_eq_u32 s28, 4
    s_cbranch_scc1 K1_RET4_1
    s_cmp_eq_u32 s28, 5
    s_cbranch_scc1 K1_RET5_1
    s_cmp_eq_u32 s28, 6
    s_cbranch_scc1 K1_RET6_1
    s_branch K1_RET7_1
K1_TAIL:
    s_nop 0
    s_add_u32 s65, s46, 3
    s_and_b32 s65, s65, 7
    s_mul_i32 s65, s65, 40960
    s_add_u32 s65, s65, s43
    buffer_load_dwordx4 v[68:71], v7, s[24:27], s65 offen offset:0 sc1
    buffer_load_dwordx4 v[72:75], v7, s[24:27], s65 offen offset:1024 sc1
    buffer_load_dwordx4 v[76:79], v7, s[24:27], s65 offen offset:2048 sc1
    buffer_load_dwordx4 v[80:83], v7, s[24:27], s65 offen offset:3072 sc1
    buffer_load_dwordx4 v[84:87], v8, s[24:27], s65 offen offset:0 sc1
    s_add_u32 s65, s46, 4
    s_and_b32 s65, s65, 7
    s_mul_i32 s65, s65, 40960
    s_add_u32 s65, s65, s43
    buffer_load_dwordx4 v[96:99], v7, s[24:27], s65 offen offset:0 sc1
    buffer_load_dwordx4 v[100:103], v7, s[24:27], s65 offen offset:1024 sc1
    buffer_load_dwordx4 v[104:107], v7, s[24:27], s65 offen offset:2048 sc1
    buffer_load_dwordx4 v[108:111], v7, s[24:27], s65 offen offset:3072 sc1
    buffer_load_dwordx4 v[112:115], v8, s[24:27], s65 offen offset:0 sc1
    s_add_u32 s65, s46, 5
    s_and_b32 s65, s65, 7
    s_mul_i32 s65, s65, 40960
    s_add_u32 s65, s65, s43
    buffer_load_dwordx4 v[116:119], v7, s[24:27], s65 offen offset:0 sc1
    buffer_load_dwordx4 v[120:123], v7, s[24:27], s65 offen offset:1024 sc1
    buffer_load_dwordx4 v[124:127], v7, s[24:27], s65 offen offset:2048 sc1
    buffer_load_dwordx4 v[128:131], v7, s[24:27], s65 offen offset:3072 sc1
    buffer_load_dwordx4 v[132:135], v8, s[24:27], s65 offen offset:0 sc1
    s_waitcnt vmcnt(15)
    s_barrier
    v_mov_b32 v2, s30
    v_mov_b32 v3, s31
    v_mov_b32 v1, 0
    s_mov_b64 exec, 1
    buffer_store_dwordx2 v[2:3], v1, s[24:27], s44 offen sc1
    s_mov_b64 exec, -1
    s_nop 1
    s_lshr_b32 s44, s40, 1
    s_lshl_b32 s44, s44, 12
    s_lshl_b32 s56, s42, 5
    s_add_u32 s44, s44, s56
    s_add_u32 s44, s44, 25165824
    v_mov_b32 v4, 0
    buffer_load_dwordx2 v[2:3], v4, s[24:27], s44 offen offset:0 sc1
    s_add_u32 s65, s46, 6
    s_and_b32 s65, s65, 7
    s_mul_i32 s65, s65, 40960
    s_add_u32 s65, s65, s43
    buffer_load_dwordx4 v[208:211], v7, s[24:27], s65 offen offset:0 sc1
    buffer_load_dwordx4 v[212:215], v7, s[24:27], s65 offen offset:1024 sc1
    buffer_load_dwordx4 v[216:219], v7, s[24:27], s65 offen offset:2048 sc1
    buffer_load_dwordx4 v[220:223], v7, s[24:27], s65 offen offset:3072 sc1
    buffer_load_dwordx4 v[224:227], v8, s[24:27], s65 offen offset:0 sc1
    s_add_u32 s65, s46, 7
    s_and_b32 s65, s65, 7
    s_mul_i32 s65, s65, 40960
    s_add_u32 s65, s65, s43
    buffer_load_dwordx4 v[228:231], v7, s[24:27], s65 offen offset:0 sc1
    buffer_load_dwordx4 v[232:235], v7, s[24:27], s65 offen offset:1024 sc1
    buffer_load_dwordx4 v[236:239], v7, s[24:27], s65 offen offset:2048 sc1
    buffer_load_dwordx4 v[240:243], v7, s[24:27], s65 offen offset:3072 sc1
    buffer_load_dwordx4 v[244:247], v8, s[24:27], s65 offen offset:0 sc1
    s_lshl_b32 s61, s40, 7
    s_add_u32 s61, s61, s42
    s_xor_b32 s60, s61, 128
    s_mul_i32 s60, s60, 3072
    s_mul_i32 s61, s61, 3072
    s_lshl_b32 s62, s2, 4
    s_add_u32 s62, s62, s48
    s_lshl_b32 s62, s62, 10
    s_add_u32 s62, s62, 27262976
    s_lshl_b32 s63, s2, 3
    s_add_u32 s63, s63, s48
    s_lshl_b32 s63, s63, 6
    s_add_u32 s63, s63, 32505856
    s_waitcnt vmcnt(10)
    s_mov_b32 s57, 0
K1_F0_CMP:
    v_cmp_ne_u64 vcc, s[30:31], v[2:3]
    s_add_u32 s57, s57, 1
    s_nop 3
    s_cbranch_vccz K1_F0_OK
    s_cmp_ge_u32 s57, 0x40000
    s_cbranch_scc1 K1_F0_OK
    s_sleep 4
    buffer_load_dwordx2 v[2:3], v4, s[24:27], s44 offen offset:0 sc1
    s_waitcnt vmcnt(0)
    s_branch K1_F0_CMP
K1_F0_OK:
    s_lshl_b32 s56, s48, 14
    v_add_u32 v0, s56, v7
    s_add_u32 s66, s46, 0
    s_and_b32 s66, s66, 7
    s_mul_i32 s66, s66, 3072
    s_add_u32 s66, s66, s60
    buffer_load_dwordx4 v[88:91], v7, s[24:27], s66 offen offset:0 sc1
    buffer_load_dwordx4 v[92:95], v7, s[24:27], s66 offen offset:1024 sc1
    buffer_load_dwordx4 v[136:139], v7, s[24:27], s66 offen offset:2048 sc1
    s_add_u32 s66, s46, 1
    s_and_b32 s66, s66, 7
    s_mul_i32 s66, s66, 3072
    s_add_u32 s66, s66, s60
    buffer_load_dwordx4 v[140:143], v7, s[24:27], s66 offen offset:0 sc1
    buffer_load_dwordx4 v[144:147], v7, s[24:27], s66 offen offset:1024 sc1
    buffer_load_dwordx4 v[248:251], v7, s[24:27], s66 offen offset:2048 sc1
    s_add_u32 s66, s46, 2
    s_and_b32 s66, s66, 7
    s_mul_i32 s66, s66, 3072
    s_add_u32 s66, s66, s60
    buffer_load_dwordx4 v[252:255], v7, s[24:27], s66 offen offset:0 sc1
    s_waitcnt vmcnt(6)
    v_mfma_f32_16x16x32_bf16 v[8:11], v[148:151], v[88:91], 0
    v_mfma_f32_16x16x32_bf16 v[20:23], v[152:155], v[88:91], 0
    v_mfma_f32_16x16x32_bf16 v[32:35], v[156:159], v[88:91], 0
    v_mfma_f32_16x16x32_bf16 v[44:47], v[160:163], v[88:91], 0
    v_mfma_f32_16x16x32_bf16 v[56:59], v[164:167], v[88:91], 0
    buffer_load_dwordx4 v[88:91], v7, s[24:27], s66 offen offset:1024 sc1
    s_waitcnt vmcnt(6)
    v_mfma_f32_16x16x32_bf16 v[12:15], v[148:151], v[92:95], 0
    v_mfma_f32_16x16x32_bf16 v[24:27], v[152:155], v[92:95], 0
    v_mfma_f32_16x16x32_bf16 v[36:39], v[156:159], v[92:95], 0
    v_mfma_f32_16x16x32_bf16 v[48:51], v[160:163], v[92:95], 0
    v_mfma_f32_16x16x32_bf16 v[60:63], v[164:167], v[92:95], 0
    buffer_load_dwordx4 v[92:95], v7, s[24:27], s66 offen offset:2048 sc1
    s_waitcnt vmcnt(6)
    v_mfma_f32_16x16x32_bf16 v[16:19], v[148:151], v[136:139], 0
    v_mfma_f32_16x16x32_bf16 v[28:31], v[152:155], v[136:139], 0
    v_mfma_f32_16x16x32_bf16 v[40:43], v[156:159], v[136:139], 0
    v_mfma_f32_16x16x32_bf16 v[52:55], v[160:163], v[136:139], 0
    v_mfma_f32_16x16x32_bf16 v[64:67], v[164:167], v[136:139], 0
    s_add_u32 s66, s46, 3
    s_and_b32 s66, s66, 7
    s_mul_i32 s66, s66, 3072
    s_add_u32 s66, s66, s60
    buffer_load_dwordx4 v[136:139], v7, s[24:27], s66 offen offset:0 sc1
    s_waitcnt vmcnt(6)
    v_mfma_f32_16x16x32_bf16 v[8:11], v[168:171], v[140:143], v[8:11]
    v_mfma_f32_16x16x32_bf16 v[20:23], v[172:175], v[140:143], v[20:23]
    v_mfma_f32_16x16x32_bf16 v[32:35], v[176:179], v[140:143], v[32:35]
    v_mfma_f32_16x16x32_bf16 v[44:47], v[180:183], v[140:143], v[44:47]
    v_mfma_f32_16x16x32_bf16 v[56:59], v[184:187], v[140:143], v[56:59]
    buffer_load_dwordx4 v[140:143], v7, s[24:27], s66 offen offset:1024 sc1
    s_waitcnt vmcnt(6)
    v_mfma_f32_16x16x32_bf16 v[12:15], v[168:171], v[144:147], v[12:15]
    v_mfma_f32_16x16x32_bf16 v[24:27], v[172:175], v[144:147], v[24:27]
    v_mfma_f32_16x16x32_bf16 v[36:39], v[176:179], v[144:147], v[36:39]
    v_mfma_f32_16x16x32_bf16 v[48:51], v[180:183], v[144:147], v[48:51]
    v_mfma_f32_16x16x32_bf16 v[60:63], v[184:187], v[144:147], v[60:63]
    buffer_load_dwordx4 v[144:147], v7, s[24:27], s66 offen offset:2048 sc1
    s_waitcnt vmcnt(6)
    v_mfma_f32_16x16x32_bf16 v[16:19], v[168:171], v[248:251], v[16:19]
    v_mfma_f32_16x16x32_bf16 v[28:31], v[172:175], v[248:251], v[28:31]
    v_mfma_f32_16x16x32_bf16 v[40:43], v[176:179], v[248:251], v[40:43]
    v_mfma_f32_16x16x32_bf16 v[52:55], v[180:183], v[248:251], v[52:55]
    v_mfma_f32_16x16x32_bf16 v[64:67], v[184:187], v[248:251], v[64:67]
    s_add_u32 s66, s46, 4
    s_and_b32 s66, s66, 7
    s_mul_i32 s66, s66, 3072
    s_add_u32 s66, s66, s60
    buffer_load_dwordx4 v[248:251], v7, s[24:27], s66 offen offset:0 sc1
    s_waitcnt vmcnt(6)
    v_mfma_f32_16x16x32_bf16 v[8:11], v[188:191], v[252:255], v[8:11]
    v_mfma_f32_16x16x32_bf16 v[20:23], v[192:195], v[252:255], v[20:23]
    v_mfma_f32_16x16x32_bf16 v[32:35], v[196:199], v[252:255], v[32:35]
    v_mfma_f32_16x16x32_bf16 v[44:47], v[200:203], v[252:255], v[44:47]
    v_mfma_f32_16x16x32_bf16 v[56:59], v[204:207], v[252:255], v[56:59]
    buffer_load_dwordx4 v[252:255], v7, s[24:27], s66 offen offset:1024 sc1
    s_waitcnt vmcnt(6)
    v_mfma_f32_16x16x32_bf16 v[12:15], v[188:191], v[88:91], v[12:15]
    v_mfma_f32_16x16x32_bf16 v[24:27], v[192:195], v[88:91], v[24:27]
    v_mfma_f32_16x16x32_bf16 v[36:39], v[196:199], v[88:91], v[36:39]
    v_mfma_f32_16x16x32_bf16 v[48:51], v[200:203], v[88:91], v[48:51]
    v_mfma_f32_16x16x32_bf16 v[60:63], v[204:207], v[88:91], v[60:63]
    buffer_load_dwordx4 v[88:91], v7, s[24:27], s66 offen offset:2048 sc1
    s_waitcnt vmcnt(6)
    v_mfma_f32_16x16x32_bf16 v[16:19], v[188:191], v[92:95], v[16:19]
    v_mfma_f32_16x16x32_bf16 v[28:31], v[192:195], v[92:95], v[28:31]
    v_mfma_f32_16x16x32_bf16 v[40:43], v[196:199], v[92:95], v[40:43]
    v_mfma_f32_16x16x32_bf16 v[52:55], v[200:203], v[92:95], v[52:55]
    v_mfma_f32_16x16x32_bf16 v[64:67], v[204:207], v[92:95], v[64:67]
    s_add_u32 s66, s46, 5
    s_and_b32 s66, s66, 7
    s_mul_i32 s66, s66, 3072
    s_add_u32 s66, s66, s60
    buffer_load_dwordx4 v[92:95], v7, s[24:27], s66 offen offset:0 sc1
    s_waitcnt vmcnt(6)
    v_mfma_f32_16x16x32_bf16 v[8:11], v[68:71], v[136:139], v[8:11]
    v_mfma_f32_16x16x32_bf16 v[20:23], v[72:75], v[136:139], v[20:23]
    v_mfma_f32_16x16x32_bf16 v[32:35], v[76:79], v[136:139], v[32:35]
    v_mfma_f32_16x16x32_bf16 v[44:47], v[80:83], v[136:139], v[44:47]
    v_mfma_f32_16x16x32_bf16 v[56:59], v[84:87], v[136:139], v[56:59]
    buffer_load_dwordx4 v[136:139], v7, s[24:27], s66 offen offset:1024 sc1
    s_waitcnt vmcnt(6)
    v_mfma_f32_16x16x32_bf16 v[12:15], v[68:71], v[140:143], v[12:15]
    v_mfma_f32_16x16x32_bf16 v[24:27], v[72:75], v[140:143], v[24:27]
    v_mfma_f32_16x16x32_bf16 v[36:39], v[76:79], v[140:143], v[36:39]
    v_mfma_f32_16x16x32_bf16 v[48:51], v[80:83], v[140:143], v[48:51]
    v_mfma_f32_16x16x32_bf16 v[60:63], v[84:87], v[140:143], v[60:63]
    buffer_load_dwordx4 v[140:143], v7, s[24:27], s66 offen offset:2048 sc1
    s_waitcnt vmcnt(6)
    v_mfma_f32_16x16x32_bf16 v[16:19], v[68:71], v[144:147], v[16:19]
    v_mfma_f32_16x16x32_bf16 v[28:31], v[72:75], v[144:147], v[28:31]
    v_mfma_f32_16x16x32_bf16 v[40:43], v[76:79], v[144:147], v[40:43]
    v_mfma_f32_16x16x32_bf16 v[52:55], v[80:83], v[144:147], v[52:55]
    v_mfma_f32_16x16x32_bf16 v[64:67], v[84:87], v[144:147], v[64:67]
    s_add_u32 s66, s46, 6
    s_and_b32 s66, s66, 7
    s_mul_i32 s66, s66, 3072
    s_add_u32 s66, s66, s60
    buffer_load_dwordx4 v[144:147], v7, s[24:27], s66 offen offset:0 sc1
    s_waitcnt vmcnt(6)
    v_mfma_f32_16x16x32_bf16 v[8:11], v[96:99], v[248:251], v[8:11]
    v_mfma_f32_16x16x32_bf16 v[20:23], v[100:103], v[248:251], v[20:23]
    v_mfma_f32_16x16x32_bf16 v[32:35], v[104:107], v[248:251], v[32:35]
    v_mfma_f32_16x16x32_bf16 v[44:47], v[108:111], v[248:251], v[44:47]
    v_mfma_f32_16x16x32_bf16 v[56:59], v[112:115], v[248:251], v[56:59]
    buffer_load_dwordx4 v[248:251], v7, s[24:27], s66 offen offset:1024 sc1
    s_waitcnt vmcnt(6)
    v_mfma_f32_16x16x32_bf16 v[12:15], v[96:99], v[252:255], v[12:15]
    v_mfma_f32_16x16x32_bf16 v[24:27], v[100:103], v[252:255], v[24:27]
    v_mfma_f32_16x16x32_bf16 v[36:39], v[104:107], v[252:255], v[36:39]
    v_mfma_f32_16x16x32_bf16 v[48:51], v[108:111], v[252:255], v[48:51]
    v_mfma_f32_16x16x32_bf16 v[60:63], v[112:115], v[252:255], v[60:63]
    buffer_load_dwordx4 v[252:255], v7, s[24:27], s66 offen offset:2048 sc1
    s_waitcnt vmcnt(6)
    v_mfma_f32_16x16x32_bf16 v[16:19], v[96:99], v[88:91], v[16:19]
    v_mfma_f32_16x16x32_bf16 v[28:31], v[100:103], v[88:91], v[28:31]
    v_mfma_f32_16x16x32_bf16 v[40:43], v[104:107], v[88:91], v[40:43]
    v_mfma_f32_16x16x32_bf16 v[52:55], v[108:111], v[88:91], v[52:55]
    v_mfma_f32_16x16x32_bf16 v[64:67], v[112:115], v[88:91], v[64:67]
    s_add_u32 s66, s46, 7
    s_and_b32 s66, s66, 7
    s_mul_i32 s66, s66, 3072
    s_add_u32 s66, s66, s60
    buffer_load_dwordx4 v[88:91], v7, s[24:27], s66 offen offset:0 sc1
    s_waitcnt vmcnt(6)
    v_mfma_f32_16x16x32_bf16 v[8:11], v[116:119], v[92:95], v[8:11]
    v_mfma_f32_16x16x32_bf16 v[20:23], v[120:123], v[92:95], v[20:23]
    v_mfma_f32_16x16x32_bf16 v[32:35], v[124:127], v[92:95], v[32:35]
    v_mfma_f32_16x16x32_bf16 v[44:47], v[128:131], v[92:95], v[44:47]
    v_mfma_f32_16x16x32_bf16 v[56:59], v[132:135], v[92:95], v[56:59]
    buffer_load_dwordx4 v[92:95], v7, s[24:27], s66 offen offset:1024 sc1
    s_waitcnt vmcnt(6)
    v_mfma_f32_16x16x32_bf16 v[12:15], v[116:119], v[136:139], v[12:15]
    v_mfma_f32_16x16x32_bf16 v[24:27], v[120:123], v[136:139], v[24:27]
    v_mfma_f32_16x16x32_bf16 v[36:39], v[124:127], v[136:139], v[36:39]
    v_mfma_f32_16x16x32_bf16 v[48:51], v[128:131], v[136:139], v[48:51]
    v_mfma_f32_16x16x32_bf16 v[60:63], v[132:135], v[136:139], v[60:63]
    buffer_load_dwordx4 v[136:139], v7, s[24:27], s66 offen offset:2048 sc1
    s_waitcnt vmcnt(6)
    v_mfma_f32_16x16x32_bf16 v[16:19], v[116:119], v[140:143], v[16:19]
    v_mfma_f32_16x16x32_bf16 v[28:31], v[120:123], v[140:143], v[28:31]
    v_mfma_f32_16x16x32_bf16 v[40:43], v[124:127], v[140:143], v[40:43]
    v_mfma_f32_16x16x32_bf16 v[52:55], v[128:131], v[140:143], v[52:55]
    v_mfma_f32_16x16x32_bf16 v[64:67], v[132:135], v[140:143], v[64:67]
    s_add_u32 s66, s46, 0
    s_and_b32 s66, s66, 7
    s_mul_i32 s66, s66, 3072
    s_add_u32 s66, s66, s61
    buffer_load_dwordx4 v[140:143], v7, s[24:27], s66 offen offset:0 sc1
    s_waitcnt vmcnt(6)
    v_mfma_f32_16x16x32_bf16 v[8:11], v[208:211], v[144:147], v[8:11]
    v_mfma_f32_16x16x32_bf16 v[20:23], v[212:215], v[144:147], v[20:23]
    v_mfma_f32_16x16x32_bf16 v[32:35], v[216:219], v[144:147], v[32:35]
    v_mfma_f32_16x16x32_bf16 v[44:47], v[220:223], v[144:147], v[44:47]
    v_mfma_f32_16x16x32_bf16 v[56:59], v[224:227], v[144:147], v[56:59]
    buffer_load_dwordx4 v[144:147], v7, s[24:27], s66 offen offset:1024 sc1
    s_waitcnt vmcnt(6)
    v_mfma_f32_16x16x32_bf16 v[12:15], v[208:211], v[248:251], v[12:15]
    v_mfma_f32_16x16x32_bf16 v[24:27], v[212:215], v[248:251], v[24:27]
    v_mfma_f32_16x16x32_bf16 v[36:39], v[216:219], v[248:251], v[36:39]
    v_mfma_f32_16x16x32_bf16 v[48:51], v[220:223], v[248:251], v[48:51]
    v_mfma_f32_16x16x32_bf16 v[60:63], v[224:227], v[248:251], v[60:63]
    buffer_load_dwordx4 v[248:251], v7, s[24:27], s66 offen offset:2048 sc1
    s_waitcnt vmcnt(6)
    v_mfma_f32_16x16x32_bf16 v[16:19], v[208:211], v[252:255], v[16:19]
    v_mfma_f32_16x16x32_bf16 v[28:31], v[212:215], v[252:255], v[28:31]
    v_mfma_f32_16x16x32_bf16 v[40:43], v[216:219], v[252:255], v[40:43]
    v_mfma_f32_16x16x32_bf16 v[52:55], v[220:223], v[252:255], v[52:55]
    v_mfma_f32_16x16x32_bf16 v[64:67], v[224:227], v[252:255], v[64:67]
    s_add_u32 s66, s46, 1
    s_and_b32 s66, s66, 7
    s_mul_i32 s66, s66, 3072
    s_add_u32 s66, s66, s61
    buffer_load_dwordx4 v[252:255], v7, s[24:27], s66 offen offset:0 sc1
    s_waitcnt vmcnt(6)
    v_mfma_f32_16x16x32_bf16 v[8:11], v[228:231], v[88:91], v[8:11]
    v_mfma_f32_16x16x32_bf16 v[20:23], v[232:235], v[88:91], v[20:23]
    v_mfma_f32_16x16x32_bf16 v[32:35], v[236:239], v[88:91], v[32:35]
    v_mfma_f32_16x16x32_bf16 v[44:47], v[240:243], v[88:91], v[44:47]
    v_mfma_f32_16x16x32_bf16 v[56:59], v[244:247], v[88:91], v[56:59]
    buffer_load_dwordx4 v[88:91], v7, s[24:27], s66 offen offset:1024 sc1
    s_waitcnt vmcnt(6)
    v_mfma_f32_16x16x32_bf16 v[12:15], v[228:231], v[92:95], v[12:15]
    v_mfma_f32_16x16x32_bf16 v[24:27], v[232:235], v[92:95], v[24:27]
    v_mfma_f32_16x16x32_bf16 v[36:39], v[236:239], v[92:95], v[36:39]
    v_mfma_f32_16x16x32_bf16 v[48:51], v[240:243], v[92:95], v[48:51]
    v_mfma_f32_16x16x32_bf16 v[60:63], v[244:247], v[92:95], v[60:63]
    buffer_load_dwordx4 v[92:95], v7, s[24:27], s66 offen offset:2048 sc1
    s_waitcnt vmcnt(6)
    v_mfma_f32_16x16x32_bf16 v[16:19], v[228:231], v[136:139], v[16:19]
    v_mfma_f32_16x16x32_bf16 v[28:31], v[232:235], v[136:139], v[28:31]
    v_mfma_f32_16x16x32_bf16 v[40:43], v[236:239], v[136:139], v[40:43]
    v_mfma_f32_16x16x32_bf16 v[52:55], v[240:243], v[136:139], v[52:55]
    v_mfma_f32_16x16x32_bf16 v[64:67], v[244:247], v[136:139], v[64:67]
    s_add_u32 s66, s46, 2
    s_and_b32 s66, s66, 7
    s_mul_i32 s66, s66, 3072
    s_add_u32 s66, s66, s61
    buffer_load_dwordx4 v[136:139], v7, s[24:27], s66 offen offset:0 sc1
    ds_write_b128 v0, v[8:11] offset:0
    ds_write_b128 v0, v[12:15] offset:1024
    ds_write_b128 v0, v[16:19] offset:2048
    ds_write_b128 v0, v[20:23] offset:3072
    ds_write_b128 v0, v[24:27] offset:4096
    ds_write_b128 v0, v[28:31] offset:5120
    ds_write_b128 v0, v[32:35] offset:6144
    ds_write_b128 v0, v[36:39] offset:7168
    ds_write_b128 v0, v[40:43] offset:8192
    ds_write_b128 v0, v[44:47] offset:9216
    ds_write_b128 v0, v[48:51] offset:10240
    ds_write_b128 v0, v[52:55] offset:11264
    ds_write_b128 v0, v[56:59] offset:12288
    ds_write_b128 v0, v[60:63] offset:13312
    ds_write_b128 v0, v[64:67] offset:14336
    s_waitcnt vmcnt(6)
    v_mfma_f32_16x16x32_bf16 v[8:11], v[148:151], v[140:143], 0
    v_mfma_f32_16x16x32_bf16 v[20:23], v[152:155], v[140:143], 0
    v_mfma_f32_16x16x32_bf16 v[32:35], v[156:159], v[140:143], 0
    v_mfma_f32_16x16x32_bf16 v[44:47], v[160:163], v[140:143], 0
    v_mfma_f32_16x16x32_bf16 v[56:59], v[164:167], v[140:143], 0
    buffer_load_dwordx4 v[140:143], v7, s[24:27], s66 offen offset:1024 sc1
    s_waitcnt vmcnt(6)
    v_mfma_f32_16x16x32_bf16 v[12:15], v[148:151], v[144:147], 0
    v_mfma_f32_16x16x32_bf16 v[24:27], v[152:155], v[144:147], 0
    v_mfma_f32_16x16x32_bf16 v[36:39], v[156:159], v[144:147], 0
    v_mfma_f32_16x16x32_bf16 v[48:51], v[160:163], v[144:147], 0
    v_mfma_f32_16x16x32_bf16 v[60:63], v[164:167], v[144:147], 0
    buffer_load_dwordx4 v[144:147], v7, s[24:27], s66 offen offset:2048 sc1
    s_waitcnt vmcnt(6)
    v_mfma_f32_16x16x32_bf16 v[16:19], v[148:151], v[248:251], 0
    v_mfma_f32_16x16x32_bf16 v[28:31], v[152:155], v[248:251], 0
    v_mfma_f32_16x16x32_bf16 v[40:43], v[156:159], v[248:251], 0
    v_mfma_f32_16x16x32_bf16 v[52:55], v[160:163], v[248:251], 0
    v_mfma_f32_16x16x32_bf16 v[64:67], v[164:167], v[248:251], 0
    s_add_u32 s66, s46, 3
    s_and_b32 s66, s66, 7
    s_mul_i32 s66, s66, 3072
    s_add_u32 s66, s66, s61
    buffer_load_dwordx4 v[248:251], v7, s[24:27], s66 offen offset:0 sc1
    s_waitcnt vmcnt(6)
    v_mfma_f32_16x16x32_bf16 v[8:11], v[168:171], v[252:255], v[8:11]
    v_mfma_f32_16x16x32_bf16 v[20:23], v[172:175], v[252:255], v[20:23]
    v_mfma_f32_16x16x32_bf16 v[32:35], v[176:179], v[252:255], v[32:35]
    v_mfma_f32_16x16x32_bf16 v[44:47], v[180:183], v[252:255], v[44:47]
    v_mfma_f32_16x16x32_bf16 v[56:59], v[184:187], v[252:255], v[56:59]
    buffer_load_dwordx4 v[252:255], v7, s[24:27], s66 offen offset:1024 sc1
    s_waitcnt vmcnt(6)
    v_mfma_f32_16x16x32_bf16 v[12:15], v[168:171], v[88:91], v[12:15]
    v_mfma_f32_16x16x32_bf16 v[24:27], v[172:175], v[88:91], v[24:27]
    v_mfma_f32_16x16x32_bf16 v[36:39], v[176:179], v[88:91], v[36:39]
    v_mfma_f32_16x16x32_bf16 v[48:51], v[180:183], v[88:91], v[48:51]
    v_mfma_f32_16x16x32_bf16 v[60:63], v[184:187], v[88:91], v[60:63]
    buffer_load_dwordx4 v[88:91], v7, s[24:27], s66 offen offset:2048 sc1
    s_waitcnt vmcnt(6)
    v_mfma_f32_16x16x32_bf16 v[16:19], v[168:171], v[92:95], v[16:19]
    v_mfma_f32_16x16x32_bf16 v[28:31], v[172:175], v[92:95], v[28:31]
    v_mfma_f32_16x16x32_bf16 v[40:43], v[176:179], v[92:95], v[40:43]
    v_mfma_f32_16x16x32_bf16 v[52:55], v[180:183], v[92:95], v[52:55]
    v_mfma_f32_16x16x32_bf16 v[64:67], v[184:187], v[92:95], v[64:67]
    s_add_u32 s66, s46, 4
    s_and_b32 s66, s66, 7
    s_mul_i32 s66, s66, 3072
    s_add_u32 s66, s66, s61
    buffer_load_dwordx4 v[92:95], v7, s[24:27], s66 offen offset:0 sc1
    s_waitcnt lgkmcnt(0)
    s_barrier
    s_lshl_b32 s56, s48, 10
    s_add_u32 s56, s56, 0
    v_add_u32 v1, s56, v7
    v_add_u32 v2, 65536, v1
    ds_read_b128 v[148:151], v1 offset:0
    ds_read_b128 v[152:155], v1 offset:16384
    ds_read_b128 v[156:159], v1 offset:32768
    ds_read_b128 v[160:163], v1 offset:49152
    ds_read_b128 v[164:167], v2 offset:0
    ds_read_b128 v[168:171], v2 offset:16384
    ds_read_b128 v[172:175], v2 offset:32768
    ds_read_b128 v[176:179], v2 offset:49152
    s_waitcnt lgkmcnt(0)
    v_add_f32 v148, v148, v164
    v_add_f32 v149, v149, v165
    v_add_f32 v150, v150, v166
    v_add_f32 v151, v151, v167
    v_add_f32 v152, v152, v168
    v_add_f32 v153, v153, v169
    v_add_f32 v154, v154, v170
    v_add_f32 v155, v155, v171
    v_add_f32 v156, v156, v172
    v_add_f32 v157, v157, v173
    v_add_f32 v158, v158, v174
    v_add_f32 v159, v159, v175
    v_add_f32 v160, v160, v176
    v_add_f32 v161, v161, v177
    v_add_f32 v162, v162, v178
    v_add_f32 v163, v163, v179
    v_add_f32 v148, v148, v156
    v_add_f32 v149, v149, v157
    v_add_f32 v150, v150, v158
    v_add_f32 v151, v151, v159
    v_add_f32 v152, v152, v160
    v_add_f32 v153, v153, v161
    v_add_f32 v154, v154, v162
    v_add_f32 v155, v155, v163
    v_add_f32 v148, v148, v152
    v_add_f32 v149, v149, v153
    v_add_f32 v150, v150, v154
    v_add_f32 v151, v151, v155
    v_mov_b32 v180, v148
    v_mov_b32 v181, v149
    v_mov_b32 v182, v150
    v_mov_b32 v183, v151
    buffer_store_dwordx4 v[180:183], v7, s[24:27], s62 offen sc1
    s_lshl_b32 s56, s48, 10
    s_add_u32 s56, s56, 8192
    v_add_u32 v1, s56, v7
    v_add_u32 v2, 65536, v1
    ds_read_b128 v[148:151], v1 offset:0
    ds_read_b128 v[152:155], v1 offset:16384
    ds_read_b128 v[156:159], v1 offset:32768
    ds_read_b128 v[160:163], v1 offset:49152
    ds_read_b128 v[164:167], v2 offset:0
    ds_read_b128 v[168:171], v2 offset:16384
    ds_read_b128 v[172:175], v2 offset:32768
    ds_read_b128 v[176:179], v2 offset:49152
    s_waitcnt lgkmcnt(0)
    v_add_f32 v148, v148, v164
    v_add_f32 v149, v149, v165
    v_add_f32 v150, v150, v166
    v_add_f32 v151, v151, v167
    v_add_f32 v152, v152, v168
    v_add_f32 v153, v153, v169
    v_add_f32 v154, v154, v170
    v_add_f32 v155, v155, v171
    v_add_f32 v156, v156, v172
    v_add_f32 v157, v157, v173
    v_add_f32 v158, v158, v174
    v_add_f32 v159, v159, v175
    v_add_f32 v160, v160, v176
    v_add_f32 v161, v161, v177
    v_add_f32 v162, v162, v178
    v_add_f32 v163, v163, v179
    v_add_f32 v148, v148, v156
    v_add_f32 v149, v149, v157
    v_add_f32 v150, v150, v158
    v_add_f32 v151, v151, v159
    v_add_f32 v152, v152, v160
    v_add_f32 v153, v153, v161
    v_add_f32 v154, v154, v162
    v_add_f32 v155, v155, v163
    v_add_f32 v148, v148, v152
    v_add_f32 v149, v149, v153
    v_add_f32 v150, v150, v154
    v_add_f32 v151, v151, v155
    v_mov_b32 v184, v148
    v_mov_b32 v185, v149
    v_mov_b32 v186, v150
    v_mov_b32 v187, v151
    s_add_u32 s58, s62, 8192
    buffer_store_dwordx4 v[184:187], v7, s[24:27], s58 offen sc1
    s_waitcnt vmcnt(8)
    v_mfma_f32_16x16x32_bf16 v[8:11], v[188:191], v[136:139], v[8:11]
    v_mfma_f32_16x16x32_bf16 v[20:23], v[192:195], v[136:139], v[20:23]
    v_mfma_f32_16x16x32_bf16 v[32:35], v[196:199], v[136:139], v[32:35]
    v_mfma_f32_16x16x32_bf16 v[44:47], v[200:203], v[136:139], v[44:47]
    v_mfma_f32_16x16x32_bf16 v[56:59], v[204:207], v[136:139], v[56:59]
    buffer_load_dwordx4 v[136:139], v7, s[24:27], s66 offen offset:1024 sc1
    s_waitcnt vmcnt(8)
    v_mfma_f32_16x16x32_bf16 v[12:15], v[188:191], v[140:143], v[12:15]
    v_mfma_f32_16x16x32_bf16 v[24:27], v[192:195], v[140:143], v[24:27]
    v_mfma_f32_16x16x32_bf16 v[36:39], v[196:199], v[140:143], v[36:39]
    v_mfma_f32_16x16x32_bf16 v[48:51], v[200:203], v[140:143], v[48:51]
    v_mfma_f32_16x16x32_bf16 v[60:63], v[204:207], v[140:143], v[60:63]
    buffer_load_dwordx4 v[140:143], v7, s[24:27], s66 offen offset:2048 sc1
    s_waitcnt vmcnt(8)
    v_mfma_f32_16x16x32_bf16 v[16:19], v[188:191], v[144:147], v[16:19]
    v_mfma_f32_16x16x32_bf16 v[28:31], v[192:195], v[144:147], v[28:31]
    v_mfma_f32_16x16x32_bf16 v[40:43], v[196:199], v[144:147], v[40:43]
    v_mfma_f32_16x16x32_bf16 v[52:55], v[200:203], v[144:147], v[52:55]
    v_mfma_f32_16x16x32_bf16 v[64:67], v[204:207], v[144:147], v[64:67]
    s_add_u32 s66, s46, 5
    s_and_b32 s66, s66, 7
    s_mul_i32 s66, s66, 3072
    s_add_u32 s66, s66, s61
    buffer_load_dwordx4 v[144:147], v7, s[24:27], s66 offen offset:0 sc1
    s_waitcnt vmcnt(8)
    v_mfma_f32_16x16x32_bf16 v[8:11], v[68:71], v[248:251], v[8:11]
    v_mfma_f32_16x16x32_bf16 v[20:23], v[72:75], v[248:251], v[20:23]
    v_mfma_f32_16x16x32_bf16 v[32:35], v[76:79], v[248:251], v[32:35]
    v_mfma_f32_16x16x32_bf16 v[44:47], v[80:83], v[248:251], v[44:47]
    v_mfma_f32_16x16x32_bf16 v[56:59], v[84:87], v[248:251], v[56:59]
    buffer_load_dwordx4 v[248:251], v7, s[24:27], s66 offen offset:1024 sc1
    s_waitcnt vmcnt(8)
    v_mfma_f32_16x16x32_bf16 v[12:15], v[68:71], v[252:255], v[12:15]
    v_mfma_f32_16x16x32_bf16 v[24:27], v[72:75], v[252:255], v[24:27]
    v_mfma_f32_16x16x32_bf16 v[36:39], v[76:79], v[252:255], v[36:39]
    v_mfma_f32_16x16x32_bf16 v[48:51], v[80:83], v[252:255], v[48:51]
    v_mfma_f32_16x16x32_bf16 v[60:63], v[84:87], v[252:255], v[60:63]
    buffer_load_dwordx4 v[252:255], v7, s[24:27], s66 offen offset:2048 sc1
    s_waitcnt vmcnt(8)
    v_mfma_f32_16x16x32_bf16 v[16:19], v[68:71], v[88:91], v[16:19]
    v_mfma_f32_16x16x32_bf16 v[28:31], v[72:75], v[88:91], v[28:31]
    v_mfma_f32_16x16x32_bf16 v[40:43], v[76:79], v[88:91], v[40:43]
    v_mfma_f32_16x16x32_bf16 v[52:55], v[80:83], v[88:91], v[52:55]
    v_mfma_f32_16x16x32_bf16 v[64:67], v[84:87], v[88:91], v[64:67]
    s_add_u32 s66, s46, 6
    s_and_b32 s66, s66, 7
    s_mul_i32 s66, s66, 3072
    s_add_u32 s66, s66, s61
    buffer_load_dwordx4 v[88:91], v7, s[24:27], s66 offen offset:0 sc1
    s_waitcnt vmcnt(8)
    v_mfma_f32_16x16x32_bf16 v[8:11], v[96:99], v[92:95], v[8:11]
    v_mfma_f32_16x16x32_bf16 v[20:23], v[100:103], v[92:95], v[20:23]
    v_mfma_f32_16x16x32_bf16 v[32:35], v[104:107], v[92:95], v[32:35]
    v_mfma_f32_16x16x32_bf16 v[44:47], v[108:111], v[92:95], v[44:47]
    v_mfma_f32_16x16x32_bf16 v[56:59], v[112:115], v[92:95], v[56:59]
    buffer_load_dwordx4 v[92:95], v7, s[24:27], s66 offen offset:1024 sc1
    s_waitcnt vmcnt(6)
    v_mfma_f32_16x16x32_bf16 v[12:15], v[96:99], v[136:139], v[12:15]
    v_mfma_f32_16x16x32_bf16 v[24:27], v[100:103], v[136:139], v[24:27]
    v_mfma_f32_16x16x32_bf16 v[36:39], v[104:107], v[136:139], v[36:39]
    v_mfma_f32_16x16x32_bf16 v[48:51], v[108:111], v[136:139], v[48:51]
    v_mfma_f32_16x16x32_bf16 v[60:63], v[112:115], v[136:139], v[60:63]
    buffer_load_dwordx4 v[136:139], v7, s[24:27], s66 offen offset:2048 sc1
    s_waitcnt vmcnt(6)
    v_mfma_f32_16x16x32_bf16 v[16:19], v[96:99], v[140:143], v[16:19]
    v_mfma_f32_16x16x32_bf16 v[28:31], v[100:103], v[140:143], v[28:31]
    v_mfma_f32_16x16x32_bf16 v[40:43], v[104:107], v[140:143], v[40:43]
    v_mfma_f32_16x16x32_bf16 v[52:55], v[108:111], v[140:143], v[52:55]
    v_mfma_f32_16x16x32_bf16 v[64:67], v[112:115], v[140:143], v[64:67]
    s_add_u32 s66, s46, 7
    s_and_b32 s66, s66, 7
    s_mul_i32 s66, s66, 3072
    s_add_u32 s66, s66, s61
    buffer_load_dwordx4 v[140:143], v7, s[24:27], s66 offen offset:0 sc1
    v_mov_b32 v2, s30
    v_mov_b32 v3, s31
    v_mov_b32 v1, 0
    s_mov_b64 exec, 1
    buffer_store_dwordx2 v[2:3], v1, s[24:27], s63 offen sc1
    s_mov_b64 exec, -1
    s_nop 1
    s_barrier
    s_waitcnt vmcnt(7)
    v_mfma_f32_16x16x32_bf16 v[8:11], v[116:119], v[144:147], v[8:11]
    v_mfma_f32_16x16x32_bf16 v[20:23], v[120:123], v[144:147], v[20:23]
    v_mfma_f32_16x16x32_bf16 v[32:35], v[124:127], v[144:147], v[32:35]
    v_mfma_f32_16x16x32_bf16 v[44:47], v[128:131], v[144:147], v[44:47]
    v_mfma_f32_16x16x32_bf16 v[56:59], v[132:135], v[144:147], v[56:59]
    buffer_load_dwordx4 v[144:147], v7, s[24:27], s66 offen offset:1024 sc1
    s_waitcnt vmcnt(7)
    v_mfma_f32_16x16x32_bf16 v[12:15], v[116:119], v[248:251], v[12:15]
    v_mfma_f32_16x16x32_bf16 v[24:27], v[120:123], v[248:251], v[24:27]
    v_mfma_f32_16x16x32_bf16 v[36:39], v[124:127], v[248:251], v[36:39]
    v_mfma_f32_16x16x32_bf16 v[48:51], v[128:131], v[248:251], v[48:51]
    v_mfma_f32_16x16x32_bf16 v[60:63], v[132:135], v[248:251], v[60:63]
    buffer_load_dwordx4 v[248:251], v7, s[24:27], s66 offen offset:2048 sc1
    s_waitcnt vmcnt(7)
    v_mfma_f32_16x16x32_bf16 v[16:19], v[116:119], v[252:255], v[16:19]
    v_mfma_f32_16x16x32_bf16 v[28:31], v[120:123], v[252:255], v[28:31]
    v_mfma_f32_16x16x32_bf16 v[40:43], v[124:127], v[252:255], v[40:43]
    v_mfma_f32_16x16x32_bf16 v[52:55], v[128:131], v[252:255], v[52:55]
    v_mfma_f32_16x16x32_bf16 v[64:67], v[132:135], v[252:255], v[64:67]
    s_waitcnt vmcnt(6)
    v_mfma_f32_16x16x32_bf16 v[8:11], v[208:211], v[88:91], v[8:11]
    v_mfma_f32_16x16x32_bf16 v[20:23], v[212:215], v[88:91], v[20:23]
    v_mfma_f32_16x16x32_bf16 v[32:35], v[216:219], v[88:91], v[32:35]
    v_mfma_f32_16x16x32_bf16 v[44:47], v[220:223], v[88:91], v[44:47]
    v_mfma_f32_16x16x32_bf16 v[56:59], v[224:227], v[88:91], v[56:59]
    s_waitcnt vmcnt(5)
    v_mfma_f32_16x16x32_bf16 v[12:15], v[208:211], v[92:95], v[12:15]
    v_mfma_f32_16x16x32_bf16 v[24:27], v[212:215], v[92:95], v[24:27]
    v_mfma_f32_16x16x32_bf16 v[36:39], v[216:219], v[92:95], v[36:39]
    v_mfma_f32_16x16x32_bf16 v[48:51], v[220:223], v[92:95], v[48:51]
    v_mfma_f32_16x16x32_bf16 v[60:63], v[224:227], v[92:95], v[60:63]
    s_waitcnt vmcnt(4)
    v_mfma_f32_16x16x32_bf16 v[16:19], v[208:211], v[136:139], v[16:19]
    v_mfma_f32_16x16x32_bf16 v[28:31], v[212:215], v[136:139], v[28:31]
    v_mfma_f32_16x16x32_bf16 v[40:43], v[216:219], v[136:139], v[40:43]
    v_mfma_f32_16x16x32_bf16 v[52:55], v[220:223], v[136:139], v[52:55]
    v_mfma_f32_16x16x32_bf16 v[64:67], v[224:227], v[136:139], v[64:67]
    s_waitcnt vmcnt(3)
    v_mfma_f32_16x16x32_bf16 v[8:11], v[228:231], v[140:143], v[8:11]
    v_mfma_f32_16x16x32_bf16 v[20:23], v[232:235], v[140:143], v[20:23]
    v_mfma_f32_16x16x32_bf16 v[32:35], v[236:239], v[140:143], v[32:35]
    v_mfma_f32_16x16x32_bf16 v[44:47], v[240:243], v[140:143], v[44:47]
    v_mfma_f32_16x16x32_bf16 v[56:59], v[244:247], v[140:143], v[56:59]
    s_waitcnt vmcnt(1)
    v_mfma_f32_16x16x32_bf16 v[12:15], v[228:231], v[144:147], v[12:15]
    v_mfma_f32_16x16x32_bf16 v[24:27], v[232:235], v[144:147], v[24:27]
    v_mfma_f32_16x16x32_bf16 v[36:39], v[236:239], v[144:147], v[36:39]
    v_mfma_f32_16x16x32_bf16 v[48:51], v[240:243], v[144:147], v[48:51]
    v_mfma_f32_16x16x32_bf16 v[60:63], v[244:247], v[144:147], v[60:63]
    s_waitcnt vmcnt(0)
    v_mfma_f32_16x16x32_bf16 v[16:19], v[228:231], v[248:251], v[16:19]
    v_mfma_f32_16x16x32_bf16 v[28:31], v[232:235], v[248:251], v[28:31]
    v_mfma_f32_16x16x32_bf16 v[40:43], v[236:239], v[248:251], v[40:43]
    v_mfma_f32_16x16x32_bf16 v[52:55], v[240:243], v[248:251], v[52:55]
    v_mfma_f32_16x16x32_bf16 v[64:67], v[244:247], v[248:251], v[64:67]
    s_xor_b32 s63, s63, 512
    s_xor_b32 s62, s62, 16384
    v_mov_b32 v4, 0
    buffer_load_dwordx2 v[2:3], v4, s[24:27], s63 offen offset:0 sc1
    ds_write_b128 v0, v[8:11] offset:0
    ds_write_b128 v0, v[12:15] offset:1024
    ds_write_b128 v0, v[16:19] offset:2048
    ds_write_b128 v0, v[20:23] offset:3072
    ds_write_b128 v0, v[24:27] offset:4096
    ds_write_b128 v0, v[28:31] offset:5120
    ds_write_b128 v0, v[32:35] offset:6144
    ds_write_b128 v0, v[36:39] offset:7168
    ds_write_b128 v0, v[40:43] offset:8192
    ds_write_b128 v0, v[44:47] offset:9216
    ds_write_b128 v0, v[48:51] offset:10240
    ds_write_b128 v0, v[52:55] offset:11264
    ds_write_b128 v0, v[56:59] offset:12288
    ds_write_b128 v0, v[60:63] offset:13312
    ds_write_b128 v0, v[64:67] offset:14336
    s_waitcnt vmcnt(0)
    s_mov_b32 s57, 0
K1_PF_CMP:
    v_cmp_ne_u64 vcc, s[30:31], v[2:3]
    s_add_u32 s57, s57, 1
    s_nop 3
    s_cbranch_vccz K1_PF_OK
    s_cmp_ge_u32 s57, 0x40000
    s_cbranch_scc1 K1_PF_OK
    s_sleep 4
    buffer_load_dwordx2 v[2:3], v4, s[24:27], s63 offen offset:0 sc1
    s_waitcnt vmcnt(0)
    s_branch K1_PF_CMP
K1_PF_OK:
    buffer_load_dwordx4 v[208:211], v7, s[24:27], s62 offen sc1
    s_add_u32 s58, s62, 8192
    buffer_load_dwordx4 v[212:215], v7, s[24:27], s58 offen sc1
    s_waitcnt lgkmcnt(0)
    s_barrier
    s_lshl_b32 s56, s48, 10
    s_add_u32 s56, s56, 0
    v_add_u32 v1, s56, v7
    v_add_u32 v2, 65536, v1
    ds_read_b128 v[72:75], v1 offset:0
    ds_read_b128 v[76:79], v1 offset:16384
    ds_read_b128 v[80:83], v1 offset:32768
    ds_read_b128 v[84:87], v1 offset:49152
    ds_read_b128 v[88:91], v2 offset:0
    ds_read_b128 v[92:95], v2 offset:16384
    ds_read_b128 v[96:99], v2 offset:32768
    ds_read_b128 v[100:103], v2 offset:49152
    s_lshl_b32 s56, s48, 10
    s_add_u32 s56, s56, 8192
    v_add_u32 v1, s56, v7
    v_add_u32 v2, 65536, v1
    ds_read_b128 v[104:107], v1 offset:0
    ds_read_b128 v[108:111], v1 offset:16384
    ds_read_b128 v[112:115], v1 offset:32768
    ds_read_b128 v[116:119], v1 offset:49152
    ds_read_b128 v[120:123], v2 offset:0
    ds_read_b128 v[124:127], v2 offset:16384
    ds_read_b128 v[128:131], v2 offset:32768
    ds_read_b128 v[132:135], v2 offset:49152
    v_mul_u32_u24 v3, 1280, v6
    v_lshl_add_u32 v3, v5, 3, v3
    s_add_u32 s56, s48, 0
    s_mul_i32 s57, s56, 11
    s_lshr_b32 s57, s57, 5
    s_mul_i32 s58, s57, 3
    s_sub_u32 s58, s56, s58
    s_mul_i32 s42, s40, 48
    s_lshl_b32 s58, s58, 4
    s_add_u32 s42, s42, s58
    s_mul_i32 s42, s42, 1280
    s_mul_i32 s43, s41, 160
    s_add_u32 s42, s42, s43
    s_lshl_b32 s57, s57, 5
    s_add_u32 s42, s42, s57
    s_waitcnt lgkmcnt(8)
    v_add_f32 v72, v72, v88
    v_add_f32 v73, v73, v89
    v_add_f32 v74, v74, v90
    v_add_f32 v75, v75, v91
    v_add_f32 v76, v76, v92
    v_add_f32 v77, v77, v93
    v_add_f32 v78, v78, v94
    v_add_f32 v79, v79, v95
    v_add_f32 v80, v80, v96
    v_add_f32 v81, v81, v97
    v_add_f32 v82, v82, v98
    v_add_f32 v83, v83, v99
    v_add_f32 v84, v84, v100
    v_add_f32 v85, v85, v101
    v_add_f32 v86, v86, v102
    v_add_f32 v87, v87, v103
    v_add_f32 v72, v72, v80
    v_add_f32 v73, v73, v81
    v_add_f32 v74, v74, v82
    v_add_f32 v75, v75, v83
    v_add_f32 v76, v76, v84
    v_add_f32 v77, v77, v85
    v_add_f32 v78, v78, v86
    v_add_f32 v79, v79, v87
    v_add_f32 v72, v72, v76
    v_add_f32 v73, v73, v77
    v_add_f32 v74, v74, v78
    v_add_f32 v75, v75, v79
    s_waitcnt vmcnt(1)
    v_add_f32 v72, v72, v208
    v_add_f32 v73, v73, v209
    v_add_f32 v74, v74, v210
    v_add_f32 v75, v75, v211
    v_cvt_pk_bf16_f32 v76, v72, v73
    v_cvt_pk_bf16_f32 v77, v74, v75
    buffer_store_dwordx2 v[76:77], v3, s[32:35], s42 offen sc1
    s_add_u32 s56, s48, 8
    s_mul_i32 s57, s56, 11
    s_lshr_b32 s57, s57, 5
    s_mul_i32 s58, s57, 3
    s_sub_u32 s58, s56, s58
    s_mul_i32 s42, s40, 48
    s_lshl_b32 s58, s58, 4
    s_add_u32 s42, s42, s58
    s_mul_i32 s42, s42, 1280
    s_mul_i32 s43, s41, 160
    s_add_u32 s42, s42, s43
    s_lshl_b32 s57, s57, 5
    s_add_u32 s42, s42, s57
    s_cmp_lt_u32 s48, 7
    s_cselect_b32 s42, s42, 0x7f000000
    s_waitcnt lgkmcnt(0)
    v_add_f32 v104, v104, v120
    v_add_f32 v105, v105, v121
    v_add_f32 v106, v106, v122
    v_add_f32 v107, v107, v123
    v_add_f32 v108, v108, v124
    v_add_f32 v109, v109, v125
    v_add_f32 v110, v110, v126
    v_add_f32 v111, v111, v127
    v_add_f32 v112, v112, v128
    v_add_f32 v113, v113, v129
    v_add_f32 v114, v114, v130
    v_add_f32 v115, v115, v131
    v_add_f32 v116, v116, v132
    v_add_f32 v117, v117, v133
    v_add_f32 v118, v118, v134
    v_add_f32 v119, v119, v135
    v_add_f32 v104, v104, v112
    v_add_f32 v105, v105, v113
    v_add_f32 v106, v106, v114
    v_add_f32 v107, v107, v115
    v_add_f32 v108, v108, v116
    v_add_f32 v109, v109, v117
    v_add_f32 v110, v110, v118
    v_add_f32 v111, v111, v119
    v_add_f32 v104, v104, v108
    v_add_f32 v105, v105, v109
    v_add_f32 v106, v106, v110
    v_add_f32 v107, v107, v111
    s_waitcnt vmcnt(1)
    v_add_f32 v104, v104, v212
    v_add_f32 v105, v105, v213
    v_add_f32 v106, v106, v214
    v_add_f32 v107, v107, v215
    v_cvt_pk_bf16_f32 v108, v104, v105
    v_cvt_pk_bf16_f32 v109, v106, v107
    buffer_store_dwordx2 v[108:109], v3, s[32:35], s42 offen sc1
    s_endpgm
K1_END:
    s_endpgm
K1_CODE_END:
.section .rodata,"a"
.p2align 6
.amdhsa_kernel standalone__mha_block_cached__near_ridge_kernel
  .amdhsa_next_free_vgpr 256
  .amdhsa_next_free_sgpr 102
  .amdhsa_accum_offset 256
  .amdhsa_group_segment_fixed_size 0
  .amdhsa_kernarg_size 64
  .amdhsa_user_sgpr_count 2
  .amdhsa_user_sgpr_kernarg_segment_ptr 1
  .amdhsa_system_sgpr_workgroup_id_x 1
.end_amdhsa_kernel
```
